```python
import torch

def _softmax(x, axis=-1):
    return torch.softmax(x, dim=axis)
def _gelu(x):
    return torch.nn.functional.gelu(x, approximate="tanh")
def _silu(x):
    return torch.nn.functional.silu(x)
def _sigmoid(x):
    return torch.sigmoid(x)
def _layernorm(x, axis=-1, eps=1e-5):
    m = x.mean(dim=axis, keepdim=True)
    v = x.var(dim=axis, keepdim=True, unbiased=False)
    return (x - m) / torch.sqrt(v + eps)
def _scatter_add(tgt, idx, src, axis=0):
    return tgt.clone().index_add_(axis, idx, src)
def _segment_sum(src, seg, n):
    out = torch.zeros((n,) + src.shape[1:], dtype=src.dtype)
    return out.index_add_(0, seg, src)
def _pad(x, pw):
    flat = tuple(v for pair in reversed(pw) for v in pair)
    return torch.nn.functional.pad(x, flat)

kernel_name = 'sequential_preLN__grouped_kv_mqa__glu_gated_swiglu__prompt'

def setup_inputs():

    _w = (lambda a: (lambda t: t.to(torch.bfloat16) if t.is_floating_point() else t)(torch.as_tensor(a)))
    def _A_setup():
        B, S, D, H = 1, 2048, 512, 32
        Dh = D // H
        return {
            "x": _w((lambda *s: torch.randn(*s, dtype=torch.bfloat16) * 0.05)(B, S, D)),
            "wq": _w((lambda *s: torch.randn(*s, dtype=torch.bfloat16) * 0.05)(D, H * Dh)),
            "wk": _w((lambda *s: torch.randn(*s, dtype=torch.bfloat16) * 0.05)(D, Dh)),
            "wv": _w((lambda *s: torch.randn(*s, dtype=torch.bfloat16) * 0.05)(D, Dh)),
            "wo": _w((lambda *s: torch.randn(*s, dtype=torch.bfloat16) * 0.05)(H * Dh, D)),
        }
    _A_in = _A_setup()

    def _B_setup():
        B, S, D, F = 1, 2048, 512, 1376
        return {
            "x": _w((lambda *s: torch.randn(*s, dtype=torch.bfloat16) * 0.05)(B, S, D)),
            "w1": _w((lambda *s: torch.randn(*s, dtype=torch.bfloat16) * 0.4)(D, F) * (2.0 / D) ** 0.5),
            "w3": _w((lambda *s: torch.randn(*s, dtype=torch.bfloat16) * 0.4)(D, F) * (2.0 / D) ** 0.5),
            "w2": _w((lambda *s: torch.randn(*s, dtype=torch.bfloat16) * 0.4)(F, D) * (2.0 / F) ** 0.5),
        }
    _B_in = _B_setup()

    return {
        "A_x": _A_in["x"],
        "A_wq": _A_in["wq"],
        "A_wk": _A_in["wk"],
        "A_wv": _A_in["wv"],
        "A_wo": _A_in["wo"],
        "B_x": _B_in["x"],
        "B_w1": _B_in["w1"],
        "B_w3": _B_in["w3"],
        "B_w2": _B_in["w2"],
    }

def reference(A_x, A_wq, A_wk, A_wv, A_wo, B_x, B_w1, B_w3, B_w2):
    def _A_ref(x, wq, wk, wv, wo):
        B, S, D = x.shape
        H = 32
        Dh = D // H
        q = (lambda x, *d: x.permute(*d))((x @ wq).reshape(B, S, H, Dh), 0, 2, 1, 3)
        k = x @ wk
        v = x @ wv
        scores = torch.einsum("bhqd,bkd->bhqk", q, k) * (Dh ** -0.5)
        p = _softmax(scores, axis=-1)
        o = torch.einsum("bhqk,bkd->bhqd", p, v)
        return (lambda x, *d: x.permute(*d))(o, 0, 2, 1, 3).reshape(B, S, H * Dh) @ wo

    def _B_ref(x, w1, w3, w2):
        gate = torch.einsum("bsd,df->bsf", x, w1)
        up = torch.einsum("bsd,df->bsf", x, w3)
        h = _silu(gate) * up
        out = torch.einsum("bsf,fd->bsd", h, w2)
        return out

    x = A_x
    h = x + _A_ref(_layernorm(x, axis=-1), A_wq, A_wk, A_wv, A_wo)
    h2 = h + _B_ref(_layernorm(h, axis=-1), B_w1, B_w3, B_w2)
    return h2
```

```asm
; @launch kernel=qkv_kernel grid=(288,1,1) block=(256,1,1) lds=39424
; @launch kernel=attn_kernel grid=(256,1,1) block=(512,1,1) lds=132096
; @launch kernel=oproj_kernel grid=(256,1,1) block=(256,1,1) lds=39424
; @launch kernel=glu_kernel grid=(704,1,1) block=(256,1,1) lds=59904
; @launch kernel=down_kernel grid=(256,1,1) block=(256,1,1) lds=20992
.amdgcn_target "amdgcn-amd-amdhsa--gfx950"
.text
.p2align 8
.globl qkv_kernel
.type qkv_kernel,@function
qkv_kernel:
  s_cmp_ge_u32 s2, 288
  s_cbranch_scc1 L_qkv_kernel_end
  s_and_b32 s24, s2, 31
  s_lshl_b32 s24, s24, 6
  s_lshr_b32 s25, s2, 5
  s_lshl_b32 s25, s25, 6
  s_cmp_eq_u32 s25, 512
  s_cbranch_scc1 L_kvtile
  s_load_dwordx2 s[4:5], s[0:1], 0
  s_load_dwordx2 s[8:9], s[0:1], 8
  s_load_dwordx2 s[16:17], s[0:1], 88
  s_waitcnt lgkmcnt(0)
  s_mov_b32 s6, 2097152
  s_mov_b32 s7, 0x00020000
  s_mov_b32 s10, 524288
  s_mov_b32 s11, 0x00020000
  s_mov_b32 s18, 2097152
  s_mov_b32 s19, 0x00020000
  s_mov_b32 s26, 1024
  s_mov_b32 s27, 1024
  v_and_b32 v1, 63, v0
  v_lshrrev_b32 v2, 6, v0
  v_lshrrev_b32 v3, 5, v1
  v_and_b32 v4, 31, v1
  v_lshrrev_b32 v5, 4, v1
  v_lshl_add_u32 v5, v2, 4, v5
  v_add_u32 v5, s24, v5
  v_mul_lo_u32 v5, v5, s26
  v_and_b32 v6, 15, v1
  v_lshl_add_u32 v5, v6, 4, v5
  s_mov_b32 s30, 0
  buffer_load_dwordx4 v[64:67], v5, s[4:7], s30 offen offset:0
  s_mov_b32 s30, 0
  buffer_load_dwordx4 v[68:71], v5, s[4:7], s30 offen offset:256
  s_mov_b32 s30, 0
  buffer_load_dwordx4 v[72:75], v5, s[4:7], s30 offen offset:512
  s_mov_b32 s30, 0
  buffer_load_dwordx4 v[76:79], v5, s[4:7], s30 offen offset:768
  s_mov_b32 s30, 4096
  buffer_load_dwordx4 v[80:83], v5, s[4:7], s30 offen offset:0
  s_mov_b32 s30, 4096
  buffer_load_dwordx4 v[84:87], v5, s[4:7], s30 offen offset:256
  s_mov_b32 s30, 4096
  buffer_load_dwordx4 v[88:91], v5, s[4:7], s30 offen offset:512
  s_mov_b32 s30, 4096
  buffer_load_dwordx4 v[92:95], v5, s[4:7], s30 offen offset:768
  s_mov_b32 s30, 8192
  buffer_load_dwordx4 v[96:99], v5, s[4:7], s30 offen offset:0
  s_mov_b32 s30, 8192
  buffer_load_dwordx4 v[100:103], v5, s[4:7], s30 offen offset:256
  s_mov_b32 s30, 8192
  buffer_load_dwordx4 v[104:107], v5, s[4:7], s30 offen offset:512
  s_mov_b32 s30, 8192
  buffer_load_dwordx4 v[108:111], v5, s[4:7], s30 offen offset:768
  s_mov_b32 s30, 12288
  buffer_load_dwordx4 v[112:115], v5, s[4:7], s30 offen offset:0
  s_mov_b32 s30, 12288
  buffer_load_dwordx4 v[116:119], v5, s[4:7], s30 offen offset:256
  s_mov_b32 s30, 12288
  buffer_load_dwordx4 v[120:123], v5, s[4:7], s30 offen offset:512
  s_mov_b32 s30, 12288
  buffer_load_dwordx4 v[124:127], v5, s[4:7], s30 offen offset:768
  s_mov_b32 s31, 0x3f803f80
  s_waitcnt vmcnt(0)
  v_dot2_f32_bf16 v8, v64, s31, 0
  v_dot2_f32_bf16 v9, v64, v64, 0
  v_dot2_f32_bf16 v8, v65, s31, v8
  v_dot2_f32_bf16 v9, v65, v65, v9
  v_dot2_f32_bf16 v8, v66, s31, v8
  v_dot2_f32_bf16 v9, v66, v66, v9
  v_dot2_f32_bf16 v8, v67, s31, v8
  v_dot2_f32_bf16 v9, v67, v67, v9
  v_dot2_f32_bf16 v8, v68, s31, v8
  v_dot2_f32_bf16 v9, v68, v68, v9
  v_dot2_f32_bf16 v8, v69, s31, v8
  v_dot2_f32_bf16 v9, v69, v69, v9
  v_dot2_f32_bf16 v8, v70, s31, v8
  v_dot2_f32_bf16 v9, v70, v70, v9
  v_dot2_f32_bf16 v8, v71, s31, v8
  v_dot2_f32_bf16 v9, v71, v71, v9
  v_dot2_f32_bf16 v8, v72, s31, v8
  v_dot2_f32_bf16 v9, v72, v72, v9
  v_dot2_f32_bf16 v8, v73, s31, v8
  v_dot2_f32_bf16 v9, v73, v73, v9
  v_dot2_f32_bf16 v8, v74, s31, v8
  v_dot2_f32_bf16 v9, v74, v74, v9
  v_dot2_f32_bf16 v8, v75, s31, v8
  v_dot2_f32_bf16 v9, v75, v75, v9
  v_dot2_f32_bf16 v8, v76, s31, v8
  v_dot2_f32_bf16 v9, v76, v76, v9
  v_dot2_f32_bf16 v8, v77, s31, v8
  v_dot2_f32_bf16 v9, v77, v77, v9
  v_dot2_f32_bf16 v8, v78, s31, v8
  v_dot2_f32_bf16 v9, v78, v78, v9
  v_dot2_f32_bf16 v8, v79, s31, v8
  v_dot2_f32_bf16 v9, v79, v79, v9
  v_dot2_f32_bf16 v10, v80, s31, 0
  v_dot2_f32_bf16 v11, v80, v80, 0
  v_dot2_f32_bf16 v10, v81, s31, v10
  v_dot2_f32_bf16 v11, v81, v81, v11
  v_dot2_f32_bf16 v10, v82, s31, v10
  v_dot2_f32_bf16 v11, v82, v82, v11
  v_dot2_f32_bf16 v10, v83, s31, v10
  v_dot2_f32_bf16 v11, v83, v83, v11
  v_dot2_f32_bf16 v10, v84, s31, v10
  v_dot2_f32_bf16 v11, v84, v84, v11
  v_dot2_f32_bf16 v10, v85, s31, v10
  v_dot2_f32_bf16 v11, v85, v85, v11
  v_dot2_f32_bf16 v10, v86, s31, v10
  v_dot2_f32_bf16 v11, v86, v86, v11
  v_dot2_f32_bf16 v10, v87, s31, v10
  v_dot2_f32_bf16 v11, v87, v87, v11
  v_dot2_f32_bf16 v10, v88, s31, v10
  v_dot2_f32_bf16 v11, v88, v88, v11
  v_dot2_f32_bf16 v10, v89, s31, v10
  v_dot2_f32_bf16 v11, v89, v89, v11
  v_dot2_f32_bf16 v10, v90, s31, v10
  v_dot2_f32_bf16 v11, v90, v90, v11
  v_dot2_f32_bf16 v10, v91, s31, v10
  v_dot2_f32_bf16 v11, v91, v91, v11
  v_dot2_f32_bf16 v10, v92, s31, v10
  v_dot2_f32_bf16 v11, v92, v92, v11
  v_dot2_f32_bf16 v10, v93, s31, v10
  v_dot2_f32_bf16 v11, v93, v93, v11
  v_dot2_f32_bf16 v10, v94, s31, v10
  v_dot2_f32_bf16 v11, v94, v94, v11
  v_dot2_f32_bf16 v10, v95, s31, v10
  v_dot2_f32_bf16 v11, v95, v95, v11
  v_dot2_f32_bf16 v12, v96, s31, 0
  v_dot2_f32_bf16 v13, v96, v96, 0
  v_dot2_f32_bf16 v12, v97, s31, v12
  v_dot2_f32_bf16 v13, v97, v97, v13
  v_dot2_f32_bf16 v12, v98, s31, v12
  v_dot2_f32_bf16 v13, v98, v98, v13
  v_dot2_f32_bf16 v12, v99, s31, v12
  v_dot2_f32_bf16 v13, v99, v99, v13
  v_dot2_f32_bf16 v12, v100, s31, v12
  v_dot2_f32_bf16 v13, v100, v100, v13
  v_dot2_f32_bf16 v12, v101, s31, v12
  v_dot2_f32_bf16 v13, v101, v101, v13
  v_dot2_f32_bf16 v12, v102, s31, v12
  v_dot2_f32_bf16 v13, v102, v102, v13
  v_dot2_f32_bf16 v12, v103, s31, v12
  v_dot2_f32_bf16 v13, v103, v103, v13
  v_dot2_f32_bf16 v12, v104, s31, v12
  v_dot2_f32_bf16 v13, v104, v104, v13
  v_dot2_f32_bf16 v12, v105, s31, v12
  v_dot2_f32_bf16 v13, v105, v105, v13
  v_dot2_f32_bf16 v12, v106, s31, v12
  v_dot2_f32_bf16 v13, v106, v106, v13
  v_dot2_f32_bf16 v12, v107, s31, v12
  v_dot2_f32_bf16 v13, v107, v107, v13
  v_dot2_f32_bf16 v12, v108, s31, v12
  v_dot2_f32_bf16 v13, v108, v108, v13
  v_dot2_f32_bf16 v12, v109, s31, v12
  v_dot2_f32_bf16 v13, v109, v109, v13
  v_dot2_f32_bf16 v12, v110, s31, v12
  v_dot2_f32_bf16 v13, v110, v110, v13
  v_dot2_f32_bf16 v12, v111, s31, v12
  v_dot2_f32_bf16 v13, v111, v111, v13
  v_dot2_f32_bf16 v14, v112, s31, 0
  v_dot2_f32_bf16 v15, v112, v112, 0
  v_dot2_f32_bf16 v14, v113, s31, v14
  v_dot2_f32_bf16 v15, v113, v113, v15
  v_dot2_f32_bf16 v14, v114, s31, v14
  v_dot2_f32_bf16 v15, v114, v114, v15
  v_dot2_f32_bf16 v14, v115, s31, v14
  v_dot2_f32_bf16 v15, v115, v115, v15
  v_dot2_f32_bf16 v14, v116, s31, v14
  v_dot2_f32_bf16 v15, v116, v116, v15
  v_dot2_f32_bf16 v14, v117, s31, v14
  v_dot2_f32_bf16 v15, v117, v117, v15
  v_dot2_f32_bf16 v14, v118, s31, v14
  v_dot2_f32_bf16 v15, v118, v118, v15
  v_dot2_f32_bf16 v14, v119, s31, v14
  v_dot2_f32_bf16 v15, v119, v119, v15
  v_dot2_f32_bf16 v14, v120, s31, v14
  v_dot2_f32_bf16 v15, v120, v120, v15
  v_dot2_f32_bf16 v14, v121, s31, v14
  v_dot2_f32_bf16 v15, v121, v121, v15
  v_dot2_f32_bf16 v14, v122, s31, v14
  v_dot2_f32_bf16 v15, v122, v122, v15
  v_dot2_f32_bf16 v14, v123, s31, v14
  v_dot2_f32_bf16 v15, v123, v123, v15
  v_dot2_f32_bf16 v14, v124, s31, v14
  v_dot2_f32_bf16 v15, v124, v124, v15
  v_dot2_f32_bf16 v14, v125, s31, v14
  v_dot2_f32_bf16 v15, v125, v125, v15
  v_dot2_f32_bf16 v14, v126, s31, v14
  v_dot2_f32_bf16 v15, v126, v126, v15
  v_dot2_f32_bf16 v14, v127, s31, v14
  v_dot2_f32_bf16 v15, v127, v127, v15
  v_add_f32_dpp v16, v8, v8 row_ror:1 row_mask:0xf bank_mask:0xf
  v_add_f32_dpp v17, v9, v9 row_ror:1 row_mask:0xf bank_mask:0xf
  v_add_f32_dpp v18, v10, v10 row_ror:1 row_mask:0xf bank_mask:0xf
  v_add_f32_dpp v19, v11, v11 row_ror:1 row_mask:0xf bank_mask:0xf
  v_add_f32_dpp v20, v12, v12 row_ror:1 row_mask:0xf bank_mask:0xf
  v_add_f32_dpp v21, v13, v13 row_ror:1 row_mask:0xf bank_mask:0xf
  v_add_f32_dpp v22, v14, v14 row_ror:1 row_mask:0xf bank_mask:0xf
  v_add_f32_dpp v23, v15, v15 row_ror:1 row_mask:0xf bank_mask:0xf
  v_mov_b32 v8, v16
  v_mov_b32 v9, v17
  v_mov_b32 v10, v18
  v_mov_b32 v11, v19
  v_mov_b32 v12, v20
  v_mov_b32 v13, v21
  v_mov_b32 v14, v22
  v_mov_b32 v15, v23
  v_add_f32_dpp v16, v8, v8 row_ror:2 row_mask:0xf bank_mask:0xf
  v_add_f32_dpp v17, v9, v9 row_ror:2 row_mask:0xf bank_mask:0xf
  v_add_f32_dpp v18, v10, v10 row_ror:2 row_mask:0xf bank_mask:0xf
  v_add_f32_dpp v19, v11, v11 row_ror:2 row_mask:0xf bank_mask:0xf
  v_add_f32_dpp v20, v12, v12 row_ror:2 row_mask:0xf bank_mask:0xf
  v_add_f32_dpp v21, v13, v13 row_ror:2 row_mask:0xf bank_mask:0xf
  v_add_f32_dpp v22, v14, v14 row_ror:2 row_mask:0xf bank_mask:0xf
  v_add_f32_dpp v23, v15, v15 row_ror:2 row_mask:0xf bank_mask:0xf
  v_mov_b32 v8, v16
  v_mov_b32 v9, v17
  v_mov_b32 v10, v18
  v_mov_b32 v11, v19
  v_mov_b32 v12, v20
  v_mov_b32 v13, v21
  v_mov_b32 v14, v22
  v_mov_b32 v15, v23
  v_add_f32_dpp v16, v8, v8 row_ror:4 row_mask:0xf bank_mask:0xf
  v_add_f32_dpp v17, v9, v9 row_ror:4 row_mask:0xf bank_mask:0xf
  v_add_f32_dpp v18, v10, v10 row_ror:4 row_mask:0xf bank_mask:0xf
  v_add_f32_dpp v19, v11, v11 row_ror:4 row_mask:0xf bank_mask:0xf
  v_add_f32_dpp v20, v12, v12 row_ror:4 row_mask:0xf bank_mask:0xf
  v_add_f32_dpp v21, v13, v13 row_ror:4 row_mask:0xf bank_mask:0xf
  v_add_f32_dpp v22, v14, v14 row_ror:4 row_mask:0xf bank_mask:0xf
  v_add_f32_dpp v23, v15, v15 row_ror:4 row_mask:0xf bank_mask:0xf
  v_mov_b32 v8, v16
  v_mov_b32 v9, v17
  v_mov_b32 v10, v18
  v_mov_b32 v11, v19
  v_mov_b32 v12, v20
  v_mov_b32 v13, v21
  v_mov_b32 v14, v22
  v_mov_b32 v15, v23
  v_add_f32_dpp v16, v8, v8 row_ror:8 row_mask:0xf bank_mask:0xf
  v_add_f32_dpp v17, v9, v9 row_ror:8 row_mask:0xf bank_mask:0xf
  v_add_f32_dpp v18, v10, v10 row_ror:8 row_mask:0xf bank_mask:0xf
  v_add_f32_dpp v19, v11, v11 row_ror:8 row_mask:0xf bank_mask:0xf
  v_add_f32_dpp v20, v12, v12 row_ror:8 row_mask:0xf bank_mask:0xf
  v_add_f32_dpp v21, v13, v13 row_ror:8 row_mask:0xf bank_mask:0xf
  v_add_f32_dpp v22, v14, v14 row_ror:8 row_mask:0xf bank_mask:0xf
  v_add_f32_dpp v23, v15, v15 row_ror:8 row_mask:0xf bank_mask:0xf
  v_mov_b32 v8, v16
  v_mov_b32 v9, v17
  v_mov_b32 v10, v18
  v_mov_b32 v11, v19
  v_mov_b32 v12, v20
  v_mov_b32 v13, v21
  v_mov_b32 v14, v22
  v_mov_b32 v15, v23
  s_mov_b32 s31, 989855744
  s_mov_b32 s30, 925353388
  v_lshrrev_b32 v6, 4, v1
  v_lshl_add_u32 v6, v2, 4, v6
  v_lshlrev_b32 v6, 3, v6
  v_mul_f32 v8, s31, v8
  v_mul_f32 v9, s31, v9
  v_fma_f32 v9, -v8, v8, v9
  v_max_f32 v9, 0, v9
  v_add_f32 v9, s30, v9
  v_rsq_f32 v9, v9
  s_nop 0
  v_mul_f32 v8, v8, v9
  v_sub_f32 v8, 0, v8
  ds_write_b64 v6, v[8:9] offset:0
  v_mul_f32 v10, s31, v10
  v_mul_f32 v11, s31, v11
  v_fma_f32 v11, -v10, v10, v11
  v_max_f32 v11, 0, v11
  v_add_f32 v11, s30, v11
  v_rsq_f32 v11, v11
  s_nop 0
  v_mul_f32 v10, v10, v11
  v_sub_f32 v10, 0, v10
  ds_write_b64 v6, v[10:11] offset:32
  v_mul_f32 v12, s31, v12
  v_mul_f32 v13, s31, v13
  v_fma_f32 v13, -v12, v12, v13
  v_max_f32 v13, 0, v13
  v_add_f32 v13, s30, v13
  v_rsq_f32 v13, v13
  s_nop 0
  v_mul_f32 v12, v12, v13
  v_sub_f32 v12, 0, v12
  ds_write_b64 v6, v[12:13] offset:64
  v_mul_f32 v14, s31, v14
  v_mul_f32 v15, s31, v15
  v_fma_f32 v15, -v14, v14, v15
  v_max_f32 v15, 0, v15
  v_add_f32 v15, s30, v15
  v_rsq_f32 v15, v15
  s_nop 0
  v_mul_f32 v14, v14, v15
  v_sub_f32 v14, 0, v14
  ds_write_b64 v6, v[14:15] offset:96
  s_waitcnt lgkmcnt(0)
  s_barrier
  v_lshrrev_b32 v6, 3, v0
  v_lshlrev_b32 v6, 3, v6
  ds_read_b64 v[24:25], v6 offset:0
  ds_read_b64 v[26:27], v6 offset:256
  v_lshrrev_b32 v5, 3, v0
  v_and_b32 v6, 7, v0
  v_add_u32 v7, s24, v5
  v_mul_lo_u32 v7, v7, s26
  v_lshl_add_u32 v8, v6, 4, v7
  v_add_u32 v9, 32768, v8
  v_mul_u32_u24 v10, 144, v5
  v_lshl_add_u32 v10, v6, 4, v10
  v_lshrrev_b32 v5, 3, v0
  v_and_b32 v6, 7, v0
  v_mul_lo_u32 v7, v5, s27
  v_lshl_add_u32 v7, v6, 4, v7
  s_lshl_b32 s28, s25, 1
  v_add_u32 v11, s28, v7
  v_add_u32 v12, 32768, v11
  v_mul_u32_u24 v13, 160, v5
  v_lshl_add_u32 v13, v6, 4, v13
  v_lshrrev_b32 v5, 1, v2
  v_and_b32 v6, 1, v2
  v_lshl_add_u32 v7, v5, 5, v4
  v_mul_u32_u24 v14, 144, v7
  v_lshl_add_u32 v14, v3, 4, v14
  v_and_b32 v7, 15, v1
  v_lshrrev_b32 v7, 2, v7
  v_lshl_add_u32 v7, v3, 3, v7
  v_mul_u32_u24 v15, 160, v7
  v_lshl_add_u32 v15, v6, 6, v15
  v_lshrrev_b32 v7, 4, v1
  v_and_b32 v7, 1, v7
  v_lshl_add_u32 v15, v7, 5, v15
  v_and_b32 v7, 3, v1
  v_lshl_add_u32 v15, v7, 3, v15
  s_waitcnt lgkmcnt(0)
  buffer_load_dwordx4 v[136:139], v8, s[4:7], 0 offen offset:0
  buffer_load_dwordx4 v[140:143], v9, s[4:7], 0 offen offset:0
  s_mov_b32 s29, 0
  buffer_load_dwordx4 v[144:147], v11, s[8:11], s29 offen
  buffer_load_dwordx4 v[148:151], v12, s[8:11], s29 offen
  buffer_load_dwordx4 v[152:155], v8, s[4:7], 0 offen offset:128
  buffer_load_dwordx4 v[156:159], v9, s[4:7], 0 offen offset:128
  s_mov_b32 s29, 65536
  buffer_load_dwordx4 v[160:163], v11, s[8:11], s29 offen
  buffer_load_dwordx4 v[164:167], v12, s[8:11], s29 offen
  buffer_load_dwordx4 v[168:171], v8, s[4:7], 0 offen offset:256
  buffer_load_dwordx4 v[172:175], v9, s[4:7], 0 offen offset:256
  s_mov_b32 s29, 131072
  buffer_load_dwordx4 v[176:179], v11, s[8:11], s29 offen
  buffer_load_dwordx4 v[180:183], v12, s[8:11], s29 offen
  s_waitcnt vmcnt(8)
  v_lshlrev_b32 v28, 16, v136
  v_and_b32 v29, 0xffff0000, v136
  v_fma_f32 v28, v28, v25, v24
  v_fma_f32 v29, v29, v25, v24
  v_cvt_pk_bf16_f32 v136, v28, v29
  v_lshlrev_b32 v28, 16, v137
  v_and_b32 v29, 0xffff0000, v137
  v_fma_f32 v28, v28, v25, v24
  v_fma_f32 v29, v29, v25, v24
  v_cvt_pk_bf16_f32 v137, v28, v29
  v_lshlrev_b32 v28, 16, v138
  v_and_b32 v29, 0xffff0000, v138
  v_fma_f32 v28, v28, v25, v24
  v_fma_f32 v29, v29, v25, v24
  v_cvt_pk_bf16_f32 v138, v28, v29
  v_lshlrev_b32 v28, 16, v139
  v_and_b32 v29, 0xffff0000, v139
  v_fma_f32 v28, v28, v25, v24
  v_fma_f32 v29, v29, v25, v24
  v_cvt_pk_bf16_f32 v139, v28, v29
  v_lshlrev_b32 v28, 16, v140
  v_and_b32 v29, 0xffff0000, v140
  v_fma_f32 v28, v28, v27, v26
  v_fma_f32 v29, v29, v27, v26
  v_cvt_pk_bf16_f32 v140, v28, v29
  v_lshlrev_b32 v28, 16, v141
  v_and_b32 v29, 0xffff0000, v141
  v_fma_f32 v28, v28, v27, v26
  v_fma_f32 v29, v29, v27, v26
  v_cvt_pk_bf16_f32 v141, v28, v29
  v_lshlrev_b32 v28, 16, v142
  v_and_b32 v29, 0xffff0000, v142
  v_fma_f32 v28, v28, v27, v26
  v_fma_f32 v29, v29, v27, v26
  v_cvt_pk_bf16_f32 v142, v28, v29
  v_lshlrev_b32 v28, 16, v143
  v_and_b32 v29, 0xffff0000, v143
  v_fma_f32 v28, v28, v27, v26
  v_fma_f32 v29, v29, v27, v26
  v_cvt_pk_bf16_f32 v143, v28, v29
  ds_write_b128 v10, v[136:139] offset:512
  ds_write_b128 v10, v[140:143] offset:5120
  ds_write_b128 v13, v[144:147] offset:9728
  ds_write_b128 v13, v[148:151] offset:14848
  s_waitcnt lgkmcnt(0)
  s_barrier
  buffer_load_dwordx4 v[136:139], v8, s[4:7], 0 offen offset:384
  buffer_load_dwordx4 v[140:143], v9, s[4:7], 0 offen offset:384
  s_mov_b32 s29, 196608
  buffer_load_dwordx4 v[144:147], v11, s[8:11], s29 offen
  buffer_load_dwordx4 v[148:151], v12, s[8:11], s29 offen
  ds_read_b128 v[88:91], v14 offset:512
  ds_read_b64_tr_b16 v[104:105], v15 offset:9728
  ds_read_b64_tr_b16 v[106:107], v15 offset:10368
  ds_read_b128 v[92:95], v14 offset:544
  ds_read_b64_tr_b16 v[108:109], v15 offset:12288
  ds_read_b64_tr_b16 v[110:111], v15 offset:12928
  ds_read_b128 v[96:99], v14 offset:576
  ds_read_b64_tr_b16 v[112:113], v15 offset:14848
  ds_read_b64_tr_b16 v[114:115], v15 offset:15488
  ds_read_b128 v[100:103], v14 offset:608
  ds_read_b64_tr_b16 v[116:117], v15 offset:17408
  ds_read_b64_tr_b16 v[118:119], v15 offset:18048
  s_waitcnt lgkmcnt(9)
  v_mfma_f32_32x32x16_bf16 v[32:47], v[88:91], v[104:107], 0
  s_waitcnt lgkmcnt(6)
  v_mfma_f32_32x32x16_bf16 v[32:47], v[92:95], v[108:111], v[32:47]
  s_waitcnt lgkmcnt(3)
  v_mfma_f32_32x32x16_bf16 v[32:47], v[96:99], v[112:115], v[32:47]
  s_waitcnt lgkmcnt(0)
  v_mfma_f32_32x32x16_bf16 v[32:47], v[100:103], v[116:119], v[32:47]
  s_waitcnt vmcnt(8)
  v_lshlrev_b32 v28, 16, v152
  v_and_b32 v29, 0xffff0000, v152
  v_fma_f32 v28, v28, v25, v24
  v_fma_f32 v29, v29, v25, v24
  v_cvt_pk_bf16_f32 v152, v28, v29
  v_lshlrev_b32 v28, 16, v153
  v_and_b32 v29, 0xffff0000, v153
  v_fma_f32 v28, v28, v25, v24
  v_fma_f32 v29, v29, v25, v24
  v_cvt_pk_bf16_f32 v153, v28, v29
  v_lshlrev_b32 v28, 16, v154
  v_and_b32 v29, 0xffff0000, v154
  v_fma_f32 v28, v28, v25, v24
  v_fma_f32 v29, v29, v25, v24
  v_cvt_pk_bf16_f32 v154, v28, v29
  v_lshlrev_b32 v28, 16, v155
  v_and_b32 v29, 0xffff0000, v155
  v_fma_f32 v28, v28, v25, v24
  v_fma_f32 v29, v29, v25, v24
  v_cvt_pk_bf16_f32 v155, v28, v29
  v_lshlrev_b32 v28, 16, v156
  v_and_b32 v29, 0xffff0000, v156
  v_fma_f32 v28, v28, v27, v26
  v_fma_f32 v29, v29, v27, v26
  v_cvt_pk_bf16_f32 v156, v28, v29
  v_lshlrev_b32 v28, 16, v157
  v_and_b32 v29, 0xffff0000, v157
  v_fma_f32 v28, v28, v27, v26
  v_fma_f32 v29, v29, v27, v26
  v_cvt_pk_bf16_f32 v157, v28, v29
  v_lshlrev_b32 v28, 16, v158
  v_and_b32 v29, 0xffff0000, v158
  v_fma_f32 v28, v28, v27, v26
  v_fma_f32 v29, v29, v27, v26
  v_cvt_pk_bf16_f32 v158, v28, v29
  v_lshlrev_b32 v28, 16, v159
  v_and_b32 v29, 0xffff0000, v159
  v_fma_f32 v28, v28, v27, v26
  v_fma_f32 v29, v29, v27, v26
  v_cvt_pk_bf16_f32 v159, v28, v29
  ds_write_b128 v10, v[152:155] offset:19968
  ds_write_b128 v10, v[156:159] offset:24576
  ds_write_b128 v13, v[160:163] offset:29184
  ds_write_b128 v13, v[164:167] offset:34304
  s_waitcnt lgkmcnt(0)
  s_barrier
  buffer_load_dwordx4 v[152:155], v8, s[4:7], 0 offen offset:512
  buffer_load_dwordx4 v[156:159], v9, s[4:7], 0 offen offset:512
  s_mov_b32 s29, 262144
  buffer_load_dwordx4 v[160:163], v11, s[8:11], s29 offen
  buffer_load_dwordx4 v[164:167], v12, s[8:11], s29 offen
  ds_read_b128 v[88:91], v14 offset:19968
  ds_read_b64_tr_b16 v[104:105], v15 offset:29184
  ds_read_b64_tr_b16 v[106:107], v15 offset:29824
  ds_read_b128 v[92:95], v14 offset:20000
  ds_read_b64_tr_b16 v[108:109], v15 offset:31744
  ds_read_b64_tr_b16 v[110:111], v15 offset:32384
  ds_read_b128 v[96:99], v14 offset:20032
  ds_read_b64_tr_b16 v[112:113], v15 offset:34304
  ds_read_b64_tr_b16 v[114:115], v15 offset:34944
  ds_read_b128 v[100:103], v14 offset:20064
  ds_read_b64_tr_b16 v[116:117], v15 offset:36864
  ds_read_b64_tr_b16 v[118:119], v15 offset:37504
  s_waitcnt lgkmcnt(9)
  v_mfma_f32_32x32x16_bf16 v[32:47], v[88:91], v[104:107], v[32:47]
  s_waitcnt lgkmcnt(6)
  v_mfma_f32_32x32x16_bf16 v[32:47], v[92:95], v[108:111], v[32:47]
  s_waitcnt lgkmcnt(3)
  v_mfma_f32_32x32x16_bf16 v[32:47], v[96:99], v[112:115], v[32:47]
  s_waitcnt lgkmcnt(0)
  v_mfma_f32_32x32x16_bf16 v[32:47], v[100:103], v[116:119], v[32:47]
  s_waitcnt vmcnt(8)
  v_lshlrev_b32 v28, 16, v168
  v_and_b32 v29, 0xffff0000, v168
  v_fma_f32 v28, v28, v25, v24
  v_fma_f32 v29, v29, v25, v24
  v_cvt_pk_bf16_f32 v168, v28, v29
  v_lshlrev_b32 v28, 16, v169
  v_and_b32 v29, 0xffff0000, v169
  v_fma_f32 v28, v28, v25, v24
  v_fma_f32 v29, v29, v25, v24
  v_cvt_pk_bf16_f32 v169, v28, v29
  v_lshlrev_b32 v28, 16, v170
  v_and_b32 v29, 0xffff0000, v170
  v_fma_f32 v28, v28, v25, v24
  v_fma_f32 v29, v29, v25, v24
  v_cvt_pk_bf16_f32 v170, v28, v29
  v_lshlrev_b32 v28, 16, v171
  v_and_b32 v29, 0xffff0000, v171
  v_fma_f32 v28, v28, v25, v24
  v_fma_f32 v29, v29, v25, v24
  v_cvt_pk_bf16_f32 v171, v28, v29
  v_lshlrev_b32 v28, 16, v172
  v_and_b32 v29, 0xffff0000, v172
  v_fma_f32 v28, v28, v27, v26
  v_fma_f32 v29, v29, v27, v26
  v_cvt_pk_bf16_f32 v172, v28, v29
  v_lshlrev_b32 v28, 16, v173
  v_and_b32 v29, 0xffff0000, v173
  v_fma_f32 v28, v28, v27, v26
  v_fma_f32 v29, v29, v27, v26
  v_cvt_pk_bf16_f32 v173, v28, v29
  v_lshlrev_b32 v28, 16, v174
  v_and_b32 v29, 0xffff0000, v174
  v_fma_f32 v28, v28, v27, v26
  v_fma_f32 v29, v29, v27, v26
  v_cvt_pk_bf16_f32 v174, v28, v29
  v_lshlrev_b32 v28, 16, v175
  v_and_b32 v29, 0xffff0000, v175
  v_fma_f32 v28, v28, v27, v26
  v_fma_f32 v29, v29, v27, v26
  v_cvt_pk_bf16_f32 v175, v28, v29
  ds_write_b128 v10, v[168:171] offset:512
  ds_write_b128 v10, v[172:175] offset:5120
  ds_write_b128 v13, v[176:179] offset:9728
  ds_write_b128 v13, v[180:183] offset:14848
  s_waitcnt lgkmcnt(0)
  s_barrier
  buffer_load_dwordx4 v[168:171], v8, s[4:7], 0 offen offset:640
  buffer_load_dwordx4 v[172:175], v9, s[4:7], 0 offen offset:640
  s_mov_b32 s29, 327680
  buffer_load_dwordx4 v[176:179], v11, s[8:11], s29 offen
  buffer_load_dwordx4 v[180:183], v12, s[8:11], s29 offen
  ds_read_b128 v[88:91], v14 offset:512
  ds_read_b64_tr_b16 v[104:105], v15 offset:9728
  ds_read_b64_tr_b16 v[106:107], v15 offset:10368
  ds_read_b128 v[92:95], v14 offset:544
  ds_read_b64_tr_b16 v[108:109], v15 offset:12288
  ds_read_b64_tr_b16 v[110:111], v15 offset:12928
  ds_read_b128 v[96:99], v14 offset:576
  ds_read_b64_tr_b16 v[112:113], v15 offset:14848
  ds_read_b64_tr_b16 v[114:115], v15 offset:15488
  ds_read_b128 v[100:103], v14 offset:608
  ds_read_b64_tr_b16 v[116:117], v15 offset:17408
  ds_read_b64_tr_b16 v[118:119], v15 offset:18048
  s_waitcnt lgkmcnt(9)
  v_mfma_f32_32x32x16_bf16 v[32:47], v[88:91], v[104:107], v[32:47]
  s_waitcnt lgkmcnt(6)
  v_mfma_f32_32x32x16_bf16 v[32:47], v[92:95], v[108:111], v[32:47]
  s_waitcnt lgkmcnt(3)
  v_mfma_f32_32x32x16_bf16 v[32:47], v[96:99], v[112:115], v[32:47]
  s_waitcnt lgkmcnt(0)
  v_mfma_f32_32x32x16_bf16 v[32:47], v[100:103], v[116:119], v[32:47]
  s_waitcnt vmcnt(8)
  v_lshlrev_b32 v28, 16, v136
  v_and_b32 v29, 0xffff0000, v136
  v_fma_f32 v28, v28, v25, v24
  v_fma_f32 v29, v29, v25, v24
  v_cvt_pk_bf16_f32 v136, v28, v29
  v_lshlrev_b32 v28, 16, v137
  v_and_b32 v29, 0xffff0000, v137
  v_fma_f32 v28, v28, v25, v24
  v_fma_f32 v29, v29, v25, v24
  v_cvt_pk_bf16_f32 v137, v28, v29
  v_lshlrev_b32 v28, 16, v138
  v_and_b32 v29, 0xffff0000, v138
  v_fma_f32 v28, v28, v25, v24
  v_fma_f32 v29, v29, v25, v24
  v_cvt_pk_bf16_f32 v138, v28, v29
  v_lshlrev_b32 v28, 16, v139
  v_and_b32 v29, 0xffff0000, v139
  v_fma_f32 v28, v28, v25, v24
  v_fma_f32 v29, v29, v25, v24
  v_cvt_pk_bf16_f32 v139, v28, v29
  v_lshlrev_b32 v28, 16, v140
  v_and_b32 v29, 0xffff0000, v140
  v_fma_f32 v28, v28, v27, v26
  v_fma_f32 v29, v29, v27, v26
  v_cvt_pk_bf16_f32 v140, v28, v29
  v_lshlrev_b32 v28, 16, v141
  v_and_b32 v29, 0xffff0000, v141
  v_fma_f32 v28, v28, v27, v26
  v_fma_f32 v29, v29, v27, v26
  v_cvt_pk_bf16_f32 v141, v28, v29
  v_lshlrev_b32 v28, 16, v142
  v_and_b32 v29, 0xffff0000, v142
  v_fma_f32 v28, v28, v27, v26
  v_fma_f32 v29, v29, v27, v26
  v_cvt_pk_bf16_f32 v142, v28, v29
  v_lshlrev_b32 v28, 16, v143
  v_and_b32 v29, 0xffff0000, v143
  v_fma_f32 v28, v28, v27, v26
  v_fma_f32 v29, v29, v27, v26
  v_cvt_pk_bf16_f32 v143, v28, v29
  ds_write_b128 v10, v[136:139] offset:19968
  ds_write_b128 v10, v[140:143] offset:24576
  ds_write_b128 v13, v[144:147] offset:29184
  ds_write_b128 v13, v[148:151] offset:34304
  s_waitcnt lgkmcnt(0)
  s_barrier
  buffer_load_dwordx4 v[136:139], v8, s[4:7], 0 offen offset:768
  buffer_load_dwordx4 v[140:143], v9, s[4:7], 0 offen offset:768
  s_mov_b32 s29, 393216
  buffer_load_dwordx4 v[144:147], v11, s[8:11], s29 offen
  buffer_load_dwordx4 v[148:151], v12, s[8:11], s29 offen
  ds_read_b128 v[88:91], v14 offset:19968
  ds_read_b64_tr_b16 v[104:105], v15 offset:29184
  ds_read_b64_tr_b16 v[106:107], v15 offset:29824
  ds_read_b128 v[92:95], v14 offset:20000
  ds_read_b64_tr_b16 v[108:109], v15 offset:31744
  ds_read_b64_tr_b16 v[110:111], v15 offset:32384
  ds_read_b128 v[96:99], v14 offset:20032
  ds_read_b64_tr_b16 v[112:113], v15 offset:34304
  ds_read_b64_tr_b16 v[114:115], v15 offset:34944
  ds_read_b128 v[100:103], v14 offset:20064
  ds_read_b64_tr_b16 v[116:117], v15 offset:36864
  ds_read_b64_tr_b16 v[118:119], v15 offset:37504
  s_waitcnt lgkmcnt(9)
  v_mfma_f32_32x32x16_bf16 v[32:47], v[88:91], v[104:107], v[32:47]
  s_waitcnt lgkmcnt(6)
  v_mfma_f32_32x32x16_bf16 v[32:47], v[92:95], v[108:111], v[32:47]
  s_waitcnt lgkmcnt(3)
  v_mfma_f32_32x32x16_bf16 v[32:47], v[96:99], v[112:115], v[32:47]
  s_waitcnt lgkmcnt(0)
  v_mfma_f32_32x32x16_bf16 v[32:47], v[100:103], v[116:119], v[32:47]
  s_waitcnt vmcnt(8)
  v_lshlrev_b32 v28, 16, v152
  v_and_b32 v29, 0xffff0000, v152
  v_fma_f32 v28, v28, v25, v24
  v_fma_f32 v29, v29, v25, v24
  v_cvt_pk_bf16_f32 v152, v28, v29
  v_lshlrev_b32 v28, 16, v153
  v_and_b32 v29, 0xffff0000, v153
  v_fma_f32 v28, v28, v25, v24
  v_fma_f32 v29, v29, v25, v24
  v_cvt_pk_bf16_f32 v153, v28, v29
  v_lshlrev_b32 v28, 16, v154
  v_and_b32 v29, 0xffff0000, v154
  v_fma_f32 v28, v28, v25, v24
  v_fma_f32 v29, v29, v25, v24
  v_cvt_pk_bf16_f32 v154, v28, v29
  v_lshlrev_b32 v28, 16, v155
  v_and_b32 v29, 0xffff0000, v155
  v_fma_f32 v28, v28, v25, v24
  v_fma_f32 v29, v29, v25, v24
  v_cvt_pk_bf16_f32 v155, v28, v29
  v_lshlrev_b32 v28, 16, v156
  v_and_b32 v29, 0xffff0000, v156
  v_fma_f32 v28, v28, v27, v26
  v_fma_f32 v29, v29, v27, v26
  v_cvt_pk_bf16_f32 v156, v28, v29
  v_lshlrev_b32 v28, 16, v157
  v_and_b32 v29, 0xffff0000, v157
  v_fma_f32 v28, v28, v27, v26
  v_fma_f32 v29, v29, v27, v26
  v_cvt_pk_bf16_f32 v157, v28, v29
  v_lshlrev_b32 v28, 16, v158
  v_and_b32 v29, 0xffff0000, v158
  v_fma_f32 v28, v28, v27, v26
  v_fma_f32 v29, v29, v27, v26
  v_cvt_pk_bf16_f32 v158, v28, v29
  v_lshlrev_b32 v28, 16, v159
  v_and_b32 v29, 0xffff0000, v159
  v_fma_f32 v28, v28, v27, v26
  v_fma_f32 v29, v29, v27, v26
  v_cvt_pk_bf16_f32 v159, v28, v29
  ds_write_b128 v10, v[152:155] offset:512
  ds_write_b128 v10, v[156:159] offset:5120
  ds_write_b128 v13, v[160:163] offset:9728
  ds_write_b128 v13, v[164:167] offset:14848
  s_waitcnt lgkmcnt(0)
  s_barrier
  buffer_load_dwordx4 v[152:155], v8, s[4:7], 0 offen offset:896
  buffer_load_dwordx4 v[156:159], v9, s[4:7], 0 offen offset:896
  s_mov_b32 s29, 458752
  buffer_load_dwordx4 v[160:163], v11, s[8:11], s29 offen
  buffer_load_dwordx4 v[164:167], v12, s[8:11], s29 offen
  ds_read_b128 v[88:91], v14 offset:512
  ds_read_b64_tr_b16 v[104:105], v15 offset:9728
  ds_read_b64_tr_b16 v[106:107], v15 offset:10368
  ds_read_b128 v[92:95], v14 offset:544
  ds_read_b64_tr_b16 v[108:109], v15 offset:12288
  ds_read_b64_tr_b16 v[110:111], v15 offset:12928
  ds_read_b128 v[96:99], v14 offset:576
  ds_read_b64_tr_b16 v[112:113], v15 offset:14848
  ds_read_b64_tr_b16 v[114:115], v15 offset:15488
  ds_read_b128 v[100:103], v14 offset:608
  ds_read_b64_tr_b16 v[116:117], v15 offset:17408
  ds_read_b64_tr_b16 v[118:119], v15 offset:18048
  s_waitcnt lgkmcnt(9)
  v_mfma_f32_32x32x16_bf16 v[32:47], v[88:91], v[104:107], v[32:47]
  s_waitcnt lgkmcnt(6)
  v_mfma_f32_32x32x16_bf16 v[32:47], v[92:95], v[108:111], v[32:47]
  s_waitcnt lgkmcnt(3)
  v_mfma_f32_32x32x16_bf16 v[32:47], v[96:99], v[112:115], v[32:47]
  s_waitcnt lgkmcnt(0)
  v_mfma_f32_32x32x16_bf16 v[32:47], v[100:103], v[116:119], v[32:47]
  s_waitcnt vmcnt(8)
  v_lshlrev_b32 v28, 16, v168
  v_and_b32 v29, 0xffff0000, v168
  v_fma_f32 v28, v28, v25, v24
  v_fma_f32 v29, v29, v25, v24
  v_cvt_pk_bf16_f32 v168, v28, v29
  v_lshlrev_b32 v28, 16, v169
  v_and_b32 v29, 0xffff0000, v169
  v_fma_f32 v28, v28, v25, v24
  v_fma_f32 v29, v29, v25, v24
  v_cvt_pk_bf16_f32 v169, v28, v29
  v_lshlrev_b32 v28, 16, v170
  v_and_b32 v29, 0xffff0000, v170
  v_fma_f32 v28, v28, v25, v24
  v_fma_f32 v29, v29, v25, v24
  v_cvt_pk_bf16_f32 v170, v28, v29
  v_lshlrev_b32 v28, 16, v171
  v_and_b32 v29, 0xffff0000, v171
  v_fma_f32 v28, v28, v25, v24
  v_fma_f32 v29, v29, v25, v24
  v_cvt_pk_bf16_f32 v171, v28, v29
  v_lshlrev_b32 v28, 16, v172
  v_and_b32 v29, 0xffff0000, v172
  v_fma_f32 v28, v28, v27, v26
  v_fma_f32 v29, v29, v27, v26
  v_cvt_pk_bf16_f32 v172, v28, v29
  v_lshlrev_b32 v28, 16, v173
  v_and_b32 v29, 0xffff0000, v173
  v_fma_f32 v28, v28, v27, v26
  v_fma_f32 v29, v29, v27, v26
  v_cvt_pk_bf16_f32 v173, v28, v29
  v_lshlrev_b32 v28, 16, v174
  v_and_b32 v29, 0xffff0000, v174
  v_fma_f32 v28, v28, v27, v26
  v_fma_f32 v29, v29, v27, v26
  v_cvt_pk_bf16_f32 v174, v28, v29
  v_lshlrev_b32 v28, 16, v175
  v_and_b32 v29, 0xffff0000, v175
  v_fma_f32 v28, v28, v27, v26
  v_fma_f32 v29, v29, v27, v26
  v_cvt_pk_bf16_f32 v175, v28, v29
  ds_write_b128 v10, v[168:171] offset:19968
  ds_write_b128 v10, v[172:175] offset:24576
  ds_write_b128 v13, v[176:179] offset:29184
  ds_write_b128 v13, v[180:183] offset:34304
  s_waitcnt lgkmcnt(0)
  s_barrier
  ds_read_b128 v[88:91], v14 offset:19968
  ds_read_b64_tr_b16 v[104:105], v15 offset:29184
  ds_read_b64_tr_b16 v[106:107], v15 offset:29824
  ds_read_b128 v[92:95], v14 offset:20000
  ds_read_b64_tr_b16 v[108:109], v15 offset:31744
  ds_read_b64_tr_b16 v[110:111], v15 offset:32384
  ds_read_b128 v[96:99], v14 offset:20032
  ds_read_b64_tr_b16 v[112:113], v15 offset:34304
  ds_read_b64_tr_b16 v[114:115], v15 offset:34944
  ds_read_b128 v[100:103], v14 offset:20064
  ds_read_b64_tr_b16 v[116:117], v15 offset:36864
  ds_read_b64_tr_b16 v[118:119], v15 offset:37504
  s_waitcnt lgkmcnt(9)
  v_mfma_f32_32x32x16_bf16 v[32:47], v[88:91], v[104:107], v[32:47]
  s_waitcnt lgkmcnt(6)
  v_mfma_f32_32x32x16_bf16 v[32:47], v[92:95], v[108:111], v[32:47]
  s_waitcnt lgkmcnt(3)
  v_mfma_f32_32x32x16_bf16 v[32:47], v[96:99], v[112:115], v[32:47]
  s_waitcnt lgkmcnt(0)
  v_mfma_f32_32x32x16_bf16 v[32:47], v[100:103], v[116:119], v[32:47]
  s_waitcnt vmcnt(4)
  v_lshlrev_b32 v28, 16, v136
  v_and_b32 v29, 0xffff0000, v136
  v_fma_f32 v28, v28, v25, v24
  v_fma_f32 v29, v29, v25, v24
  v_cvt_pk_bf16_f32 v136, v28, v29
  v_lshlrev_b32 v28, 16, v137
  v_and_b32 v29, 0xffff0000, v137
  v_fma_f32 v28, v28, v25, v24
  v_fma_f32 v29, v29, v25, v24
  v_cvt_pk_bf16_f32 v137, v28, v29
  v_lshlrev_b32 v28, 16, v138
  v_and_b32 v29, 0xffff0000, v138
  v_fma_f32 v28, v28, v25, v24
  v_fma_f32 v29, v29, v25, v24
  v_cvt_pk_bf16_f32 v138, v28, v29
  v_lshlrev_b32 v28, 16, v139
  v_and_b32 v29, 0xffff0000, v139
  v_fma_f32 v28, v28, v25, v24
  v_fma_f32 v29, v29, v25, v24
  v_cvt_pk_bf16_f32 v139, v28, v29
  v_lshlrev_b32 v28, 16, v140
  v_and_b32 v29, 0xffff0000, v140
  v_fma_f32 v28, v28, v27, v26
  v_fma_f32 v29, v29, v27, v26
  v_cvt_pk_bf16_f32 v140, v28, v29
  v_lshlrev_b32 v28, 16, v141
  v_and_b32 v29, 0xffff0000, v141
  v_fma_f32 v28, v28, v27, v26
  v_fma_f32 v29, v29, v27, v26
  v_cvt_pk_bf16_f32 v141, v28, v29
  v_lshlrev_b32 v28, 16, v142
  v_and_b32 v29, 0xffff0000, v142
  v_fma_f32 v28, v28, v27, v26
  v_fma_f32 v29, v29, v27, v26
  v_cvt_pk_bf16_f32 v142, v28, v29
  v_lshlrev_b32 v28, 16, v143
  v_and_b32 v29, 0xffff0000, v143
  v_fma_f32 v28, v28, v27, v26
  v_fma_f32 v29, v29, v27, v26
  v_cvt_pk_bf16_f32 v143, v28, v29
  ds_write_b128 v10, v[136:139] offset:512
  ds_write_b128 v10, v[140:143] offset:5120
  ds_write_b128 v13, v[144:147] offset:9728
  ds_write_b128 v13, v[148:151] offset:14848
  s_waitcnt lgkmcnt(0)
  s_barrier
  ds_read_b128 v[88:91], v14 offset:512
  ds_read_b64_tr_b16 v[104:105], v15 offset:9728
  ds_read_b64_tr_b16 v[106:107], v15 offset:10368
  ds_read_b128 v[92:95], v14 offset:544
  ds_read_b64_tr_b16 v[108:109], v15 offset:12288
  ds_read_b64_tr_b16 v[110:111], v15 offset:12928
  ds_read_b128 v[96:99], v14 offset:576
  ds_read_b64_tr_b16 v[112:113], v15 offset:14848
  ds_read_b64_tr_b16 v[114:115], v15 offset:15488
  ds_read_b128 v[100:103], v14 offset:608
  ds_read_b64_tr_b16 v[116:117], v15 offset:17408
  ds_read_b64_tr_b16 v[118:119], v15 offset:18048
  s_waitcnt lgkmcnt(9)
  v_mfma_f32_32x32x16_bf16 v[32:47], v[88:91], v[104:107], v[32:47]
  s_waitcnt lgkmcnt(6)
  v_mfma_f32_32x32x16_bf16 v[32:47], v[92:95], v[108:111], v[32:47]
  s_waitcnt lgkmcnt(3)
  v_mfma_f32_32x32x16_bf16 v[32:47], v[96:99], v[112:115], v[32:47]
  s_waitcnt lgkmcnt(0)
  v_mfma_f32_32x32x16_bf16 v[32:47], v[100:103], v[116:119], v[32:47]
  s_waitcnt vmcnt(0)
  v_lshlrev_b32 v28, 16, v152
  v_and_b32 v29, 0xffff0000, v152
  v_fma_f32 v28, v28, v25, v24
  v_fma_f32 v29, v29, v25, v24
  v_cvt_pk_bf16_f32 v152, v28, v29
  v_lshlrev_b32 v28, 16, v153
  v_and_b32 v29, 0xffff0000, v153
  v_fma_f32 v28, v28, v25, v24
  v_fma_f32 v29, v29, v25, v24
  v_cvt_pk_bf16_f32 v153, v28, v29
  v_lshlrev_b32 v28, 16, v154
  v_and_b32 v29, 0xffff0000, v154
  v_fma_f32 v28, v28, v25, v24
  v_fma_f32 v29, v29, v25, v24
  v_cvt_pk_bf16_f32 v154, v28, v29
  v_lshlrev_b32 v28, 16, v155
  v_and_b32 v29, 0xffff0000, v155
  v_fma_f32 v28, v28, v25, v24
  v_fma_f32 v29, v29, v25, v24
  v_cvt_pk_bf16_f32 v155, v28, v29
  v_lshlrev_b32 v28, 16, v156
  v_and_b32 v29, 0xffff0000, v156
  v_fma_f32 v28, v28, v27, v26
  v_fma_f32 v29, v29, v27, v26
  v_cvt_pk_bf16_f32 v156, v28, v29
  v_lshlrev_b32 v28, 16, v157
  v_and_b32 v29, 0xffff0000, v157
  v_fma_f32 v28, v28, v27, v26
  v_fma_f32 v29, v29, v27, v26
  v_cvt_pk_bf16_f32 v157, v28, v29
  v_lshlrev_b32 v28, 16, v158
  v_and_b32 v29, 0xffff0000, v158
  v_fma_f32 v28, v28, v27, v26
  v_fma_f32 v29, v29, v27, v26
  v_cvt_pk_bf16_f32 v158, v28, v29
  v_lshlrev_b32 v28, 16, v159
  v_and_b32 v29, 0xffff0000, v159
  v_fma_f32 v28, v28, v27, v26
  v_fma_f32 v29, v29, v27, v26
  v_cvt_pk_bf16_f32 v159, v28, v29
  ds_write_b128 v10, v[152:155] offset:19968
  ds_write_b128 v10, v[156:159] offset:24576
  ds_write_b128 v13, v[160:163] offset:29184
  ds_write_b128 v13, v[164:167] offset:34304
  s_waitcnt lgkmcnt(0)
  s_barrier
  ds_read_b128 v[88:91], v14 offset:19968
  ds_read_b64_tr_b16 v[104:105], v15 offset:29184
  ds_read_b64_tr_b16 v[106:107], v15 offset:29824
  ds_read_b128 v[92:95], v14 offset:20000
  ds_read_b64_tr_b16 v[108:109], v15 offset:31744
  ds_read_b64_tr_b16 v[110:111], v15 offset:32384
  ds_read_b128 v[96:99], v14 offset:20032
  ds_read_b64_tr_b16 v[112:113], v15 offset:34304
  ds_read_b64_tr_b16 v[114:115], v15 offset:34944
  ds_read_b128 v[100:103], v14 offset:20064
  ds_read_b64_tr_b16 v[116:117], v15 offset:36864
  ds_read_b64_tr_b16 v[118:119], v15 offset:37504
  s_waitcnt lgkmcnt(9)
  v_mfma_f32_32x32x16_bf16 v[32:47], v[88:91], v[104:107], v[32:47]
  s_waitcnt lgkmcnt(6)
  v_mfma_f32_32x32x16_bf16 v[32:47], v[92:95], v[108:111], v[32:47]
  s_waitcnt lgkmcnt(3)
  v_mfma_f32_32x32x16_bf16 v[32:47], v[96:99], v[112:115], v[32:47]
  s_waitcnt lgkmcnt(0)
  v_mfma_f32_32x32x16_bf16 v[32:47], v[100:103], v[116:119], v[32:47]
  s_nop 15
  v_lshrrev_b32 v5, 1, v2
  v_and_b32 v6, 1, v2
  v_lshlrev_b32 v7, 5, v5
  v_lshl_add_u32 v7, v3, 2, v7
  v_add_u32 v7, s24, v7
  s_mov_b32 s28, 1024
  v_mul_lo_u32 v8, v7, s28
  v_lshl_add_u32 v9, v6, 5, v4
  v_add_u32 v9, s25, v9
  v_lshl_add_u32 v8, v9, 1, v8
  s_mov_b32 s28, 1052289595
  v_mul_f32 v32, s28, v32
  v_mul_f32 v33, s28, v33
  v_mul_f32 v34, s28, v34
  v_mul_f32 v35, s28, v35
  v_mul_f32 v36, s28, v36
  v_mul_f32 v37, s28, v37
  v_mul_f32 v38, s28, v38
  v_mul_f32 v39, s28, v39
  v_mul_f32 v40, s28, v40
  v_mul_f32 v41, s28, v41
  v_mul_f32 v42, s28, v42
  v_mul_f32 v43, s28, v43
  v_mul_f32 v44, s28, v44
  v_mul_f32 v45, s28, v45
  v_mul_f32 v46, s28, v46
  v_mul_f32 v47, s28, v47
  v_cvt_pk_bf16_f32 v32, v32, v32
  s_mov_b32 s29, 0
  buffer_store_short v32, v8, s[16:19], s29 offen
  v_cvt_pk_bf16_f32 v33, v33, v33
  s_mov_b32 s29, 1024
  buffer_store_short v33, v8, s[16:19], s29 offen
  v_cvt_pk_bf16_f32 v34, v34, v34
  s_mov_b32 s29, 2048
  buffer_store_short v34, v8, s[16:19], s29 offen
  v_cvt_pk_bf16_f32 v35, v35, v35
  s_mov_b32 s29, 3072
  buffer_store_short v35, v8, s[16:19], s29 offen
  v_cvt_pk_bf16_f32 v36, v36, v36
  s_mov_b32 s29, 8192
  buffer_store_short v36, v8, s[16:19], s29 offen
  v_cvt_pk_bf16_f32 v37, v37, v37
  s_mov_b32 s29, 9216
  buffer_store_short v37, v8, s[16:19], s29 offen
  v_cvt_pk_bf16_f32 v38, v38, v38
  s_mov_b32 s29, 10240
  buffer_store_short v38, v8, s[16:19], s29 offen
  v_cvt_pk_bf16_f32 v39, v39, v39
  s_mov_b32 s29, 11264
  buffer_store_short v39, v8, s[16:19], s29 offen
  v_cvt_pk_bf16_f32 v40, v40, v40
  s_mov_b32 s29, 16384
  buffer_store_short v40, v8, s[16:19], s29 offen
  v_cvt_pk_bf16_f32 v41, v41, v41
  s_mov_b32 s29, 17408
  buffer_store_short v41, v8, s[16:19], s29 offen
  v_cvt_pk_bf16_f32 v42, v42, v42
  s_mov_b32 s29, 18432
  buffer_store_short v42, v8, s[16:19], s29 offen
  v_cvt_pk_bf16_f32 v43, v43, v43
  s_mov_b32 s29, 19456
  buffer_store_short v43, v8, s[16:19], s29 offen
  v_cvt_pk_bf16_f32 v44, v44, v44
  s_mov_b32 s29, 24576
  buffer_store_short v44, v8, s[16:19], s29 offen
  v_cvt_pk_bf16_f32 v45, v45, v45
  s_mov_b32 s29, 25600
  buffer_store_short v45, v8, s[16:19], s29 offen
  v_cvt_pk_bf16_f32 v46, v46, v46
  s_mov_b32 s29, 26624
  buffer_store_short v46, v8, s[16:19], s29 offen
  v_cvt_pk_bf16_f32 v47, v47, v47
  s_mov_b32 s29, 27648
  buffer_store_short v47, v8, s[16:19], s29 offen
  s_endpgm
L_kvtile:
  s_load_dwordx2 s[4:5], s[0:1], 0
  s_load_dwordx2 s[8:9], s[0:1], 16
  s_load_dwordx2 s[12:13], s[0:1], 24
  s_load_dwordx2 s[16:17], s[0:1], 88
  s_waitcnt lgkmcnt(0)
  s_mov_b32 s6, 2097152
  s_mov_b32 s7, 0x00020000
  s_mov_b32 s10, 16384
  s_mov_b32 s11, 0x00020000
  s_mov_b32 s14, 16384
  s_mov_b32 s15, 0x00020000
  s_add_u32 s16, s16, 2097152
  s_addc_u32 s17, s17, 0
  s_mov_b32 s18, 131072
  s_mov_b32 s19, 0x00020000
  s_mov_b32 s26, 1024
  s_mov_b32 s27, 32
  v_and_b32 v1, 63, v0
  v_lshrrev_b32 v2, 6, v0
  v_lshrrev_b32 v3, 5, v1
  v_and_b32 v4, 31, v1
  v_lshrrev_b32 v5, 4, v1
  v_lshl_add_u32 v5, v2, 4, v5
  v_add_u32 v5, s24, v5
  v_mul_lo_u32 v5, v5, s26
  v_and_b32 v6, 15, v1
  v_lshl_add_u32 v5, v6, 4, v5
  s_mov_b32 s30, 0
  buffer_load_dwordx4 v[64:67], v5, s[4:7], s30 offen offset:0
  s_mov_b32 s30, 0
  buffer_load_dwordx4 v[68:71], v5, s[4:7], s30 offen offset:256
  s_mov_b32 s30, 0
  buffer_load_dwordx4 v[72:75], v5, s[4:7], s30 offen offset:512
  s_mov_b32 s30, 0
  buffer_load_dwordx4 v[76:79], v5, s[4:7], s30 offen offset:768
  s_mov_b32 s30, 4096
  buffer_load_dwordx4 v[80:83], v5, s[4:7], s30 offen offset:0
  s_mov_b32 s30, 4096
  buffer_load_dwordx4 v[84:87], v5, s[4:7], s30 offen offset:256
  s_mov_b32 s30, 4096
  buffer_load_dwordx4 v[88:91], v5, s[4:7], s30 offen offset:512
  s_mov_b32 s30, 4096
  buffer_load_dwordx4 v[92:95], v5, s[4:7], s30 offen offset:768
  s_mov_b32 s30, 8192
  buffer_load_dwordx4 v[96:99], v5, s[4:7], s30 offen offset:0
  s_mov_b32 s30, 8192
  buffer_load_dwordx4 v[100:103], v5, s[4:7], s30 offen offset:256
  s_mov_b32 s30, 8192
  buffer_load_dwordx4 v[104:107], v5, s[4:7], s30 offen offset:512
  s_mov_b32 s30, 8192
  buffer_load_dwordx4 v[108:111], v5, s[4:7], s30 offen offset:768
  s_mov_b32 s30, 12288
  buffer_load_dwordx4 v[112:115], v5, s[4:7], s30 offen offset:0
  s_mov_b32 s30, 12288
  buffer_load_dwordx4 v[116:119], v5, s[4:7], s30 offen offset:256
  s_mov_b32 s30, 12288
  buffer_load_dwordx4 v[120:123], v5, s[4:7], s30 offen offset:512
  s_mov_b32 s30, 12288
  buffer_load_dwordx4 v[124:127], v5, s[4:7], s30 offen offset:768
  s_mov_b32 s31, 0x3f803f80
  s_waitcnt vmcnt(0)
  v_dot2_f32_bf16 v8, v64, s31, 0
  v_dot2_f32_bf16 v9, v64, v64, 0
  v_dot2_f32_bf16 v8, v65, s31, v8
  v_dot2_f32_bf16 v9, v65, v65, v9
  v_dot2_f32_bf16 v8, v66, s31, v8
  v_dot2_f32_bf16 v9, v66, v66, v9
  v_dot2_f32_bf16 v8, v67, s31, v8
  v_dot2_f32_bf16 v9, v67, v67, v9
  v_dot2_f32_bf16 v8, v68, s31, v8
  v_dot2_f32_bf16 v9, v68, v68, v9
  v_dot2_f32_bf16 v8, v69, s31, v8
  v_dot2_f32_bf16 v9, v69, v69, v9
  v_dot2_f32_bf16 v8, v70, s31, v8
  v_dot2_f32_bf16 v9, v70, v70, v9
  v_dot2_f32_bf16 v8, v71, s31, v8
  v_dot2_f32_bf16 v9, v71, v71, v9
  v_dot2_f32_bf16 v8, v72, s31, v8
  v_dot2_f32_bf16 v9, v72, v72, v9
  v_dot2_f32_bf16 v8, v73, s31, v8
  v_dot2_f32_bf16 v9, v73, v73, v9
  v_dot2_f32_bf16 v8, v74, s31, v8
  v_dot2_f32_bf16 v9, v74, v74, v9
  v_dot2_f32_bf16 v8, v75, s31, v8
  v_dot2_f32_bf16 v9, v75, v75, v9
  v_dot2_f32_bf16 v8, v76, s31, v8
  v_dot2_f32_bf16 v9, v76, v76, v9
  v_dot2_f32_bf16 v8, v77, s31, v8
  v_dot2_f32_bf16 v9, v77, v77, v9
  v_dot2_f32_bf16 v8, v78, s31, v8
  v_dot2_f32_bf16 v9, v78, v78, v9
  v_dot2_f32_bf16 v8, v79, s31, v8
  v_dot2_f32_bf16 v9, v79, v79, v9
  v_dot2_f32_bf16 v10, v80, s31, 0
  v_dot2_f32_bf16 v11, v80, v80, 0
  v_dot2_f32_bf16 v10, v81, s31, v10
  v_dot2_f32_bf16 v11, v81, v81, v11
  v_dot2_f32_bf16 v10, v82, s31, v10
  v_dot2_f32_bf16 v11, v82, v82, v11
  v_dot2_f32_bf16 v10, v83, s31, v10
  v_dot2_f32_bf16 v11, v83, v83, v11
  v_dot2_f32_bf16 v10, v84, s31, v10
  v_dot2_f32_bf16 v11, v84, v84, v11
  v_dot2_f32_bf16 v10, v85, s31, v10
  v_dot2_f32_bf16 v11, v85, v85, v11
  v_dot2_f32_bf16 v10, v86, s31, v10
  v_dot2_f32_bf16 v11, v86, v86, v11
  v_dot2_f32_bf16 v10, v87, s31, v10
  v_dot2_f32_bf16 v11, v87, v87, v11
  v_dot2_f32_bf16 v10, v88, s31, v10
  v_dot2_f32_bf16 v11, v88, v88, v11
  v_dot2_f32_bf16 v10, v89, s31, v10
  v_dot2_f32_bf16 v11, v89, v89, v11
  v_dot2_f32_bf16 v10, v90, s31, v10
  v_dot2_f32_bf16 v11, v90, v90, v11
  v_dot2_f32_bf16 v10, v91, s31, v10
  v_dot2_f32_bf16 v11, v91, v91, v11
  v_dot2_f32_bf16 v10, v92, s31, v10
  v_dot2_f32_bf16 v11, v92, v92, v11
  v_dot2_f32_bf16 v10, v93, s31, v10
  v_dot2_f32_bf16 v11, v93, v93, v11
  v_dot2_f32_bf16 v10, v94, s31, v10
  v_dot2_f32_bf16 v11, v94, v94, v11
  v_dot2_f32_bf16 v10, v95, s31, v10
  v_dot2_f32_bf16 v11, v95, v95, v11
  v_dot2_f32_bf16 v12, v96, s31, 0
  v_dot2_f32_bf16 v13, v96, v96, 0
  v_dot2_f32_bf16 v12, v97, s31, v12
  v_dot2_f32_bf16 v13, v97, v97, v13
  v_dot2_f32_bf16 v12, v98, s31, v12
  v_dot2_f32_bf16 v13, v98, v98, v13
  v_dot2_f32_bf16 v12, v99, s31, v12
  v_dot2_f32_bf16 v13, v99, v99, v13
  v_dot2_f32_bf16 v12, v100, s31, v12
  v_dot2_f32_bf16 v13, v100, v100, v13
  v_dot2_f32_bf16 v12, v101, s31, v12
  v_dot2_f32_bf16 v13, v101, v101, v13
  v_dot2_f32_bf16 v12, v102, s31, v12
  v_dot2_f32_bf16 v13, v102, v102, v13
  v_dot2_f32_bf16 v12, v103, s31, v12
  v_dot2_f32_bf16 v13, v103, v103, v13
  v_dot2_f32_bf16 v12, v104, s31, v12
  v_dot2_f32_bf16 v13, v104, v104, v13
  v_dot2_f32_bf16 v12, v105, s31, v12
  v_dot2_f32_bf16 v13, v105, v105, v13
  v_dot2_f32_bf16 v12, v106, s31, v12
  v_dot2_f32_bf16 v13, v106, v106, v13
  v_dot2_f32_bf16 v12, v107, s31, v12
  v_dot2_f32_bf16 v13, v107, v107, v13
  v_dot2_f32_bf16 v12, v108, s31, v12
  v_dot2_f32_bf16 v13, v108, v108, v13
  v_dot2_f32_bf16 v12, v109, s31, v12
  v_dot2_f32_bf16 v13, v109, v109, v13
  v_dot2_f32_bf16 v12, v110, s31, v12
  v_dot2_f32_bf16 v13, v110, v110, v13
  v_dot2_f32_bf16 v12, v111, s31, v12
  v_dot2_f32_bf16 v13, v111, v111, v13
  v_dot2_f32_bf16 v14, v112, s31, 0
  v_dot2_f32_bf16 v15, v112, v112, 0
  v_dot2_f32_bf16 v14, v113, s31, v14
  v_dot2_f32_bf16 v15, v113, v113, v15
  v_dot2_f32_bf16 v14, v114, s31, v14
  v_dot2_f32_bf16 v15, v114, v114, v15
  v_dot2_f32_bf16 v14, v115, s31, v14
  v_dot2_f32_bf16 v15, v115, v115, v15
  v_dot2_f32_bf16 v14, v116, s31, v14
  v_dot2_f32_bf16 v15, v116, v116, v15
  v_dot2_f32_bf16 v14, v117, s31, v14
  v_dot2_f32_bf16 v15, v117, v117, v15
  v_dot2_f32_bf16 v14, v118, s31, v14
  v_dot2_f32_bf16 v15, v118, v118, v15
  v_dot2_f32_bf16 v14, v119, s31, v14
  v_dot2_f32_bf16 v15, v119, v119, v15
  v_dot2_f32_bf16 v14, v120, s31, v14
  v_dot2_f32_bf16 v15, v120, v120, v15
  v_dot2_f32_bf16 v14, v121, s31, v14
  v_dot2_f32_bf16 v15, v121, v121, v15
  v_dot2_f32_bf16 v14, v122, s31, v14
  v_dot2_f32_bf16 v15, v122, v122, v15
  v_dot2_f32_bf16 v14, v123, s31, v14
  v_dot2_f32_bf16 v15, v123, v123, v15
  v_dot2_f32_bf16 v14, v124, s31, v14
  v_dot2_f32_bf16 v15, v124, v124, v15
  v_dot2_f32_bf16 v14, v125, s31, v14
  v_dot2_f32_bf16 v15, v125, v125, v15
  v_dot2_f32_bf16 v14, v126, s31, v14
  v_dot2_f32_bf16 v15, v126, v126, v15
  v_dot2_f32_bf16 v14, v127, s31, v14
  v_dot2_f32_bf16 v15, v127, v127, v15
  v_add_f32_dpp v16, v8, v8 row_ror:1 row_mask:0xf bank_mask:0xf
  v_add_f32_dpp v17, v9, v9 row_ror:1 row_mask:0xf bank_mask:0xf
  v_add_f32_dpp v18, v10, v10 row_ror:1 row_mask:0xf bank_mask:0xf
  v_add_f32_dpp v19, v11, v11 row_ror:1 row_mask:0xf bank_mask:0xf
  v_add_f32_dpp v20, v12, v12 row_ror:1 row_mask:0xf bank_mask:0xf
  v_add_f32_dpp v21, v13, v13 row_ror:1 row_mask:0xf bank_mask:0xf
  v_add_f32_dpp v22, v14, v14 row_ror:1 row_mask:0xf bank_mask:0xf
  v_add_f32_dpp v23, v15, v15 row_ror:1 row_mask:0xf bank_mask:0xf
  v_mov_b32 v8, v16
  v_mov_b32 v9, v17
  v_mov_b32 v10, v18
  v_mov_b32 v11, v19
  v_mov_b32 v12, v20
  v_mov_b32 v13, v21
  v_mov_b32 v14, v22
  v_mov_b32 v15, v23
  v_add_f32_dpp v16, v8, v8 row_ror:2 row_mask:0xf bank_mask:0xf
  v_add_f32_dpp v17, v9, v9 row_ror:2 row_mask:0xf bank_mask:0xf
  v_add_f32_dpp v18, v10, v10 row_ror:2 row_mask:0xf bank_mask:0xf
  v_add_f32_dpp v19, v11, v11 row_ror:2 row_mask:0xf bank_mask:0xf
  v_add_f32_dpp v20, v12, v12 row_ror:2 row_mask:0xf bank_mask:0xf
  v_add_f32_dpp v21, v13, v13 row_ror:2 row_mask:0xf bank_mask:0xf
  v_add_f32_dpp v22, v14, v14 row_ror:2 row_mask:0xf bank_mask:0xf
  v_add_f32_dpp v23, v15, v15 row_ror:2 row_mask:0xf bank_mask:0xf
  v_mov_b32 v8, v16
  v_mov_b32 v9, v17
  v_mov_b32 v10, v18
  v_mov_b32 v11, v19
  v_mov_b32 v12, v20
  v_mov_b32 v13, v21
  v_mov_b32 v14, v22
  v_mov_b32 v15, v23
  v_add_f32_dpp v16, v8, v8 row_ror:4 row_mask:0xf bank_mask:0xf
  v_add_f32_dpp v17, v9, v9 row_ror:4 row_mask:0xf bank_mask:0xf
  v_add_f32_dpp v18, v10, v10 row_ror:4 row_mask:0xf bank_mask:0xf
  v_add_f32_dpp v19, v11, v11 row_ror:4 row_mask:0xf bank_mask:0xf
  v_add_f32_dpp v20, v12, v12 row_ror:4 row_mask:0xf bank_mask:0xf
  v_add_f32_dpp v21, v13, v13 row_ror:4 row_mask:0xf bank_mask:0xf
  v_add_f32_dpp v22, v14, v14 row_ror:4 row_mask:0xf bank_mask:0xf
  v_add_f32_dpp v23, v15, v15 row_ror:4 row_mask:0xf bank_mask:0xf
  v_mov_b32 v8, v16
  v_mov_b32 v9, v17
  v_mov_b32 v10, v18
  v_mov_b32 v11, v19
  v_mov_b32 v12, v20
  v_mov_b32 v13, v21
  v_mov_b32 v14, v22
  v_mov_b32 v15, v23
  v_add_f32_dpp v16, v8, v8 row_ror:8 row_mask:0xf bank_mask:0xf
  v_add_f32_dpp v17, v9, v9 row_ror:8 row_mask:0xf bank_mask:0xf
  v_add_f32_dpp v18, v10, v10 row_ror:8 row_mask:0xf bank_mask:0xf
  v_add_f32_dpp v19, v11, v11 row_ror:8 row_mask:0xf bank_mask:0xf
  v_add_f32_dpp v20, v12, v12 row_ror:8 row_mask:0xf bank_mask:0xf
  v_add_f32_dpp v21, v13, v13 row_ror:8 row_mask:0xf bank_mask:0xf
  v_add_f32_dpp v22, v14, v14 row_ror:8 row_mask:0xf bank_mask:0xf
  v_add_f32_dpp v23, v15, v15 row_ror:8 row_mask:0xf bank_mask:0xf
  v_mov_b32 v8, v16
  v_mov_b32 v9, v17
  v_mov_b32 v10, v18
  v_mov_b32 v11, v19
  v_mov_b32 v12, v20
  v_mov_b32 v13, v21
  v_mov_b32 v14, v22
  v_mov_b32 v15, v23
  s_mov_b32 s31, 989855744
  s_mov_b32 s30, 925353388
  v_lshrrev_b32 v6, 4, v1
  v_lshl_add_u32 v6, v2, 4, v6
  v_lshlrev_b32 v6, 3, v6
  v_mul_f32 v8, s31, v8
  v_mul_f32 v9, s31, v9
  v_fma_f32 v9, -v8, v8, v9
  v_max_f32 v9, 0, v9
  v_add_f32 v9, s30, v9
  v_rsq_f32 v9, v9
  s_nop 0
  v_mul_f32 v8, v8, v9
  v_sub_f32 v8, 0, v8
  ds_write_b64 v6, v[8:9] offset:0
  v_mul_f32 v10, s31, v10
  v_mul_f32 v11, s31, v11
  v_fma_f32 v11, -v10, v10, v11
  v_max_f32 v11, 0, v11
  v_add_f32 v11, s30, v11
  v_rsq_f32 v11, v11
  s_nop 0
  v_mul_f32 v10, v10, v11
  v_sub_f32 v10, 0, v10
  ds_write_b64 v6, v[10:11] offset:32
  v_mul_f32 v12, s31, v12
  v_mul_f32 v13, s31, v13
  v_fma_f32 v13, -v12, v12, v13
  v_max_f32 v13, 0, v13
  v_add_f32 v13, s30, v13
  v_rsq_f32 v13, v13
  s_nop 0
  v_mul_f32 v12, v12, v13
  v_sub_f32 v12, 0, v12
  ds_write_b64 v6, v[12:13] offset:64
  v_mul_f32 v14, s31, v14
  v_mul_f32 v15, s31, v15
  v_fma_f32 v15, -v14, v14, v15
  v_max_f32 v15, 0, v15
  v_add_f32 v15, s30, v15
  v_rsq_f32 v15, v15
  s_nop 0
  v_mul_f32 v14, v14, v15
  v_sub_f32 v14, 0, v14
  ds_write_b64 v6, v[14:15] offset:96
  s_waitcnt lgkmcnt(0)
  s_barrier
  v_lshrrev_b32 v6, 3, v0
  v_lshlrev_b32 v6, 3, v6
  ds_read_b64 v[24:25], v6 offset:0
  ds_read_b64 v[26:27], v6 offset:256
  v_lshrrev_b32 v5, 3, v0
  v_and_b32 v6, 7, v0
  v_add_u32 v7, s24, v5
  v_mul_lo_u32 v7, v7, s26
  v_lshl_add_u32 v8, v6, 4, v7
  v_add_u32 v9, 32768, v8
  v_mul_u32_u24 v10, 144, v5
  v_lshl_add_u32 v10, v6, 4, v10
  v_lshrrev_b32 v5, 2, v0
  v_and_b32 v6, 3, v0
  v_lshlrev_b32 v7, 5, v5
  v_and_b32 v14, 1, v6
  v_lshl_add_u32 v7, v14, 4, v7
  v_mov_b32 v14, 0xfffffff0
  v_cmp_gt_u32 vcc, 2, v6
  s_nop 1
  v_cndmask_b32 v11, v14, v7, vcc
  v_cndmask_b32 v12, v7, v14, vcc
  v_mul_u32_u24 v13, 160, v5
  v_lshl_add_u32 v13, v6, 4, v13
  v_lshrrev_b32 v5, 1, v2
  v_and_b32 v6, 1, v2
  v_lshl_add_u32 v7, v5, 5, v4
  v_mul_u32_u24 v14, 144, v7
  v_lshl_add_u32 v14, v3, 4, v14
  v_and_b32 v7, 15, v1
  v_lshrrev_b32 v7, 2, v7
  v_lshl_add_u32 v7, v3, 3, v7
  v_mul_u32_u24 v15, 160, v7
  v_lshl_add_u32 v15, v6, 6, v15
  v_lshrrev_b32 v7, 4, v1
  v_and_b32 v7, 1, v7
  v_lshl_add_u32 v15, v7, 5, v15
  v_and_b32 v7, 3, v1
  v_lshl_add_u32 v15, v7, 3, v15
  s_waitcnt lgkmcnt(0)
  buffer_load_dwordx4 v[136:139], v8, s[4:7], 0 offen offset:0
  buffer_load_dwordx4 v[140:143], v9, s[4:7], 0 offen offset:0
  s_mov_b32 s29, 0
  buffer_load_dwordx4 v[144:147], v11, s[8:11], s29 offen
  buffer_load_dwordx4 v[148:151], v12, s[12:15], s29 offen
  buffer_load_dwordx4 v[156:159], v8, s[4:7], 0 offen offset:128
  buffer_load_dwordx4 v[160:163], v9, s[4:7], 0 offen offset:128
  s_mov_b32 s29, 2048
  buffer_load_dwordx4 v[164:167], v11, s[8:11], s29 offen
  buffer_load_dwordx4 v[168:171], v12, s[12:15], s29 offen
  buffer_load_dwordx4 v[176:179], v8, s[4:7], 0 offen offset:256
  buffer_load_dwordx4 v[180:183], v9, s[4:7], 0 offen offset:256
  s_mov_b32 s29, 4096
  buffer_load_dwordx4 v[184:187], v11, s[8:11], s29 offen
  buffer_load_dwordx4 v[188:191], v12, s[12:15], s29 offen
  s_waitcnt vmcnt(8)
  v_lshlrev_b32 v28, 16, v136
  v_and_b32 v29, 0xffff0000, v136
  v_fma_f32 v28, v28, v25, v24
  v_fma_f32 v29, v29, v25, v24
  v_cvt_pk_bf16_f32 v136, v28, v29
  v_lshlrev_b32 v28, 16, v137
  v_and_b32 v29, 0xffff0000, v137
  v_fma_f32 v28, v28, v25, v24
  v_fma_f32 v29, v29, v25, v24
  v_cvt_pk_bf16_f32 v137, v28, v29
  v_lshlrev_b32 v28, 16, v138
  v_and_b32 v29, 0xffff0000, v138
  v_fma_f32 v28, v28, v25, v24
  v_fma_f32 v29, v29, v25, v24
  v_cvt_pk_bf16_f32 v138, v28, v29
  v_lshlrev_b32 v28, 16, v139
  v_and_b32 v29, 0xffff0000, v139
  v_fma_f32 v28, v28, v25, v24
  v_fma_f32 v29, v29, v25, v24
  v_cvt_pk_bf16_f32 v139, v28, v29
  v_lshlrev_b32 v28, 16, v140
  v_and_b32 v29, 0xffff0000, v140
  v_fma_f32 v28, v28, v27, v26
  v_fma_f32 v29, v29, v27, v26
  v_cvt_pk_bf16_f32 v140, v28, v29
  v_lshlrev_b32 v28, 16, v141
  v_and_b32 v29, 0xffff0000, v141
  v_fma_f32 v28, v28, v27, v26
  v_fma_f32 v29, v29, v27, v26
  v_cvt_pk_bf16_f32 v141, v28, v29
  v_lshlrev_b32 v28, 16, v142
  v_and_b32 v29, 0xffff0000, v142
  v_fma_f32 v28, v28, v27, v26
  v_fma_f32 v29, v29, v27, v26
  v_cvt_pk_bf16_f32 v142, v28, v29
  v_lshlrev_b32 v28, 16, v143
  v_and_b32 v29, 0xffff0000, v143
  v_fma_f32 v28, v28, v27, v26
  v_fma_f32 v29, v29, v27, v26
  v_cvt_pk_bf16_f32 v143, v28, v29
  ds_write_b128 v10, v[136:139] offset:512
  ds_write_b128 v10, v[140:143] offset:5120
  v_or_b32 v144, v144, v148
  v_or_b32 v145, v145, v149
  v_or_b32 v146, v146, v150
  v_or_b32 v147, v147, v151
  ds_write_b128 v13, v[144:147] offset:9728
  s_waitcnt lgkmcnt(0)
  s_barrier
  buffer_load_dwordx4 v[136:139], v8, s[4:7], 0 offen offset:384
  buffer_load_dwordx4 v[140:143], v9, s[4:7], 0 offen offset:384
  s_mov_b32 s29, 6144
  buffer_load_dwordx4 v[144:147], v11, s[8:11], s29 offen
  buffer_load_dwordx4 v[148:151], v12, s[12:15], s29 offen
  ds_read_b128 v[88:91], v14 offset:512
  ds_read_b64_tr_b16 v[104:105], v15 offset:9728
  ds_read_b64_tr_b16 v[106:107], v15 offset:10368
  ds_read_b128 v[92:95], v14 offset:544
  ds_read_b64_tr_b16 v[108:109], v15 offset:12288
  ds_read_b64_tr_b16 v[110:111], v15 offset:12928
  ds_read_b128 v[96:99], v14 offset:576
  ds_read_b64_tr_b16 v[112:113], v15 offset:14848
  ds_read_b64_tr_b16 v[114:115], v15 offset:15488
  ds_read_b128 v[100:103], v14 offset:608
  ds_read_b64_tr_b16 v[116:117], v15 offset:17408
  ds_read_b64_tr_b16 v[118:119], v15 offset:18048
  s_waitcnt lgkmcnt(9)
  v_mfma_f32_32x32x16_bf16 v[32:47], v[88:91], v[104:107], 0
  s_waitcnt lgkmcnt(6)
  v_mfma_f32_32x32x16_bf16 v[32:47], v[92:95], v[108:111], v[32:47]
  s_waitcnt lgkmcnt(3)
  v_mfma_f32_32x32x16_bf16 v[32:47], v[96:99], v[112:115], v[32:47]
  s_waitcnt lgkmcnt(0)
  v_mfma_f32_32x32x16_bf16 v[32:47], v[100:103], v[116:119], v[32:47]
  s_waitcnt vmcnt(8)
  v_lshlrev_b32 v28, 16, v156
  v_and_b32 v29, 0xffff0000, v156
  v_fma_f32 v28, v28, v25, v24
  v_fma_f32 v29, v29, v25, v24
  v_cvt_pk_bf16_f32 v156, v28, v29
  v_lshlrev_b32 v28, 16, v157
  v_and_b32 v29, 0xffff0000, v157
  v_fma_f32 v28, v28, v25, v24
  v_fma_f32 v29, v29, v25, v24
  v_cvt_pk_bf16_f32 v157, v28, v29
  v_lshlrev_b32 v28, 16, v158
  v_and_b32 v29, 0xffff0000, v158
  v_fma_f32 v28, v28, v25, v24
  v_fma_f32 v29, v29, v25, v24
  v_cvt_pk_bf16_f32 v158, v28, v29
  v_lshlrev_b32 v28, 16, v159
  v_and_b32 v29, 0xffff0000, v159
  v_fma_f32 v28, v28, v25, v24
  v_fma_f32 v29, v29, v25, v24
  v_cvt_pk_bf16_f32 v159, v28, v29
  v_lshlrev_b32 v28, 16, v160
  v_and_b32 v29, 0xffff0000, v160
  v_fma_f32 v28, v28, v27, v26
  v_fma_f32 v29, v29, v27, v26
  v_cvt_pk_bf16_f32 v160, v28, v29
  v_lshlrev_b32 v28, 16, v161
  v_and_b32 v29, 0xffff0000, v161
  v_fma_f32 v28, v28, v27, v26
  v_fma_f32 v29, v29, v27, v26
  v_cvt_pk_bf16_f32 v161, v28, v29
  v_lshlrev_b32 v28, 16, v162
  v_and_b32 v29, 0xffff0000, v162
  v_fma_f32 v28, v28, v27, v26
  v_fma_f32 v29, v29, v27, v26
  v_cvt_pk_bf16_f32 v162, v28, v29
  v_lshlrev_b32 v28, 16, v163
  v_and_b32 v29, 0xffff0000, v163
  v_fma_f32 v28, v28, v27, v26
  v_fma_f32 v29, v29, v27, v26
  v_cvt_pk_bf16_f32 v163, v28, v29
  ds_write_b128 v10, v[156:159] offset:19968
  ds_write_b128 v10, v[160:163] offset:24576
  v_or_b32 v164, v164, v168
  v_or_b32 v165, v165, v169
  v_or_b32 v166, v166, v170
  v_or_b32 v167, v167, v171
  ds_write_b128 v13, v[164:167] offset:29184
  s_waitcnt lgkmcnt(0)
  s_barrier
  buffer_load_dwordx4 v[156:159], v8, s[4:7], 0 offen offset:512
  buffer_load_dwordx4 v[160:163], v9, s[4:7], 0 offen offset:512
  s_mov_b32 s29, 8192
  buffer_load_dwordx4 v[164:167], v11, s[8:11], s29 offen
  buffer_load_dwordx4 v[168:171], v12, s[12:15], s29 offen
  ds_read_b128 v[88:91], v14 offset:19968
  ds_read_b64_tr_b16 v[104:105], v15 offset:29184
  ds_read_b64_tr_b16 v[106:107], v15 offset:29824
  ds_read_b128 v[92:95], v14 offset:20000
  ds_read_b64_tr_b16 v[108:109], v15 offset:31744
  ds_read_b64_tr_b16 v[110:111], v15 offset:32384
  ds_read_b128 v[96:99], v14 offset:20032
  ds_read_b64_tr_b16 v[112:113], v15 offset:34304
  ds_read_b64_tr_b16 v[114:115], v15 offset:34944
  ds_read_b128 v[100:103], v14 offset:20064
  ds_read_b64_tr_b16 v[116:117], v15 offset:36864
  ds_read_b64_tr_b16 v[118:119], v15 offset:37504
  s_waitcnt lgkmcnt(9)
  v_mfma_f32_32x32x16_bf16 v[32:47], v[88:91], v[104:107], v[32:47]
  s_waitcnt lgkmcnt(6)
  v_mfma_f32_32x32x16_bf16 v[32:47], v[92:95], v[108:111], v[32:47]
  s_waitcnt lgkmcnt(3)
  v_mfma_f32_32x32x16_bf16 v[32:47], v[96:99], v[112:115], v[32:47]
  s_waitcnt lgkmcnt(0)
  v_mfma_f32_32x32x16_bf16 v[32:47], v[100:103], v[116:119], v[32:47]
  s_waitcnt vmcnt(8)
  v_lshlrev_b32 v28, 16, v176
  v_and_b32 v29, 0xffff0000, v176
  v_fma_f32 v28, v28, v25, v24
  v_fma_f32 v29, v29, v25, v24
  v_cvt_pk_bf16_f32 v176, v28, v29
  v_lshlrev_b32 v28, 16, v177
  v_and_b32 v29, 0xffff0000, v177
  v_fma_f32 v28, v28, v25, v24
  v_fma_f32 v29, v29, v25, v24
  v_cvt_pk_bf16_f32 v177, v28, v29
  v_lshlrev_b32 v28, 16, v178
  v_and_b32 v29, 0xffff0000, v178
  v_fma_f32 v28, v28, v25, v24
  v_fma_f32 v29, v29, v25, v24
  v_cvt_pk_bf16_f32 v178, v28, v29
  v_lshlrev_b32 v28, 16, v179
  v_and_b32 v29, 0xffff0000, v179
  v_fma_f32 v28, v28, v25, v24
  v_fma_f32 v29, v29, v25, v24
  v_cvt_pk_bf16_f32 v179, v28, v29
  v_lshlrev_b32 v28, 16, v180
  v_and_b32 v29, 0xffff0000, v180
  v_fma_f32 v28, v28, v27, v26
  v_fma_f32 v29, v29, v27, v26
  v_cvt_pk_bf16_f32 v180, v28, v29
  v_lshlrev_b32 v28, 16, v181
  v_and_b32 v29, 0xffff0000, v181
  v_fma_f32 v28, v28, v27, v26
  v_fma_f32 v29, v29, v27, v26
  v_cvt_pk_bf16_f32 v181, v28, v29
  v_lshlrev_b32 v28, 16, v182
  v_and_b32 v29, 0xffff0000, v182
  v_fma_f32 v28, v28, v27, v26
  v_fma_f32 v29, v29, v27, v26
  v_cvt_pk_bf16_f32 v182, v28, v29
  v_lshlrev_b32 v28, 16, v183
  v_and_b32 v29, 0xffff0000, v183
  v_fma_f32 v28, v28, v27, v26
  v_fma_f32 v29, v29, v27, v26
  v_cvt_pk_bf16_f32 v183, v28, v29
  ds_write_b128 v10, v[176:179] offset:512
  ds_write_b128 v10, v[180:183] offset:5120
  v_or_b32 v184, v184, v188
  v_or_b32 v185, v185, v189
  v_or_b32 v186, v186, v190
  v_or_b32 v187, v187, v191
  ds_write_b128 v13, v[184:187] offset:9728
  s_waitcnt lgkmcnt(0)
  s_barrier
  buffer_load_dwordx4 v[176:179], v8, s[4:7], 0 offen offset:640
  buffer_load_dwordx4 v[180:183], v9, s[4:7], 0 offen offset:640
  s_mov_b32 s29, 10240
  buffer_load_dwordx4 v[184:187], v11, s[8:11], s29 offen
  buffer_load_dwordx4 v[188:191], v12, s[12:15], s29 offen
  ds_read_b128 v[88:91], v14 offset:512
  ds_read_b64_tr_b16 v[104:105], v15 offset:9728
  ds_read_b64_tr_b16 v[106:107], v15 offset:10368
  ds_read_b128 v[92:95], v14 offset:544
  ds_read_b64_tr_b16 v[108:109], v15 offset:12288
  ds_read_b64_tr_b16 v[110:111], v15 offset:12928
  ds_read_b128 v[96:99], v14 offset:576
  ds_read_b64_tr_b16 v[112:113], v15 offset:14848
  ds_read_b64_tr_b16 v[114:115], v15 offset:15488
  ds_read_b128 v[100:103], v14 offset:608
  ds_read_b64_tr_b16 v[116:117], v15 offset:17408
  ds_read_b64_tr_b16 v[118:119], v15 offset:18048
  s_waitcnt lgkmcnt(9)
  v_mfma_f32_32x32x16_bf16 v[32:47], v[88:91], v[104:107], v[32:47]
  s_waitcnt lgkmcnt(6)
  v_mfma_f32_32x32x16_bf16 v[32:47], v[92:95], v[108:111], v[32:47]
  s_waitcnt lgkmcnt(3)
  v_mfma_f32_32x32x16_bf16 v[32:47], v[96:99], v[112:115], v[32:47]
  s_waitcnt lgkmcnt(0)
  v_mfma_f32_32x32x16_bf16 v[32:47], v[100:103], v[116:119], v[32:47]
  s_waitcnt vmcnt(8)
  v_lshlrev_b32 v28, 16, v136
  v_and_b32 v29, 0xffff0000, v136
  v_fma_f32 v28, v28, v25, v24
  v_fma_f32 v29, v29, v25, v24
  v_cvt_pk_bf16_f32 v136, v28, v29
  v_lshlrev_b32 v28, 16, v137
  v_and_b32 v29, 0xffff0000, v137
  v_fma_f32 v28, v28, v25, v24
  v_fma_f32 v29, v29, v25, v24
  v_cvt_pk_bf16_f32 v137, v28, v29
  v_lshlrev_b32 v28, 16, v138
  v_and_b32 v29, 0xffff0000, v138
  v_fma_f32 v28, v28, v25, v24
  v_fma_f32 v29, v29, v25, v24
  v_cvt_pk_bf16_f32 v138, v28, v29
  v_lshlrev_b32 v28, 16, v139
  v_and_b32 v29, 0xffff0000, v139
  v_fma_f32 v28, v28, v25, v24
  v_fma_f32 v29, v29, v25, v24
  v_cvt_pk_bf16_f32 v139, v28, v29
  v_lshlrev_b32 v28, 16, v140
  v_and_b32 v29, 0xffff0000, v140
  v_fma_f32 v28, v28, v27, v26
  v_fma_f32 v29, v29, v27, v26
  v_cvt_pk_bf16_f32 v140, v28, v29
  v_lshlrev_b32 v28, 16, v141
  v_and_b32 v29, 0xffff0000, v141
  v_fma_f32 v28, v28, v27, v26
  v_fma_f32 v29, v29, v27, v26
  v_cvt_pk_bf16_f32 v141, v28, v29
  v_lshlrev_b32 v28, 16, v142
  v_and_b32 v29, 0xffff0000, v142
  v_fma_f32 v28, v28, v27, v26
  v_fma_f32 v29, v29, v27, v26
  v_cvt_pk_bf16_f32 v142, v28, v29
  v_lshlrev_b32 v28, 16, v143
  v_and_b32 v29, 0xffff0000, v143
  v_fma_f32 v28, v28, v27, v26
  v_fma_f32 v29, v29, v27, v26
  v_cvt_pk_bf16_f32 v143, v28, v29
  ds_write_b128 v10, v[136:139] offset:19968
  ds_write_b128 v10, v[140:143] offset:24576
  v_or_b32 v144, v144, v148
  v_or_b32 v145, v145, v149
  v_or_b32 v146, v146, v150
  v_or_b32 v147, v147, v151
  ds_write_b128 v13, v[144:147] offset:29184
  s_waitcnt lgkmcnt(0)
  s_barrier
  buffer_load_dwordx4 v[136:139], v8, s[4:7], 0 offen offset:768
  buffer_load_dwordx4 v[140:143], v9, s[4:7], 0 offen offset:768
  s_mov_b32 s29, 12288
  buffer_load_dwordx4 v[144:147], v11, s[8:11], s29 offen
  buffer_load_dwordx4 v[148:151], v12, s[12:15], s29 offen
  ds_read_b128 v[88:91], v14 offset:19968
  ds_read_b64_tr_b16 v[104:105], v15 offset:29184
  ds_read_b64_tr_b16 v[106:107], v15 offset:29824
  ds_read_b128 v[92:95], v14 offset:20000
  ds_read_b64_tr_b16 v[108:109], v15 offset:31744
  ds_read_b64_tr_b16 v[110:111], v15 offset:32384
  ds_read_b128 v[96:99], v14 offset:20032
  ds_read_b64_tr_b16 v[112:113], v15 offset:34304
  ds_read_b64_tr_b16 v[114:115], v15 offset:34944
  ds_read_b128 v[100:103], v14 offset:20064
  ds_read_b64_tr_b16 v[116:117], v15 offset:36864
  ds_read_b64_tr_b16 v[118:119], v15 offset:37504
  s_waitcnt lgkmcnt(9)
  v_mfma_f32_32x32x16_bf16 v[32:47], v[88:91], v[104:107], v[32:47]
  s_waitcnt lgkmcnt(6)
  v_mfma_f32_32x32x16_bf16 v[32:47], v[92:95], v[108:111], v[32:47]
  s_waitcnt lgkmcnt(3)
  v_mfma_f32_32x32x16_bf16 v[32:47], v[96:99], v[112:115], v[32:47]
  s_waitcnt lgkmcnt(0)
  v_mfma_f32_32x32x16_bf16 v[32:47], v[100:103], v[116:119], v[32:47]
  s_waitcnt vmcnt(8)
  v_lshlrev_b32 v28, 16, v156
  v_and_b32 v29, 0xffff0000, v156
  v_fma_f32 v28, v28, v25, v24
  v_fma_f32 v29, v29, v25, v24
  v_cvt_pk_bf16_f32 v156, v28, v29
  v_lshlrev_b32 v28, 16, v157
  v_and_b32 v29, 0xffff0000, v157
  v_fma_f32 v28, v28, v25, v24
  v_fma_f32 v29, v29, v25, v24
  v_cvt_pk_bf16_f32 v157, v28, v29
  v_lshlrev_b32 v28, 16, v158
  v_and_b32 v29, 0xffff0000, v158
  v_fma_f32 v28, v28, v25, v24
  v_fma_f32 v29, v29, v25, v24
  v_cvt_pk_bf16_f32 v158, v28, v29
  v_lshlrev_b32 v28, 16, v159
  v_and_b32 v29, 0xffff0000, v159
  v_fma_f32 v28, v28, v25, v24
  v_fma_f32 v29, v29, v25, v24
  v_cvt_pk_bf16_f32 v159, v28, v29
  v_lshlrev_b32 v28, 16, v160
  v_and_b32 v29, 0xffff0000, v160
  v_fma_f32 v28, v28, v27, v26
  v_fma_f32 v29, v29, v27, v26
  v_cvt_pk_bf16_f32 v160, v28, v29
  v_lshlrev_b32 v28, 16, v161
  v_and_b32 v29, 0xffff0000, v161
  v_fma_f32 v28, v28, v27, v26
  v_fma_f32 v29, v29, v27, v26
  v_cvt_pk_bf16_f32 v161, v28, v29
  v_lshlrev_b32 v28, 16, v162
  v_and_b32 v29, 0xffff0000, v162
  v_fma_f32 v28, v28, v27, v26
  v_fma_f32 v29, v29, v27, v26
  v_cvt_pk_bf16_f32 v162, v28, v29
  v_lshlrev_b32 v28, 16, v163
  v_and_b32 v29, 0xffff0000, v163
  v_fma_f32 v28, v28, v27, v26
  v_fma_f32 v29, v29, v27, v26
  v_cvt_pk_bf16_f32 v163, v28, v29
  ds_write_b128 v10, v[156:159] offset:512
  ds_write_b128 v10, v[160:163] offset:5120
  v_or_b32 v164, v164, v168
  v_or_b32 v165, v165, v169
  v_or_b32 v166, v166, v170
  v_or_b32 v167, v167, v171
  ds_write_b128 v13, v[164:167] offset:9728
  s_waitcnt lgkmcnt(0)
  s_barrier
  buffer_load_dwordx4 v[156:159], v8, s[4:7], 0 offen offset:896
  buffer_load_dwordx4 v[160:163], v9, s[4:7], 0 offen offset:896
  s_mov_b32 s29, 14336
  buffer_load_dwordx4 v[164:167], v11, s[8:11], s29 offen
  buffer_load_dwordx4 v[168:171], v12, s[12:15], s29 offen
  ds_read_b128 v[88:91], v14 offset:512
  ds_read_b64_tr_b16 v[104:105], v15 offset:9728
  ds_read_b64_tr_b16 v[106:107], v15 offset:10368
  ds_read_b128 v[92:95], v14 offset:544
  ds_read_b64_tr_b16 v[108:109], v15 offset:12288
  ds_read_b64_tr_b16 v[110:111], v15 offset:12928
  ds_read_b128 v[96:99], v14 offset:576
  ds_read_b64_tr_b16 v[112:113], v15 offset:14848
  ds_read_b64_tr_b16 v[114:115], v15 offset:15488
  ds_read_b128 v[100:103], v14 offset:608
  ds_read_b64_tr_b16 v[116:117], v15 offset:17408
  ds_read_b64_tr_b16 v[118:119], v15 offset:18048
  s_waitcnt lgkmcnt(9)
  v_mfma_f32_32x32x16_bf16 v[32:47], v[88:91], v[104:107], v[32:47]
  s_waitcnt lgkmcnt(6)
  v_mfma_f32_32x32x16_bf16 v[32:47], v[92:95], v[108:111], v[32:47]
  s_waitcnt lgkmcnt(3)
  v_mfma_f32_32x32x16_bf16 v[32:47], v[96:99], v[112:115], v[32:47]
  s_waitcnt lgkmcnt(0)
  v_mfma_f32_32x32x16_bf16 v[32:47], v[100:103], v[116:119], v[32:47]
  s_waitcnt vmcnt(8)
  v_lshlrev_b32 v28, 16, v176
  v_and_b32 v29, 0xffff0000, v176
  v_fma_f32 v28, v28, v25, v24
  v_fma_f32 v29, v29, v25, v24
  v_cvt_pk_bf16_f32 v176, v28, v29
  v_lshlrev_b32 v28, 16, v177
  v_and_b32 v29, 0xffff0000, v177
  v_fma_f32 v28, v28, v25, v24
  v_fma_f32 v29, v29, v25, v24
  v_cvt_pk_bf16_f32 v177, v28, v29
  v_lshlrev_b32 v28, 16, v178
  v_and_b32 v29, 0xffff0000, v178
  v_fma_f32 v28, v28, v25, v24
  v_fma_f32 v29, v29, v25, v24
  v_cvt_pk_bf16_f32 v178, v28, v29
  v_lshlrev_b32 v28, 16, v179
  v_and_b32 v29, 0xffff0000, v179
  v_fma_f32 v28, v28, v25, v24
  v_fma_f32 v29, v29, v25, v24
  v_cvt_pk_bf16_f32 v179, v28, v29
  v_lshlrev_b32 v28, 16, v180
  v_and_b32 v29, 0xffff0000, v180
  v_fma_f32 v28, v28, v27, v26
  v_fma_f32 v29, v29, v27, v26
  v_cvt_pk_bf16_f32 v180, v28, v29
  v_lshlrev_b32 v28, 16, v181
  v_and_b32 v29, 0xffff0000, v181
  v_fma_f32 v28, v28, v27, v26
  v_fma_f32 v29, v29, v27, v26
  v_cvt_pk_bf16_f32 v181, v28, v29
  v_lshlrev_b32 v28, 16, v182
  v_and_b32 v29, 0xffff0000, v182
  v_fma_f32 v28, v28, v27, v26
  v_fma_f32 v29, v29, v27, v26
  v_cvt_pk_bf16_f32 v182, v28, v29
  v_lshlrev_b32 v28, 16, v183
  v_and_b32 v29, 0xffff0000, v183
  v_fma_f32 v28, v28, v27, v26
  v_fma_f32 v29, v29, v27, v26
  v_cvt_pk_bf16_f32 v183, v28, v29
  ds_write_b128 v10, v[176:179] offset:19968
  ds_write_b128 v10, v[180:183] offset:24576
  v_or_b32 v184, v184, v188
  v_or_b32 v185, v185, v189
  v_or_b32 v186, v186, v190
  v_or_b32 v187, v187, v191
  ds_write_b128 v13, v[184:187] offset:29184
  s_waitcnt lgkmcnt(0)
  s_barrier
  ds_read_b128 v[88:91], v14 offset:19968
  ds_read_b64_tr_b16 v[104:105], v15 offset:29184
  ds_read_b64_tr_b16 v[106:107], v15 offset:29824
  ds_read_b128 v[92:95], v14 offset:20000
  ds_read_b64_tr_b16 v[108:109], v15 offset:31744
  ds_read_b64_tr_b16 v[110:111], v15 offset:32384
  ds_read_b128 v[96:99], v14 offset:20032
  ds_read_b64_tr_b16 v[112:113], v15 offset:34304
  ds_read_b64_tr_b16 v[114:115], v15 offset:34944
  ds_read_b128 v[100:103], v14 offset:20064
  ds_read_b64_tr_b16 v[116:117], v15 offset:36864
  ds_read_b64_tr_b16 v[118:119], v15 offset:37504
  s_waitcnt lgkmcnt(9)
  v_mfma_f32_32x32x16_bf16 v[32:47], v[88:91], v[104:107], v[32:47]
  s_waitcnt lgkmcnt(6)
  v_mfma_f32_32x32x16_bf16 v[32:47], v[92:95], v[108:111], v[32:47]
  s_waitcnt lgkmcnt(3)
  v_mfma_f32_32x32x16_bf16 v[32:47], v[96:99], v[112:115], v[32:47]
  s_waitcnt lgkmcnt(0)
  v_mfma_f32_32x32x16_bf16 v[32:47], v[100:103], v[116:119], v[32:47]
  s_waitcnt vmcnt(4)
  v_lshlrev_b32 v28, 16, v136
  v_and_b32 v29, 0xffff0000, v136
  v_fma_f32 v28, v28, v25, v24
  v_fma_f32 v29, v29, v25, v24
  v_cvt_pk_bf16_f32 v136, v28, v29
  v_lshlrev_b32 v28, 16, v137
  v_and_b32 v29, 0xffff0000, v137
  v_fma_f32 v28, v28, v25, v24
  v_fma_f32 v29, v29, v25, v24
  v_cvt_pk_bf16_f32 v137, v28, v29
  v_lshlrev_b32 v28, 16, v138
  v_and_b32 v29, 0xffff0000, v138
  v_fma_f32 v28, v28, v25, v24
  v_fma_f32 v29, v29, v25, v24
  v_cvt_pk_bf16_f32 v138, v28, v29
  v_lshlrev_b32 v28, 16, v139
  v_and_b32 v29, 0xffff0000, v139
  v_fma_f32 v28, v28, v25, v24
  v_fma_f32 v29, v29, v25, v24
  v_cvt_pk_bf16_f32 v139, v28, v29
  v_lshlrev_b32 v28, 16, v140
  v_and_b32 v29, 0xffff0000, v140
  v_fma_f32 v28, v28, v27, v26
  v_fma_f32 v29, v29, v27, v26
  v_cvt_pk_bf16_f32 v140, v28, v29
  v_lshlrev_b32 v28, 16, v141
  v_and_b32 v29, 0xffff0000, v141
  v_fma_f32 v28, v28, v27, v26
  v_fma_f32 v29, v29, v27, v26
  v_cvt_pk_bf16_f32 v141, v28, v29
  v_lshlrev_b32 v28, 16, v142
  v_and_b32 v29, 0xffff0000, v142
  v_fma_f32 v28, v28, v27, v26
  v_fma_f32 v29, v29, v27, v26
  v_cvt_pk_bf16_f32 v142, v28, v29
  v_lshlrev_b32 v28, 16, v143
  v_and_b32 v29, 0xffff0000, v143
  v_fma_f32 v28, v28, v27, v26
  v_fma_f32 v29, v29, v27, v26
  v_cvt_pk_bf16_f32 v143, v28, v29
  ds_write_b128 v10, v[136:139] offset:512
  ds_write_b128 v10, v[140:143] offset:5120
  v_or_b32 v144, v144, v148
  v_or_b32 v145, v145, v149
  v_or_b32 v146, v146, v150
  v_or_b32 v147, v147, v151
  ds_write_b128 v13, v[144:147] offset:9728
  s_waitcnt lgkmcnt(0)
  s_barrier
  ds_read_b128 v[88:91], v14 offset:512
  ds_read_b64_tr_b16 v[104:105], v15 offset:9728
  ds_read_b64_tr_b16 v[106:107], v15 offset:10368
  ds_read_b128 v[92:95], v14 offset:544
  ds_read_b64_tr_b16 v[108:109], v15 offset:12288
  ds_read_b64_tr_b16 v[110:111], v15 offset:12928
  ds_read_b128 v[96:99], v14 offset:576
  ds_read_b64_tr_b16 v[112:113], v15 offset:14848
  ds_read_b64_tr_b16 v[114:115], v15 offset:15488
  ds_read_b128 v[100:103], v14 offset:608
  ds_read_b64_tr_b16 v[116:117], v15 offset:17408
  ds_read_b64_tr_b16 v[118:119], v15 offset:18048
  s_waitcnt lgkmcnt(9)
  v_mfma_f32_32x32x16_bf16 v[32:47], v[88:91], v[104:107], v[32:47]
  s_waitcnt lgkmcnt(6)
  v_mfma_f32_32x32x16_bf16 v[32:47], v[92:95], v[108:111], v[32:47]
  s_waitcnt lgkmcnt(3)
  v_mfma_f32_32x32x16_bf16 v[32:47], v[96:99], v[112:115], v[32:47]
  s_waitcnt lgkmcnt(0)
  v_mfma_f32_32x32x16_bf16 v[32:47], v[100:103], v[116:119], v[32:47]
  s_waitcnt vmcnt(0)
  v_lshlrev_b32 v28, 16, v156
  v_and_b32 v29, 0xffff0000, v156
  v_fma_f32 v28, v28, v25, v24
  v_fma_f32 v29, v29, v25, v24
  v_cvt_pk_bf16_f32 v156, v28, v29
  v_lshlrev_b32 v28, 16, v157
  v_and_b32 v29, 0xffff0000, v157
  v_fma_f32 v28, v28, v25, v24
  v_fma_f32 v29, v29, v25, v24
  v_cvt_pk_bf16_f32 v157, v28, v29
  v_lshlrev_b32 v28, 16, v158
  v_and_b32 v29, 0xffff0000, v158
  v_fma_f32 v28, v28, v25, v24
  v_fma_f32 v29, v29, v25, v24
  v_cvt_pk_bf16_f32 v158, v28, v29
  v_lshlrev_b32 v28, 16, v159
  v_and_b32 v29, 0xffff0000, v159
  v_fma_f32 v28, v28, v25, v24
  v_fma_f32 v29, v29, v25, v24
  v_cvt_pk_bf16_f32 v159, v28, v29
  v_lshlrev_b32 v28, 16, v160
  v_and_b32 v29, 0xffff0000, v160
  v_fma_f32 v28, v28, v27, v26
  v_fma_f32 v29, v29, v27, v26
  v_cvt_pk_bf16_f32 v160, v28, v29
  v_lshlrev_b32 v28, 16, v161
  v_and_b32 v29, 0xffff0000, v161
  v_fma_f32 v28, v28, v27, v26
  v_fma_f32 v29, v29, v27, v26
  v_cvt_pk_bf16_f32 v161, v28, v29
  v_lshlrev_b32 v28, 16, v162
  v_and_b32 v29, 0xffff0000, v162
  v_fma_f32 v28, v28, v27, v26
  v_fma_f32 v29, v29, v27, v26
  v_cvt_pk_bf16_f32 v162, v28, v29
  v_lshlrev_b32 v28, 16, v163
  v_and_b32 v29, 0xffff0000, v163
  v_fma_f32 v28, v28, v27, v26
  v_fma_f32 v29, v29, v27, v26
  v_cvt_pk_bf16_f32 v163, v28, v29
  ds_write_b128 v10, v[156:159] offset:19968
  ds_write_b128 v10, v[160:163] offset:24576
  v_or_b32 v164, v164, v168
  v_or_b32 v165, v165, v169
  v_or_b32 v166, v166, v170
  v_or_b32 v167, v167, v171
  ds_write_b128 v13, v[164:167] offset:29184
  s_waitcnt lgkmcnt(0)
  s_barrier
  ds_read_b128 v[88:91], v14 offset:19968
  ds_read_b64_tr_b16 v[104:105], v15 offset:29184
  ds_read_b64_tr_b16 v[106:107], v15 offset:29824
  ds_read_b128 v[92:95], v14 offset:20000
  ds_read_b64_tr_b16 v[108:109], v15 offset:31744
  ds_read_b64_tr_b16 v[110:111], v15 offset:32384
  ds_read_b128 v[96:99], v14 offset:20032
  ds_read_b64_tr_b16 v[112:113], v15 offset:34304
  ds_read_b64_tr_b16 v[114:115], v15 offset:34944
  ds_read_b128 v[100:103], v14 offset:20064
  ds_read_b64_tr_b16 v[116:117], v15 offset:36864
  ds_read_b64_tr_b16 v[118:119], v15 offset:37504
  s_waitcnt lgkmcnt(9)
  v_mfma_f32_32x32x16_bf16 v[32:47], v[88:91], v[104:107], v[32:47]
  s_waitcnt lgkmcnt(6)
  v_mfma_f32_32x32x16_bf16 v[32:47], v[92:95], v[108:111], v[32:47]
  s_waitcnt lgkmcnt(3)
  v_mfma_f32_32x32x16_bf16 v[32:47], v[96:99], v[112:115], v[32:47]
  s_waitcnt lgkmcnt(0)
  v_mfma_f32_32x32x16_bf16 v[32:47], v[100:103], v[116:119], v[32:47]
  s_nop 15
  v_lshrrev_b32 v5, 1, v2
  v_and_b32 v6, 1, v2
  v_lshlrev_b32 v7, 5, v5
  v_lshl_add_u32 v7, v3, 2, v7
  v_add_u32 v7, s24, v7
  v_cmp_eq_u32 vcc, 0, v6
  s_and_saveexec_b64 s[32:33], vcc
  s_cbranch_execz L_kv_done
  v_lshlrev_b32 v8, 5, v7
  v_and_b32 v9, 15, v1
  v_lshl_add_u32 v8, v9, 1, v8
  v_cvt_pk_bf16_f32 v64, v32, v32
  v_cvt_pk_bf16_f32 v65, v33, v33
  v_cvt_pk_bf16_f32 v66, v34, v34
  v_cvt_pk_bf16_f32 v67, v35, v35
  v_cvt_pk_bf16_f32 v68, v36, v36
  v_cvt_pk_bf16_f32 v69, v37, v37
  v_cvt_pk_bf16_f32 v70, v38, v38
  v_cvt_pk_bf16_f32 v71, v39, v39
  v_cvt_pk_bf16_f32 v72, v40, v40
  v_cvt_pk_bf16_f32 v73, v41, v41
  v_cvt_pk_bf16_f32 v74, v42, v42
  v_cvt_pk_bf16_f32 v75, v43, v43
  v_cvt_pk_bf16_f32 v76, v44, v44
  v_cvt_pk_bf16_f32 v77, v45, v45
  v_cvt_pk_bf16_f32 v78, v46, v46
  v_cvt_pk_bf16_f32 v79, v47, v47
  v_cmp_gt_u32 vcc, 16, v4
  s_and_saveexec_b64 s[34:35], vcc
  buffer_store_short v64, v8, s[16:19], 0 offen offset:0
  buffer_store_short v65, v8, s[16:19], 0 offen offset:32
  buffer_store_short v66, v8, s[16:19], 0 offen offset:64
  buffer_store_short v67, v8, s[16:19], 0 offen offset:96
  buffer_store_short v68, v8, s[16:19], 0 offen offset:256
  buffer_store_short v69, v8, s[16:19], 0 offen offset:288
  buffer_store_short v70, v8, s[16:19], 0 offen offset:320
  buffer_store_short v71, v8, s[16:19], 0 offen offset:352
  buffer_store_short v72, v8, s[16:19], 0 offen offset:512
  buffer_store_short v73, v8, s[16:19], 0 offen offset:544
  buffer_store_short v74, v8, s[16:19], 0 offen offset:576
  buffer_store_short v75, v8, s[16:19], 0 offen offset:608
  buffer_store_short v76, v8, s[16:19], 0 offen offset:768
  buffer_store_short v77, v8, s[16:19], 0 offen offset:800
  buffer_store_short v78, v8, s[16:19], 0 offen offset:832
  buffer_store_short v79, v8, s[16:19], 0 offen offset:864
  s_mov_b64 exec, s[34:35]
  v_lshrrev_b32 v8, 5, v7
  v_lshlrev_b32 v8, 2, v8
  v_add_u32 v8, v8, v3
  v_lshlrev_b32 v8, 4, v8
  v_add_u32 v8, v8, v9
  v_lshlrev_b32 v8, 4, v8
  v_cvt_pk_bf16_f32 v80, v32, v33
  v_cvt_pk_bf16_f32 v81, v34, v35
  v_cvt_pk_bf16_f32 v82, v36, v37
  v_cvt_pk_bf16_f32 v83, v38, v39
  v_cvt_pk_bf16_f32 v84, v40, v41
  v_cvt_pk_bf16_f32 v85, v42, v43
  v_cvt_pk_bf16_f32 v86, v44, v45
  v_cvt_pk_bf16_f32 v87, v46, v47
  v_cmp_le_u32 vcc, 16, v4
  s_and_saveexec_b64 s[34:35], vcc
  s_mov_b32 s29, 65536
  buffer_store_dwordx4 v[80:83], v8, s[16:19], s29 offen
  s_mov_b32 s29, 66048
  buffer_store_dwordx4 v[84:87], v8, s[16:19], s29 offen
  s_mov_b64 exec, s[34:35]
L_kv_done:
  s_mov_b64 exec, s[32:33]
L_qkv_kernel_end:
  s_endpgm
.p2align 8
.globl attn_kernel
.type attn_kernel,@function
attn_kernel:
  s_cmp_ge_u32 s2, 256
  s_cbranch_scc1 L_attn_kernel_end
  s_load_dwordx2 s[4:5], s[0:1], 88
  s_load_dwordx2 s[8:9], s[0:1], 88
  s_load_dwordx2 s[12:13], s[0:1], 88
  s_waitcnt lgkmcnt(0)
  s_mov_b32 s6, 2097152
  s_mov_b32 s7, 0x00020000
  s_add_u32 s8, s8, 2097152
  s_addc_u32 s9, s9, 0
  s_mov_b32 s10, 131072
  s_mov_b32 s11, 0x00020000
  s_add_u32 s12, s12, 3145728
  s_addc_u32 s13, s13, 0
  s_mov_b32 s14, 2097152
  s_mov_b32 s15, 0x00020000
  v_and_b32 v1, 63, v0
  v_lshrrev_b32 v2, 6, v0
  v_lshlrev_b32 v3, 4, v0
  s_mov_b32 s20, 0
  buffer_load_dwordx4 v[36:39], v3, s[8:11], s20 offen
  s_mov_b32 s20, 8192
  buffer_load_dwordx4 v[40:43], v3, s[8:11], s20 offen
  s_mov_b32 s20, 16384
  buffer_load_dwordx4 v[44:47], v3, s[8:11], s20 offen
  s_mov_b32 s20, 24576
  buffer_load_dwordx4 v[48:51], v3, s[8:11], s20 offen
  s_mov_b32 s20, 32768
  buffer_load_dwordx4 v[52:55], v3, s[8:11], s20 offen
  s_mov_b32 s20, 40960
  buffer_load_dwordx4 v[56:59], v3, s[8:11], s20 offen
  s_mov_b32 s20, 49152
  buffer_load_dwordx4 v[60:63], v3, s[8:11], s20 offen
  s_mov_b32 s20, 57344
  buffer_load_dwordx4 v[64:67], v3, s[8:11], s20 offen
  s_mov_b32 s20, 65536
  buffer_load_dwordx4 v[68:71], v3, s[8:11], s20 offen
  s_mov_b32 s20, 73728
  buffer_load_dwordx4 v[72:75], v3, s[8:11], s20 offen
  s_mov_b32 s20, 81920
  buffer_load_dwordx4 v[76:79], v3, s[8:11], s20 offen
  s_mov_b32 s20, 90112
  buffer_load_dwordx4 v[80:83], v3, s[8:11], s20 offen
  s_mov_b32 s20, 98304
  buffer_load_dwordx4 v[84:87], v3, s[8:11], s20 offen
  s_mov_b32 s20, 106496
  buffer_load_dwordx4 v[88:91], v3, s[8:11], s20 offen
  s_mov_b32 s20, 114688
  buffer_load_dwordx4 v[92:95], v3, s[8:11], s20 offen
  s_mov_b32 s20, 122880
  buffer_load_dwordx4 v[96:99], v3, s[8:11], s20 offen
  s_lshr_b32 s21, s2, 3
  s_and_b32 s22, s2, 7
  s_lshl_b32 s22, s22, 8
  v_and_b32 v8, 31, v1
  v_lshl_add_u32 v9, v2, 5, v8
  v_add_u32 v9, s22, v9
  v_lshlrev_b32 v110, 10, v9
  s_lshl_b32 s23, s21, 5
  v_add_u32 v110, s23, v110
  v_lshrrev_b32 v111, 5, v1
  v_lshl_add_u32 v9, v111, 4, v110
  buffer_load_dwordx4 v[4:7], v9, s[4:7], 0 offen
  v_mov_b32 v100, 0x3f803f80
  v_mov_b32 v101, v100
  v_mov_b32 v102, v100
  v_mov_b32 v103, v100
  v_add_u32 v104, 0x20000, v3
  v_add_u32 v105, 0x10000, v3
  v_cmp_gt_u32 vcc, 64, v0
  s_and_saveexec_b64 s[24:25], vcc
  ds_write_b128 v104, v[100:103]
  s_mov_b64 exec, s[24:25]
  s_waitcnt vmcnt(1)
  ds_write_b128 v3, v[36:39] offset:0
  ds_write_b128 v3, v[40:43] offset:8192
  ds_write_b128 v3, v[44:47] offset:16384
  ds_write_b128 v3, v[48:51] offset:24576
  ds_write_b128 v3, v[52:55] offset:32768
  ds_write_b128 v3, v[56:59] offset:40960
  ds_write_b128 v3, v[60:63] offset:49152
  ds_write_b128 v3, v[64:67] offset:57344
  ds_write_b128 v105, v[68:71] offset:0
  ds_write_b128 v105, v[72:75] offset:8192
  ds_write_b128 v105, v[76:79] offset:16384
  ds_write_b128 v105, v[80:83] offset:24576
  ds_write_b128 v105, v[84:87] offset:32768
  ds_write_b128 v105, v[88:91] offset:40960
  ds_write_b128 v105, v[92:95] offset:49152
  ds_write_b128 v105, v[96:99] offset:57344
  v_lshlrev_b32 v112, 5, v8
  v_lshl_add_u32 v112, v111, 4, v112
  v_and_b32 v113, 15, v1
  v_lshl_add_u32 v113, v111, 4, v113
  v_lshlrev_b32 v113, 4, v113
  v_add_u32 v113, 0x10000, v113
  v_mov_b32 v114, 0x20000
  v_mov_b32 v115, 1024
  v_cmp_gt_u32 vcc, 16, v8
  s_nop 1
  v_cndmask_b32 v113, v114, v113, vcc
  v_cndmask_b32 v115, 0, v115, vcc
  v_mov_b32 v11, 0xff800000
  s_waitcnt vmcnt(0) lgkmcnt(0)
  s_barrier
  ds_read_b128 v[12:15], v112 offset:0
  ds_read_b128 v[16:19], v112 offset:1024
  s_waitcnt lgkmcnt(1)
  v_mfma_f32_32x32x16_bf16 v[36:51], v[12:15], v[4:7], 0
  ds_read_b128 v[12:15], v112 offset:2048
  s_waitcnt lgkmcnt(1)
  v_mfma_f32_32x32x16_bf16 v[52:67], v[16:19], v[4:7], 0
  ds_read_b128 v[16:19], v112 offset:3072
  v_max3_f32 v11, v11, v36, v37
  v_max3_f32 v11, v11, v38, v39
  v_max3_f32 v11, v11, v40, v41
  v_max3_f32 v11, v11, v42, v43
  v_max3_f32 v11, v11, v44, v45
  v_max3_f32 v11, v11, v46, v47
  v_max3_f32 v11, v11, v48, v49
  v_max3_f32 v11, v11, v50, v51
  s_waitcnt lgkmcnt(1)
  v_mfma_f32_32x32x16_bf16 v[36:51], v[12:15], v[4:7], 0
  ds_read_b128 v[12:15], v112 offset:4096
  v_max3_f32 v11, v11, v52, v53
  v_max3_f32 v11, v11, v54, v55
  v_max3_f32 v11, v11, v56, v57
  v_max3_f32 v11, v11, v58, v59
  v_max3_f32 v11, v11, v60, v61
  v_max3_f32 v11, v11, v62, v63
  v_max3_f32 v11, v11, v64, v65
  v_max3_f32 v11, v11, v66, v67
  s_waitcnt lgkmcnt(1)
  v_mfma_f32_32x32x16_bf16 v[52:67], v[16:19], v[4:7], 0
  ds_read_b128 v[16:19], v112 offset:5120
  v_max3_f32 v11, v11, v36, v37
  v_max3_f32 v11, v11, v38, v39
  v_max3_f32 v11, v11, v40, v41
  v_max3_f32 v11, v11, v42, v43
  v_max3_f32 v11, v11, v44, v45
  v_max3_f32 v11, v11, v46, v47
  v_max3_f32 v11, v11, v48, v49
  v_max3_f32 v11, v11, v50, v51
  s_waitcnt lgkmcnt(1)
  v_mfma_f32_32x32x16_bf16 v[36:51], v[12:15], v[4:7], 0
  ds_read_b128 v[12:15], v112 offset:6144
  v_max3_f32 v11, v11, v52, v53
  v_max3_f32 v11, v11, v54, v55
  v_max3_f32 v11, v11, v56, v57
  v_max3_f32 v11, v11, v58, v59
  v_max3_f32 v11, v11, v60, v61
  v_max3_f32 v11, v11, v62, v63
  v_max3_f32 v11, v11, v64, v65
  v_max3_f32 v11, v11, v66, v67
  s_waitcnt lgkmcnt(1)
  v_mfma_f32_32x32x16_bf16 v[52:67], v[16:19], v[4:7], 0
  ds_read_b128 v[16:19], v112 offset:7168
  v_max3_f32 v11, v11, v36, v37
  v_max3_f32 v11, v11, v38, v39
  v_max3_f32 v11, v11, v40, v41
  v_max3_f32 v11, v11, v42, v43
  v_max3_f32 v11, v11, v44, v45
  v_max3_f32 v11, v11, v46, v47
  v_max3_f32 v11, v11, v48, v49
  v_max3_f32 v11, v11, v50, v51
  s_waitcnt lgkmcnt(1)
  v_mfma_f32_32x32x16_bf16 v[36:51], v[12:15], v[4:7], 0
  ds_read_b128 v[12:15], v112 offset:8192
  v_max3_f32 v11, v11, v52, v53
  v_max3_f32 v11, v11, v54, v55
  v_max3_f32 v11, v11, v56, v57
  v_max3_f32 v11, v11, v58, v59
  v_max3_f32 v11, v11, v60, v61
  v_max3_f32 v11, v11, v62, v63
  v_max3_f32 v11, v11, v64, v65
  v_max3_f32 v11, v11, v66, v67
  s_waitcnt lgkmcnt(1)
  v_mfma_f32_32x32x16_bf16 v[52:67], v[16:19], v[4:7], 0
  ds_read_b128 v[16:19], v112 offset:9216
  v_max3_f32 v11, v11, v36, v37
  v_max3_f32 v11, v11, v38, v39
  v_max3_f32 v11, v11, v40, v41
  v_max3_f32 v11, v11, v42, v43
  v_max3_f32 v11, v11, v44, v45
  v_max3_f32 v11, v11, v46, v47
  v_max3_f32 v11, v11, v48, v49
  v_max3_f32 v11, v11, v50, v51
  s_waitcnt lgkmcnt(1)
  v_mfma_f32_32x32x16_bf16 v[36:51], v[12:15], v[4:7], 0
  ds_read_b128 v[12:15], v112 offset:10240
  v_max3_f32 v11, v11, v52, v53
  v_max3_f32 v11, v11, v54, v55
  v_max3_f32 v11, v11, v56, v57
  v_max3_f32 v11, v11, v58, v59
  v_max3_f32 v11, v11, v60, v61
  v_max3_f32 v11, v11, v62, v63
  v_max3_f32 v11, v11, v64, v65
  v_max3_f32 v11, v11, v66, v67
  s_waitcnt lgkmcnt(1)
  v_mfma_f32_32x32x16_bf16 v[52:67], v[16:19], v[4:7], 0
  ds_read_b128 v[16:19], v112 offset:11264
  v_max3_f32 v11, v11, v36, v37
  v_max3_f32 v11, v11, v38, v39
  v_max3_f32 v11, v11, v40, v41
  v_max3_f32 v11, v11, v42, v43
  v_max3_f32 v11, v11, v44, v45
  v_max3_f32 v11, v11, v46, v47
  v_max3_f32 v11, v11, v48, v49
  v_max3_f32 v11, v11, v50, v51
  s_waitcnt lgkmcnt(1)
  v_mfma_f32_32x32x16_bf16 v[36:51], v[12:15], v[4:7], 0
  ds_read_b128 v[12:15], v112 offset:12288
  v_max3_f32 v11, v11, v52, v53
  v_max3_f32 v11, v11, v54, v55
  v_max3_f32 v11, v11, v56, v57
  v_max3_f32 v11, v11, v58, v59
  v_max3_f32 v11, v11, v60, v61
  v_max3_f32 v11, v11, v62, v63
  v_max3_f32 v11, v11, v64, v65
  v_max3_f32 v11, v11, v66, v67
  s_waitcnt lgkmcnt(1)
  v_mfma_f32_32x32x16_bf16 v[52:67], v[16:19], v[4:7], 0
  ds_read_b128 v[16:19], v112 offset:13312
  v_max3_f32 v11, v11, v36, v37
  v_max3_f32 v11, v11, v38, v39
  v_max3_f32 v11, v11, v40, v41
  v_max3_f32 v11, v11, v42, v43
  v_max3_f32 v11, v11, v44, v45
  v_max3_f32 v11, v11, v46, v47
  v_max3_f32 v11, v11, v48, v49
  v_max3_f32 v11, v11, v50, v51
  s_waitcnt lgkmcnt(1)
  v_mfma_f32_32x32x16_bf16 v[36:51], v[12:15], v[4:7], 0
  ds_read_b128 v[12:15], v112 offset:14336
  v_max3_f32 v11, v11, v52, v53
  v_max3_f32 v11, v11, v54, v55
  v_max3_f32 v11, v11, v56, v57
  v_max3_f32 v11, v11, v58, v59
  v_max3_f32 v11, v11, v60, v61
  v_max3_f32 v11, v11, v62, v63
  v_max3_f32 v11, v11, v64, v65
  v_max3_f32 v11, v11, v66, v67
  s_waitcnt lgkmcnt(1)
  v_mfma_f32_32x32x16_bf16 v[52:67], v[16:19], v[4:7], 0
  ds_read_b128 v[16:19], v112 offset:15360
  v_max3_f32 v11, v11, v36, v37
  v_max3_f32 v11, v11, v38, v39
  v_max3_f32 v11, v11, v40, v41
  v_max3_f32 v11, v11, v42, v43
  v_max3_f32 v11, v11, v44, v45
  v_max3_f32 v11, v11, v46, v47
  v_max3_f32 v11, v11, v48, v49
  v_max3_f32 v11, v11, v50, v51
  s_waitcnt lgkmcnt(1)
  v_mfma_f32_32x32x16_bf16 v[36:51], v[12:15], v[4:7], 0
  ds_read_b128 v[12:15], v112 offset:16384
  v_max3_f32 v11, v11, v52, v53
  v_max3_f32 v11, v11, v54, v55
  v_max3_f32 v11, v11, v56, v57
  v_max3_f32 v11, v11, v58, v59
  v_max3_f32 v11, v11, v60, v61
  v_max3_f32 v11, v11, v62, v63
  v_max3_f32 v11, v11, v64, v65
  v_max3_f32 v11, v11, v66, v67
  s_waitcnt lgkmcnt(1)
  v_mfma_f32_32x32x16_bf16 v[52:67], v[16:19], v[4:7], 0
  ds_read_b128 v[16:19], v112 offset:17408
  v_max3_f32 v11, v11, v36, v37
  v_max3_f32 v11, v11, v38, v39
  v_max3_f32 v11, v11, v40, v41
  v_max3_f32 v11, v11, v42, v43
  v_max3_f32 v11, v11, v44, v45
  v_max3_f32 v11, v11, v46, v47
  v_max3_f32 v11, v11, v48, v49
  v_max3_f32 v11, v11, v50, v51
  s_waitcnt lgkmcnt(1)
  v_mfma_f32_32x32x16_bf16 v[36:51], v[12:15], v[4:7], 0
  ds_read_b128 v[12:15], v112 offset:18432
  v_max3_f32 v11, v11, v52, v53
  v_max3_f32 v11, v11, v54, v55
  v_max3_f32 v11, v11, v56, v57
  v_max3_f32 v11, v11, v58, v59
  v_max3_f32 v11, v11, v60, v61
  v_max3_f32 v11, v11, v62, v63
  v_max3_f32 v11, v11, v64, v65
  v_max3_f32 v11, v11, v66, v67
  s_waitcnt lgkmcnt(1)
  v_mfma_f32_32x32x16_bf16 v[52:67], v[16:19], v[4:7], 0
  ds_read_b128 v[16:19], v112 offset:19456
  v_max3_f32 v11, v11, v36, v37
  v_max3_f32 v11, v11, v38, v39
  v_max3_f32 v11, v11, v40, v41
  v_max3_f32 v11, v11, v42, v43
  v_max3_f32 v11, v11, v44, v45
  v_max3_f32 v11, v11, v46, v47
  v_max3_f32 v11, v11, v48, v49
  v_max3_f32 v11, v11, v50, v51
  s_waitcnt lgkmcnt(1)
  v_mfma_f32_32x32x16_bf16 v[36:51], v[12:15], v[4:7], 0
  ds_read_b128 v[12:15], v112 offset:20480
  v_max3_f32 v11, v11, v52, v53
  v_max3_f32 v11, v11, v54, v55
  v_max3_f32 v11, v11, v56, v57
  v_max3_f32 v11, v11, v58, v59
  v_max3_f32 v11, v11, v60, v61
  v_max3_f32 v11, v11, v62, v63
  v_max3_f32 v11, v11, v64, v65
  v_max3_f32 v11, v11, v66, v67
  s_waitcnt lgkmcnt(1)
  v_mfma_f32_32x32x16_bf16 v[52:67], v[16:19], v[4:7], 0
  ds_read_b128 v[16:19], v112 offset:21504
  v_max3_f32 v11, v11, v36, v37
  v_max3_f32 v11, v11, v38, v39
  v_max3_f32 v11, v11, v40, v41
  v_max3_f32 v11, v11, v42, v43
  v_max3_f32 v11, v11, v44, v45
  v_max3_f32 v11, v11, v46, v47
  v_max3_f32 v11, v11, v48, v49
  v_max3_f32 v11, v11, v50, v51
  s_waitcnt lgkmcnt(1)
  v_mfma_f32_32x32x16_bf16 v[36:51], v[12:15], v[4:7], 0
  ds_read_b128 v[12:15], v112 offset:22528
  v_max3_f32 v11, v11, v52, v53
  v_max3_f32 v11, v11, v54, v55
  v_max3_f32 v11, v11, v56, v57
  v_max3_f32 v11, v11, v58, v59
  v_max3_f32 v11, v11, v60, v61
  v_max3_f32 v11, v11, v62, v63
  v_max3_f32 v11, v11, v64, v65
  v_max3_f32 v11, v11, v66, v67
  s_waitcnt lgkmcnt(1)
  v_mfma_f32_32x32x16_bf16 v[52:67], v[16:19], v[4:7], 0
  ds_read_b128 v[16:19], v112 offset:23552
  v_max3_f32 v11, v11, v36, v37
  v_max3_f32 v11, v11, v38, v39
  v_max3_f32 v11, v11, v40, v41
  v_max3_f32 v11, v11, v42, v43
  v_max3_f32 v11, v11, v44, v45
  v_max3_f32 v11, v11, v46, v47
  v_max3_f32 v11, v11, v48, v49
  v_max3_f32 v11, v11, v50, v51
  s_waitcnt lgkmcnt(1)
  v_mfma_f32_32x32x16_bf16 v[36:51], v[12:15], v[4:7], 0
  ds_read_b128 v[12:15], v112 offset:24576
  v_max3_f32 v11, v11, v52, v53
  v_max3_f32 v11, v11, v54, v55
  v_max3_f32 v11, v11, v56, v57
  v_max3_f32 v11, v11, v58, v59
  v_max3_f32 v11, v11, v60, v61
  v_max3_f32 v11, v11, v62, v63
  v_max3_f32 v11, v11, v64, v65
  v_max3_f32 v11, v11, v66, v67
  s_waitcnt lgkmcnt(1)
  v_mfma_f32_32x32x16_bf16 v[52:67], v[16:19], v[4:7], 0
  ds_read_b128 v[16:19], v112 offset:25600
  v_max3_f32 v11, v11, v36, v37
  v_max3_f32 v11, v11, v38, v39
  v_max3_f32 v11, v11, v40, v41
  v_max3_f32 v11, v11, v42, v43
  v_max3_f32 v11, v11, v44, v45
  v_max3_f32 v11, v11, v46, v47
  v_max3_f32 v11, v11, v48, v49
  v_max3_f32 v11, v11, v50, v51
  s_waitcnt lgkmcnt(1)
  v_mfma_f32_32x32x16_bf16 v[36:51], v[12:15], v[4:7], 0
  ds_read_b128 v[12:15], v112 offset:26624
  v_max3_f32 v11, v11, v52, v53
  v_max3_f32 v11, v11, v54, v55
  v_max3_f32 v11, v11, v56, v57
  v_max3_f32 v11, v11, v58, v59
  v_max3_f32 v11, v11, v60, v61
  v_max3_f32 v11, v11, v62, v63
  v_max3_f32 v11, v11, v64, v65
  v_max3_f32 v11, v11, v66, v67
  s_waitcnt lgkmcnt(1)
  v_mfma_f32_32x32x16_bf16 v[52:67], v[16:19], v[4:7], 0
  ds_read_b128 v[16:19], v112 offset:27648
  v_max3_f32 v11, v11, v36, v37
  v_max3_f32 v11, v11, v38, v39
  v_max3_f32 v11, v11, v40, v41
  v_max3_f32 v11, v11, v42, v43
  v_max3_f32 v11, v11, v44, v45
  v_max3_f32 v11, v11, v46, v47
  v_max3_f32 v11, v11, v48, v49
  v_max3_f32 v11, v11, v50, v51
  s_waitcnt lgkmcnt(1)
  v_mfma_f32_32x32x16_bf16 v[36:51], v[12:15], v[4:7], 0
  ds_read_b128 v[12:15], v112 offset:28672
  v_max3_f32 v11, v11, v52, v53
  v_max3_f32 v11, v11, v54, v55
  v_max3_f32 v11, v11, v56, v57
  v_max3_f32 v11, v11, v58, v59
  v_max3_f32 v11, v11, v60, v61
  v_max3_f32 v11, v11, v62, v63
  v_max3_f32 v11, v11, v64, v65
  v_max3_f32 v11, v11, v66, v67
  s_waitcnt lgkmcnt(1)
  v_mfma_f32_32x32x16_bf16 v[52:67], v[16:19], v[4:7], 0
  ds_read_b128 v[16:19], v112 offset:29696
  v_max3_f32 v11, v11, v36, v37
  v_max3_f32 v11, v11, v38, v39
  v_max3_f32 v11, v11, v40, v41
  v_max3_f32 v11, v11, v42, v43
  v_max3_f32 v11, v11, v44, v45
  v_max3_f32 v11, v11, v46, v47
  v_max3_f32 v11, v11, v48, v49
  v_max3_f32 v11, v11, v50, v51
  s_waitcnt lgkmcnt(1)
  v_mfma_f32_32x32x16_bf16 v[36:51], v[12:15], v[4:7], 0
  ds_read_b128 v[12:15], v112 offset:30720
  v_max3_f32 v11, v11, v52, v53
  v_max3_f32 v11, v11, v54, v55
  v_max3_f32 v11, v11, v56, v57
  v_max3_f32 v11, v11, v58, v59
  v_max3_f32 v11, v11, v60, v61
  v_max3_f32 v11, v11, v62, v63
  v_max3_f32 v11, v11, v64, v65
  v_max3_f32 v11, v11, v66, v67
  s_waitcnt lgkmcnt(1)
  v_mfma_f32_32x32x16_bf16 v[52:67], v[16:19], v[4:7], 0
  ds_read_b128 v[16:19], v112 offset:31744
  v_max3_f32 v11, v11, v36, v37
  v_max3_f32 v11, v11, v38, v39
  v_max3_f32 v11, v11, v40, v41
  v_max3_f32 v11, v11, v42, v43
  v_max3_f32 v11, v11, v44, v45
  v_max3_f32 v11, v11, v46, v47
  v_max3_f32 v11, v11, v48, v49
  v_max3_f32 v11, v11, v50, v51
  s_waitcnt lgkmcnt(1)
  v_mfma_f32_32x32x16_bf16 v[36:51], v[12:15], v[4:7], 0
  ds_read_b128 v[12:15], v112 offset:32768
  v_max3_f32 v11, v11, v52, v53
  v_max3_f32 v11, v11, v54, v55
  v_max3_f32 v11, v11, v56, v57
  v_max3_f32 v11, v11, v58, v59
  v_max3_f32 v11, v11, v60, v61
  v_max3_f32 v11, v11, v62, v63
  v_max3_f32 v11, v11, v64, v65
  v_max3_f32 v11, v11, v66, v67
  s_waitcnt lgkmcnt(1)
  v_mfma_f32_32x32x16_bf16 v[52:67], v[16:19], v[4:7], 0
  ds_read_b128 v[16:19], v112 offset:33792
  v_max3_f32 v11, v11, v36, v37
  v_max3_f32 v11, v11, v38, v39
  v_max3_f32 v11, v11, v40, v41
  v_max3_f32 v11, v11, v42, v43
  v_max3_f32 v11, v11, v44, v45
  v_max3_f32 v11, v11, v46, v47
  v_max3_f32 v11, v11, v48, v49
  v_max3_f32 v11, v11, v50, v51
  s_waitcnt lgkmcnt(1)
  v_mfma_f32_32x32x16_bf16 v[36:51], v[12:15], v[4:7], 0
  ds_read_b128 v[12:15], v112 offset:34816
  v_max3_f32 v11, v11, v52, v53
  v_max3_f32 v11, v11, v54, v55
  v_max3_f32 v11, v11, v56, v57
  v_max3_f32 v11, v11, v58, v59
  v_max3_f32 v11, v11, v60, v61
  v_max3_f32 v11, v11, v62, v63
  v_max3_f32 v11, v11, v64, v65
  v_max3_f32 v11, v11, v66, v67
  s_waitcnt lgkmcnt(1)
  v_mfma_f32_32x32x16_bf16 v[52:67], v[16:19], v[4:7], 0
  ds_read_b128 v[16:19], v112 offset:35840
  v_max3_f32 v11, v11, v36, v37
  v_max3_f32 v11, v11, v38, v39
  v_max3_f32 v11, v11, v40, v41
  v_max3_f32 v11, v11, v42, v43
  v_max3_f32 v11, v11, v44, v45
  v_max3_f32 v11, v11, v46, v47
  v_max3_f32 v11, v11, v48, v49
  v_max3_f32 v11, v11, v50, v51
  s_waitcnt lgkmcnt(1)
  v_mfma_f32_32x32x16_bf16 v[36:51], v[12:15], v[4:7], 0
  ds_read_b128 v[12:15], v112 offset:36864
  v_max3_f32 v11, v11, v52, v53
  v_max3_f32 v11, v11, v54, v55
  v_max3_f32 v11, v11, v56, v57
  v_max3_f32 v11, v11, v58, v59
  v_max3_f32 v11, v11, v60, v61
  v_max3_f32 v11, v11, v62, v63
  v_max3_f32 v11, v11, v64, v65
  v_max3_f32 v11, v11, v66, v67
  s_waitcnt lgkmcnt(1)
  v_mfma_f32_32x32x16_bf16 v[52:67], v[16:19], v[4:7], 0
  ds_read_b128 v[16:19], v112 offset:37888
  v_max3_f32 v11, v11, v36, v37
  v_max3_f32 v11, v11, v38, v39
  v_max3_f32 v11, v11, v40, v41
  v_max3_f32 v11, v11, v42, v43
  v_max3_f32 v11, v11, v44, v45
  v_max3_f32 v11, v11, v46, v47
  v_max3_f32 v11, v11, v48, v49
  v_max3_f32 v11, v11, v50, v51
  s_waitcnt lgkmcnt(1)
  v_mfma_f32_32x32x16_bf16 v[36:51], v[12:15], v[4:7], 0
  ds_read_b128 v[12:15], v112 offset:38912
  v_max3_f32 v11, v11, v52, v53
  v_max3_f32 v11, v11, v54, v55
  v_max3_f32 v11, v11, v56, v57
  v_max3_f32 v11, v11, v58, v59
  v_max3_f32 v11, v11, v60, v61
  v_max3_f32 v11, v11, v62, v63
  v_max3_f32 v11, v11, v64, v65
  v_max3_f32 v11, v11, v66, v67
  s_waitcnt lgkmcnt(1)
  v_mfma_f32_32x32x16_bf16 v[52:67], v[16:19], v[4:7], 0
  ds_read_b128 v[16:19], v112 offset:39936
  v_max3_f32 v11, v11, v36, v37
  v_max3_f32 v11, v11, v38, v39
  v_max3_f32 v11, v11, v40, v41
  v_max3_f32 v11, v11, v42, v43
  v_max3_f32 v11, v11, v44, v45
  v_max3_f32 v11, v11, v46, v47
  v_max3_f32 v11, v11, v48, v49
  v_max3_f32 v11, v11, v50, v51
  s_waitcnt lgkmcnt(1)
  v_mfma_f32_32x32x16_bf16 v[36:51], v[12:15], v[4:7], 0
  ds_read_b128 v[12:15], v112 offset:40960
  v_max3_f32 v11, v11, v52, v53
  v_max3_f32 v11, v11, v54, v55
  v_max3_f32 v11, v11, v56, v57
  v_max3_f32 v11, v11, v58, v59
  v_max3_f32 v11, v11, v60, v61
  v_max3_f32 v11, v11, v62, v63
  v_max3_f32 v11, v11, v64, v65
  v_max3_f32 v11, v11, v66, v67
  s_waitcnt lgkmcnt(1)
  v_mfma_f32_32x32x16_bf16 v[52:67], v[16:19], v[4:7], 0
  ds_read_b128 v[16:19], v112 offset:41984
  v_max3_f32 v11, v11, v36, v37
  v_max3_f32 v11, v11, v38, v39
  v_max3_f32 v11, v11, v40, v41
  v_max3_f32 v11, v11, v42, v43
  v_max3_f32 v11, v11, v44, v45
  v_max3_f32 v11, v11, v46, v47
  v_max3_f32 v11, v11, v48, v49
  v_max3_f32 v11, v11, v50, v51
  s_waitcnt lgkmcnt(1)
  v_mfma_f32_32x32x16_bf16 v[36:51], v[12:15], v[4:7], 0
  ds_read_b128 v[12:15], v112 offset:43008
  v_max3_f32 v11, v11, v52, v53
  v_max3_f32 v11, v11, v54, v55
  v_max3_f32 v11, v11, v56, v57
  v_max3_f32 v11, v11, v58, v59
  v_max3_f32 v11, v11, v60, v61
  v_max3_f32 v11, v11, v62, v63
  v_max3_f32 v11, v11, v64, v65
  v_max3_f32 v11, v11, v66, v67
  s_waitcnt lgkmcnt(1)
  v_mfma_f32_32x32x16_bf16 v[52:67], v[16:19], v[4:7], 0
  ds_read_b128 v[16:19], v112 offset:44032
  v_max3_f32 v11, v11, v36, v37
  v_max3_f32 v11, v11, v38, v39
  v_max3_f32 v11, v11, v40, v41
  v_max3_f32 v11, v11, v42, v43
  v_max3_f32 v11, v11, v44, v45
  v_max3_f32 v11, v11, v46, v47
  v_max3_f32 v11, v11, v48, v49
  v_max3_f32 v11, v11, v50, v51
  s_waitcnt lgkmcnt(1)
  v_mfma_f32_32x32x16_bf16 v[36:51], v[12:15], v[4:7], 0
  ds_read_b128 v[12:15], v112 offset:45056
  v_max3_f32 v11, v11, v52, v53
  v_max3_f32 v11, v11, v54, v55
  v_max3_f32 v11, v11, v56, v57
  v_max3_f32 v11, v11, v58, v59
  v_max3_f32 v11, v11, v60, v61
  v_max3_f32 v11, v11, v62, v63
  v_max3_f32 v11, v11, v64, v65
  v_max3_f32 v11, v11, v66, v67
  s_waitcnt lgkmcnt(1)
  v_mfma_f32_32x32x16_bf16 v[52:67], v[16:19], v[4:7], 0
  ds_read_b128 v[16:19], v112 offset:46080
  v_max3_f32 v11, v11, v36, v37
  v_max3_f32 v11, v11, v38, v39
  v_max3_f32 v11, v11, v40, v41
  v_max3_f32 v11, v11, v42, v43
  v_max3_f32 v11, v11, v44, v45
  v_max3_f32 v11, v11, v46, v47
  v_max3_f32 v11, v11, v48, v49
  v_max3_f32 v11, v11, v50, v51
  s_waitcnt lgkmcnt(1)
  v_mfma_f32_32x32x16_bf16 v[36:51], v[12:15], v[4:7], 0
  ds_read_b128 v[12:15], v112 offset:47104
  v_max3_f32 v11, v11, v52, v53
  v_max3_f32 v11, v11, v54, v55
  v_max3_f32 v11, v11, v56, v57
  v_max3_f32 v11, v11, v58, v59
  v_max3_f32 v11, v11, v60, v61
  v_max3_f32 v11, v11, v62, v63
  v_max3_f32 v11, v11, v64, v65
  v_max3_f32 v11, v11, v66, v67
  s_waitcnt lgkmcnt(1)
  v_mfma_f32_32x32x16_bf16 v[52:67], v[16:19], v[4:7], 0
  ds_read_b128 v[16:19], v112 offset:48128
  v_max3_f32 v11, v11, v36, v37
  v_max3_f32 v11, v11, v38, v39
  v_max3_f32 v11, v11, v40, v41
  v_max3_f32 v11, v11, v42, v43
  v_max3_f32 v11, v11, v44, v45
  v_max3_f32 v11, v11, v46, v47
  v_max3_f32 v11, v11, v48, v49
  v_max3_f32 v11, v11, v50, v51
  s_waitcnt lgkmcnt(1)
  v_mfma_f32_32x32x16_bf16 v[36:51], v[12:15], v[4:7], 0
  ds_read_b128 v[12:15], v112 offset:49152
  v_max3_f32 v11, v11, v52, v53
  v_max3_f32 v11, v11, v54, v55
  v_max3_f32 v11, v11, v56, v57
  v_max3_f32 v11, v11, v58, v59
  v_max3_f32 v11, v11, v60, v61
  v_max3_f32 v11, v11, v62, v63
  v_max3_f32 v11, v11, v64, v65
  v_max3_f32 v11, v11, v66, v67
  s_waitcnt lgkmcnt(1)
  v_mfma_f32_32x32x16_bf16 v[52:67], v[16:19], v[4:7], 0
  ds_read_b128 v[16:19], v112 offset:50176
  v_max3_f32 v11, v11, v36, v37
  v_max3_f32 v11, v11, v38, v39
  v_max3_f32 v11, v11, v40, v41
  v_max3_f32 v11, v11, v42, v43
  v_max3_f32 v11, v11, v44, v45
  v_max3_f32 v11, v11, v46, v47
  v_max3_f32 v11, v11, v48, v49
  v_max3_f32 v11, v11, v50, v51
  s_waitcnt lgkmcnt(1)
  v_mfma_f32_32x32x16_bf16 v[36:51], v[12:15], v[4:7], 0
  ds_read_b128 v[12:15], v112 offset:51200
  v_max3_f32 v11, v11, v52, v53
  v_max3_f32 v11, v11, v54, v55
  v_max3_f32 v11, v11, v56, v57
  v_max3_f32 v11, v11, v58, v59
  v_max3_f32 v11, v11, v60, v61
  v_max3_f32 v11, v11, v62, v63
  v_max3_f32 v11, v11, v64, v65
  v_max3_f32 v11, v11, v66, v67
  s_waitcnt lgkmcnt(1)
  v_mfma_f32_32x32x16_bf16 v[52:67], v[16:19], v[4:7], 0
  ds_read_b128 v[16:19], v112 offset:52224
  v_max3_f32 v11, v11, v36, v37
  v_max3_f32 v11, v11, v38, v39
  v_max3_f32 v11, v11, v40, v41
  v_max3_f32 v11, v11, v42, v43
  v_max3_f32 v11, v11, v44, v45
  v_max3_f32 v11, v11, v46, v47
  v_max3_f32 v11, v11, v48, v49
  v_max3_f32 v11, v11, v50, v51
  s_waitcnt lgkmcnt(1)
  v_mfma_f32_32x32x16_bf16 v[36:51], v[12:15], v[4:7], 0
  ds_read_b128 v[12:15], v112 offset:53248
  v_max3_f32 v11, v11, v52, v53
  v_max3_f32 v11, v11, v54, v55
  v_max3_f32 v11, v11, v56, v57
  v_max3_f32 v11, v11, v58, v59
  v_max3_f32 v11, v11, v60, v61
  v_max3_f32 v11, v11, v62, v63
  v_max3_f32 v11, v11, v64, v65
  v_max3_f32 v11, v11, v66, v67
  s_waitcnt lgkmcnt(1)
  v_mfma_f32_32x32x16_bf16 v[52:67], v[16:19], v[4:7], 0
  ds_read_b128 v[16:19], v112 offset:54272
  v_max3_f32 v11, v11, v36, v37
  v_max3_f32 v11, v11, v38, v39
  v_max3_f32 v11, v11, v40, v41
  v_max3_f32 v11, v11, v42, v43
  v_max3_f32 v11, v11, v44, v45
  v_max3_f32 v11, v11, v46, v47
  v_max3_f32 v11, v11, v48, v49
  v_max3_f32 v11, v11, v50, v51
  s_waitcnt lgkmcnt(1)
  v_mfma_f32_32x32x16_bf16 v[36:51], v[12:15], v[4:7], 0
  ds_read_b128 v[12:15], v112 offset:55296
  v_max3_f32 v11, v11, v52, v53
  v_max3_f32 v11, v11, v54, v55
  v_max3_f32 v11, v11, v56, v57
  v_max3_f32 v11, v11, v58, v59
  v_max3_f32 v11, v11, v60, v61
  v_max3_f32 v11, v11, v62, v63
  v_max3_f32 v11, v11, v64, v65
  v_max3_f32 v11, v11, v66, v67
  s_waitcnt lgkmcnt(1)
  v_mfma_f32_32x32x16_bf16 v[52:67], v[16:19], v[4:7], 0
  ds_read_b128 v[16:19], v112 offset:56320
  v_max3_f32 v11, v11, v36, v37
  v_max3_f32 v11, v11, v38, v39
  v_max3_f32 v11, v11, v40, v41
  v_max3_f32 v11, v11, v42, v43
  v_max3_f32 v11, v11, v44, v45
  v_max3_f32 v11, v11, v46, v47
  v_max3_f32 v11, v11, v48, v49
  v_max3_f32 v11, v11, v50, v51
  s_waitcnt lgkmcnt(1)
  v_mfma_f32_32x32x16_bf16 v[36:51], v[12:15], v[4:7], 0
  ds_read_b128 v[12:15], v112 offset:57344
  v_max3_f32 v11, v11, v52, v53
  v_max3_f32 v11, v11, v54, v55
  v_max3_f32 v11, v11, v56, v57
  v_max3_f32 v11, v11, v58, v59
  v_max3_f32 v11, v11, v60, v61
  v_max3_f32 v11, v11, v62, v63
  v_max3_f32 v11, v11, v64, v65
  v_max3_f32 v11, v11, v66, v67
  s_waitcnt lgkmcnt(1)
  v_mfma_f32_32x32x16_bf16 v[52:67], v[16:19], v[4:7], 0
  ds_read_b128 v[16:19], v112 offset:58368
  v_max3_f32 v11, v11, v36, v37
  v_max3_f32 v11, v11, v38, v39
  v_max3_f32 v11, v11, v40, v41
  v_max3_f32 v11, v11, v42, v43
  v_max3_f32 v11, v11, v44, v45
  v_max3_f32 v11, v11, v46, v47
  v_max3_f32 v11, v11, v48, v49
  v_max3_f32 v11, v11, v50, v51
  s_waitcnt lgkmcnt(1)
  v_mfma_f32_32x32x16_bf16 v[36:51], v[12:15], v[4:7], 0
  ds_read_b128 v[12:15], v112 offset:59392
  v_max3_f32 v11, v11, v52, v53
  v_max3_f32 v11, v11, v54, v55
  v_max3_f32 v11, v11, v56, v57
  v_max3_f32 v11, v11, v58, v59
  v_max3_f32 v11, v11, v60, v61
  v_max3_f32 v11, v11, v62, v63
  v_max3_f32 v11, v11, v64, v65
  v_max3_f32 v11, v11, v66, v67
  s_waitcnt lgkmcnt(1)
  v_mfma_f32_32x32x16_bf16 v[52:67], v[16:19], v[4:7], 0
  ds_read_b128 v[16:19], v112 offset:60416
  v_max3_f32 v11, v11, v36, v37
  v_max3_f32 v11, v11, v38, v39
  v_max3_f32 v11, v11, v40, v41
  v_max3_f32 v11, v11, v42, v43
  v_max3_f32 v11, v11, v44, v45
  v_max3_f32 v11, v11, v46, v47
  v_max3_f32 v11, v11, v48, v49
  v_max3_f32 v11, v11, v50, v51
  s_waitcnt lgkmcnt(1)
  v_mfma_f32_32x32x16_bf16 v[36:51], v[12:15], v[4:7], 0
  ds_read_b128 v[12:15], v112 offset:61440
  v_max3_f32 v11, v11, v52, v53
  v_max3_f32 v11, v11, v54, v55
  v_max3_f32 v11, v11, v56, v57
  v_max3_f32 v11, v11, v58, v59
  v_max3_f32 v11, v11, v60, v61
  v_max3_f32 v11, v11, v62, v63
  v_max3_f32 v11, v11, v64, v65
  v_max3_f32 v11, v11, v66, v67
  s_waitcnt lgkmcnt(1)
  v_mfma_f32_32x32x16_bf16 v[52:67], v[16:19], v[4:7], 0
  ds_read_b128 v[16:19], v112 offset:62464
  v_max3_f32 v11, v11, v36, v37
  v_max3_f32 v11, v11, v38, v39
  v_max3_f32 v11, v11, v40, v41
  v_max3_f32 v11, v11, v42, v43
  v_max3_f32 v11, v11, v44, v45
  v_max3_f32 v11, v11, v46, v47
  v_max3_f32 v11, v11, v48, v49
  v_max3_f32 v11, v11, v50, v51
  s_waitcnt lgkmcnt(1)
  v_mfma_f32_32x32x16_bf16 v[36:51], v[12:15], v[4:7], 0
  ds_read_b128 v[12:15], v112 offset:63488
  v_max3_f32 v11, v11, v52, v53
  v_max3_f32 v11, v11, v54, v55
  v_max3_f32 v11, v11, v56, v57
  v_max3_f32 v11, v11, v58, v59
  v_max3_f32 v11, v11, v60, v61
  v_max3_f32 v11, v11, v62, v63
  v_max3_f32 v11, v11, v64, v65
  v_max3_f32 v11, v11, v66, v67
  s_waitcnt lgkmcnt(1)
  v_mfma_f32_32x32x16_bf16 v[52:67], v[16:19], v[4:7], 0
  ds_read_b128 v[16:19], v112 offset:64512
  v_max3_f32 v11, v11, v36, v37
  v_max3_f32 v11, v11, v38, v39
  v_max3_f32 v11, v11, v40, v41
  v_max3_f32 v11, v11, v42, v43
  v_max3_f32 v11, v11, v44, v45
  v_max3_f32 v11, v11, v46, v47
  v_max3_f32 v11, v11, v48, v49
  v_max3_f32 v11, v11, v50, v51
  s_waitcnt lgkmcnt(1)
  v_mfma_f32_32x32x16_bf16 v[36:51], v[12:15], v[4:7], 0
  s_nop 0
  v_max3_f32 v11, v11, v52, v53
  v_max3_f32 v11, v11, v54, v55
  v_max3_f32 v11, v11, v56, v57
  v_max3_f32 v11, v11, v58, v59
  v_max3_f32 v11, v11, v60, v61
  v_max3_f32 v11, v11, v62, v63
  v_max3_f32 v11, v11, v64, v65
  v_max3_f32 v11, v11, v66, v67
  s_waitcnt lgkmcnt(0)
  v_mfma_f32_32x32x16_bf16 v[52:67], v[16:19], v[4:7], 0
  s_nop 0
  v_max3_f32 v11, v11, v36, v37
  v_max3_f32 v11, v11, v38, v39
  v_max3_f32 v11, v11, v40, v41
  v_max3_f32 v11, v11, v42, v43
  v_max3_f32 v11, v11, v44, v45
  v_max3_f32 v11, v11, v46, v47
  v_max3_f32 v11, v11, v48, v49
  v_max3_f32 v11, v11, v50, v51
  s_nop 7
  s_nop 7
  v_max3_f32 v11, v11, v52, v53
  v_max3_f32 v11, v11, v54, v55
  v_max3_f32 v11, v11, v56, v57
  v_max3_f32 v11, v11, v58, v59
  v_max3_f32 v11, v11, v60, v61
  v_max3_f32 v11, v11, v62, v63
  v_max3_f32 v11, v11, v64, v65
  v_max3_f32 v11, v11, v66, v67
  v_mov_b32 v10, v11
  s_nop 1
  v_permlane32_swap_b32 v11, v10
  v_max_f32 v11, v11, v10
  v_sub_f32 v68, 0, v11
  v_sub_f32 v69, 0, v11
  v_sub_f32 v70, 0, v11
  v_sub_f32 v71, 0, v11
  v_sub_f32 v72, 0, v11
  v_sub_f32 v73, 0, v11
  v_sub_f32 v74, 0, v11
  v_sub_f32 v75, 0, v11
  v_sub_f32 v76, 0, v11
  v_sub_f32 v77, 0, v11
  v_sub_f32 v78, 0, v11
  v_sub_f32 v79, 0, v11
  v_sub_f32 v80, 0, v11
  v_sub_f32 v81, 0, v11
  v_sub_f32 v82, 0, v11
  v_sub_f32 v83, 0, v11
  ds_read_b128 v[12:15], v112 offset:0
  s_waitcnt lgkmcnt(0)
  v_mfma_f32_32x32x16_bf16 v[36:51], v[12:15], v[4:7], v[68:83]
  ds_read_b128 v[16:19], v112 offset:1024
  ds_read_b128 v[20:23], v113 offset:0
  ds_read_b128 v[24:27], v113 offset:512
  v_add_u32 v113, v113, v115
  s_waitcnt lgkmcnt(2)
  v_mfma_f32_32x32x16_bf16 v[52:67], v[16:19], v[4:7], v[68:83]
  ds_read_b128 v[12:15], v112 offset:2048
  v_exp_f32 v36, v36
  v_exp_f32 v37, v37
  v_exp_f32 v38, v38
  v_exp_f32 v39, v39
  v_exp_f32 v40, v40
  v_exp_f32 v41, v41
  v_exp_f32 v42, v42
  v_exp_f32 v43, v43
  v_exp_f32 v44, v44
  v_exp_f32 v45, v45
  v_exp_f32 v46, v46
  v_exp_f32 v47, v47
  v_exp_f32 v48, v48
  v_exp_f32 v49, v49
  v_exp_f32 v50, v50
  v_exp_f32 v51, v51
  v_cvt_pk_bf16_f32 v84, v36, v37
  v_cvt_pk_bf16_f32 v85, v38, v39
  v_cvt_pk_bf16_f32 v86, v40, v41
  v_cvt_pk_bf16_f32 v87, v42, v43
  v_cvt_pk_bf16_f32 v88, v44, v45
  v_cvt_pk_bf16_f32 v89, v46, v47
  v_cvt_pk_bf16_f32 v90, v48, v49
  v_cvt_pk_bf16_f32 v91, v50, v51
  s_waitcnt lgkmcnt(1)
  s_nop 1
  v_mfma_f32_32x32x16_bf16 v[92:107], v[20:23], v[84:87], 0
  v_mfma_f32_32x32x16_bf16 v[92:107], v[24:27], v[88:91], v[92:107]
  ds_read_b128 v[28:31], v113 offset:0
  ds_read_b128 v[32:35], v113 offset:512
  v_add_u32 v113, v113, v115
  s_waitcnt lgkmcnt(2)
  v_mfma_f32_32x32x16_bf16 v[36:51], v[12:15], v[4:7], v[68:83]
  ds_read_b128 v[16:19], v112 offset:3072
  v_exp_f32 v52, v52
  v_exp_f32 v53, v53
  v_exp_f32 v54, v54
  v_exp_f32 v55, v55
  v_exp_f32 v56, v56
  v_exp_f32 v57, v57
  v_exp_f32 v58, v58
  v_exp_f32 v59, v59
  v_exp_f32 v60, v60
  v_exp_f32 v61, v61
  v_exp_f32 v62, v62
  v_exp_f32 v63, v63
  v_exp_f32 v64, v64
  v_exp_f32 v65, v65
  v_exp_f32 v66, v66
  v_exp_f32 v67, v67
  v_cvt_pk_bf16_f32 v84, v52, v53
  v_cvt_pk_bf16_f32 v85, v54, v55
  v_cvt_pk_bf16_f32 v86, v56, v57
  v_cvt_pk_bf16_f32 v87, v58, v59
  v_cvt_pk_bf16_f32 v88, v60, v61
  v_cvt_pk_bf16_f32 v89, v62, v63
  v_cvt_pk_bf16_f32 v90, v64, v65
  v_cvt_pk_bf16_f32 v91, v66, v67
  s_waitcnt lgkmcnt(1)
  s_nop 1
  v_mfma_f32_32x32x16_bf16 v[92:107], v[28:31], v[84:87], v[92:107]
  v_mfma_f32_32x32x16_bf16 v[92:107], v[32:35], v[88:91], v[92:107]
  ds_read_b128 v[20:23], v113 offset:0
  ds_read_b128 v[24:27], v113 offset:512
  v_add_u32 v113, v113, v115
  s_waitcnt lgkmcnt(2)
  v_mfma_f32_32x32x16_bf16 v[52:67], v[16:19], v[4:7], v[68:83]
  ds_read_b128 v[12:15], v112 offset:4096
  v_exp_f32 v36, v36
  v_exp_f32 v37, v37
  v_exp_f32 v38, v38
  v_exp_f32 v39, v39
  v_exp_f32 v40, v40
  v_exp_f32 v41, v41
  v_exp_f32 v42, v42
  v_exp_f32 v43, v43
  v_exp_f32 v44, v44
  v_exp_f32 v45, v45
  v_exp_f32 v46, v46
  v_exp_f32 v47, v47
  v_exp_f32 v48, v48
  v_exp_f32 v49, v49
  v_exp_f32 v50, v50
  v_exp_f32 v51, v51
  v_cvt_pk_bf16_f32 v84, v36, v37
  v_cvt_pk_bf16_f32 v85, v38, v39
  v_cvt_pk_bf16_f32 v86, v40, v41
  v_cvt_pk_bf16_f32 v87, v42, v43
  v_cvt_pk_bf16_f32 v88, v44, v45
  v_cvt_pk_bf16_f32 v89, v46, v47
  v_cvt_pk_bf16_f32 v90, v48, v49
  v_cvt_pk_bf16_f32 v91, v50, v51
  s_waitcnt lgkmcnt(1)
  s_nop 1
  v_mfma_f32_32x32x16_bf16 v[92:107], v[20:23], v[84:87], v[92:107]
  v_mfma_f32_32x32x16_bf16 v[92:107], v[24:27], v[88:91], v[92:107]
  ds_read_b128 v[28:31], v113 offset:0
  ds_read_b128 v[32:35], v113 offset:512
  v_add_u32 v113, v113, v115
  s_waitcnt lgkmcnt(2)
  v_mfma_f32_32x32x16_bf16 v[36:51], v[12:15], v[4:7], v[68:83]
  ds_read_b128 v[16:19], v112 offset:5120
  v_exp_f32 v52, v52
  v_exp_f32 v53, v53
  v_exp_f32 v54, v54
  v_exp_f32 v55, v55
  v_exp_f32 v56, v56
  v_exp_f32 v57, v57
  v_exp_f32 v58, v58
  v_exp_f32 v59, v59
  v_exp_f32 v60, v60
  v_exp_f32 v61, v61
  v_exp_f32 v62, v62
  v_exp_f32 v63, v63
  v_exp_f32 v64, v64
  v_exp_f32 v65, v65
  v_exp_f32 v66, v66
  v_exp_f32 v67, v67
  v_cvt_pk_bf16_f32 v84, v52, v53
  v_cvt_pk_bf16_f32 v85, v54, v55
  v_cvt_pk_bf16_f32 v86, v56, v57
  v_cvt_pk_bf16_f32 v87, v58, v59
  v_cvt_pk_bf16_f32 v88, v60, v61
  v_cvt_pk_bf16_f32 v89, v62, v63
  v_cvt_pk_bf16_f32 v90, v64, v65
  v_cvt_pk_bf16_f32 v91, v66, v67
  s_waitcnt lgkmcnt(1)
  s_nop 1
  v_mfma_f32_32x32x16_bf16 v[92:107], v[28:31], v[84:87], v[92:107]
  v_mfma_f32_32x32x16_bf16 v[92:107], v[32:35], v[88:91], v[92:107]
  ds_read_b128 v[20:23], v113 offset:0
  ds_read_b128 v[24:27], v113 offset:512
  v_add_u32 v113, v113, v115
  s_waitcnt lgkmcnt(2)
  v_mfma_f32_32x32x16_bf16 v[52:67], v[16:19], v[4:7], v[68:83]
  ds_read_b128 v[12:15], v112 offset:6144
  v_exp_f32 v36, v36
  v_exp_f32 v37, v37
  v_exp_f32 v38, v38
  v_exp_f32 v39, v39
  v_exp_f32 v40, v40
  v_exp_f32 v41, v41
  v_exp_f32 v42, v42
  v_exp_f32 v43, v43
  v_exp_f32 v44, v44
  v_exp_f32 v45, v45
  v_exp_f32 v46, v46
  v_exp_f32 v47, v47
  v_exp_f32 v48, v48
  v_exp_f32 v49, v49
  v_exp_f32 v50, v50
  v_exp_f32 v51, v51
  v_cvt_pk_bf16_f32 v84, v36, v37
  v_cvt_pk_bf16_f32 v85, v38, v39
  v_cvt_pk_bf16_f32 v86, v40, v41
  v_cvt_pk_bf16_f32 v87, v42, v43
  v_cvt_pk_bf16_f32 v88, v44, v45
  v_cvt_pk_bf16_f32 v89, v46, v47
  v_cvt_pk_bf16_f32 v90, v48, v49
  v_cvt_pk_bf16_f32 v91, v50, v51
  s_waitcnt lgkmcnt(1)
  s_nop 1
  v_mfma_f32_32x32x16_bf16 v[92:107], v[20:23], v[84:87], v[92:107]
  v_mfma_f32_32x32x16_bf16 v[92:107], v[24:27], v[88:91], v[92:107]
  ds_read_b128 v[28:31], v113 offset:0
  ds_read_b128 v[32:35], v113 offset:512
  v_add_u32 v113, v113, v115
  s_waitcnt lgkmcnt(2)
  v_mfma_f32_32x32x16_bf16 v[36:51], v[12:15], v[4:7], v[68:83]
  ds_read_b128 v[16:19], v112 offset:7168
  v_exp_f32 v52, v52
  v_exp_f32 v53, v53
  v_exp_f32 v54, v54
  v_exp_f32 v55, v55
  v_exp_f32 v56, v56
  v_exp_f32 v57, v57
  v_exp_f32 v58, v58
  v_exp_f32 v59, v59
  v_exp_f32 v60, v60
  v_exp_f32 v61, v61
  v_exp_f32 v62, v62
  v_exp_f32 v63, v63
  v_exp_f32 v64, v64
  v_exp_f32 v65, v65
  v_exp_f32 v66, v66
  v_exp_f32 v67, v67
  v_cvt_pk_bf16_f32 v84, v52, v53
  v_cvt_pk_bf16_f32 v85, v54, v55
  v_cvt_pk_bf16_f32 v86, v56, v57
  v_cvt_pk_bf16_f32 v87, v58, v59
  v_cvt_pk_bf16_f32 v88, v60, v61
  v_cvt_pk_bf16_f32 v89, v62, v63
  v_cvt_pk_bf16_f32 v90, v64, v65
  v_cvt_pk_bf16_f32 v91, v66, v67
  s_waitcnt lgkmcnt(1)
  s_nop 1
  v_mfma_f32_32x32x16_bf16 v[92:107], v[28:31], v[84:87], v[92:107]
  v_mfma_f32_32x32x16_bf16 v[92:107], v[32:35], v[88:91], v[92:107]
  ds_read_b128 v[20:23], v113 offset:0
  ds_read_b128 v[24:27], v113 offset:512
  v_add_u32 v113, v113, v115
  s_waitcnt lgkmcnt(2)
  v_mfma_f32_32x32x16_bf16 v[52:67], v[16:19], v[4:7], v[68:83]
  ds_read_b128 v[12:15], v112 offset:8192
  v_exp_f32 v36, v36
  v_exp_f32 v37, v37
  v_exp_f32 v38, v38
  v_exp_f32 v39, v39
  v_exp_f32 v40, v40
  v_exp_f32 v41, v41
  v_exp_f32 v42, v42
  v_exp_f32 v43, v43
  v_exp_f32 v44, v44
  v_exp_f32 v45, v45
  v_exp_f32 v46, v46
  v_exp_f32 v47, v47
  v_exp_f32 v48, v48
  v_exp_f32 v49, v49
  v_exp_f32 v50, v50
  v_exp_f32 v51, v51
  v_cvt_pk_bf16_f32 v84, v36, v37
  v_cvt_pk_bf16_f32 v85, v38, v39
  v_cvt_pk_bf16_f32 v86, v40, v41
  v_cvt_pk_bf16_f32 v87, v42, v43
  v_cvt_pk_bf16_f32 v88, v44, v45
  v_cvt_pk_bf16_f32 v89, v46, v47
  v_cvt_pk_bf16_f32 v90, v48, v49
  v_cvt_pk_bf16_f32 v91, v50, v51
  s_waitcnt lgkmcnt(1)
  s_nop 1
  v_mfma_f32_32x32x16_bf16 v[92:107], v[20:23], v[84:87], v[92:107]
  v_mfma_f32_32x32x16_bf16 v[92:107], v[24:27], v[88:91], v[92:107]
  ds_read_b128 v[28:31], v113 offset:0
  ds_read_b128 v[32:35], v113 offset:512
  v_add_u32 v113, v113, v115
  s_waitcnt lgkmcnt(2)
  v_mfma_f32_32x32x16_bf16 v[36:51], v[12:15], v[4:7], v[68:83]
  ds_read_b128 v[16:19], v112 offset:9216
  v_exp_f32 v52, v52
  v_exp_f32 v53, v53
  v_exp_f32 v54, v54
  v_exp_f32 v55, v55
  v_exp_f32 v56, v56
  v_exp_f32 v57, v57
  v_exp_f32 v58, v58
  v_exp_f32 v59, v59
  v_exp_f32 v60, v60
  v_exp_f32 v61, v61
  v_exp_f32 v62, v62
  v_exp_f32 v63, v63
  v_exp_f32 v64, v64
  v_exp_f32 v65, v65
  v_exp_f32 v66, v66
  v_exp_f32 v67, v67
  v_cvt_pk_bf16_f32 v84, v52, v53
  v_cvt_pk_bf16_f32 v85, v54, v55
  v_cvt_pk_bf16_f32 v86, v56, v57
  v_cvt_pk_bf16_f32 v87, v58, v59
  v_cvt_pk_bf16_f32 v88, v60, v61
  v_cvt_pk_bf16_f32 v89, v62, v63
  v_cvt_pk_bf16_f32 v90, v64, v65
  v_cvt_pk_bf16_f32 v91, v66, v67
  s_waitcnt lgkmcnt(1)
  s_nop 1
  v_mfma_f32_32x32x16_bf16 v[92:107], v[28:31], v[84:87], v[92:107]
  v_mfma_f32_32x32x16_bf16 v[92:107], v[32:35], v[88:91], v[92:107]
  ds_read_b128 v[20:23], v113 offset:0
  ds_read_b128 v[24:27], v113 offset:512
  v_add_u32 v113, v113, v115
  s_waitcnt lgkmcnt(2)
  v_mfma_f32_32x32x16_bf16 v[52:67], v[16:19], v[4:7], v[68:83]
  ds_read_b128 v[12:15], v112 offset:10240
  v_exp_f32 v36, v36
  v_exp_f32 v37, v37
  v_exp_f32 v38, v38
  v_exp_f32 v39, v39
  v_exp_f32 v40, v40
  v_exp_f32 v41, v41
  v_exp_f32 v42, v42
  v_exp_f32 v43, v43
  v_exp_f32 v44, v44
  v_exp_f32 v45, v45
  v_exp_f32 v46, v46
  v_exp_f32 v47, v47
  v_exp_f32 v48, v48
  v_exp_f32 v49, v49
  v_exp_f32 v50, v50
  v_exp_f32 v51, v51
  v_cvt_pk_bf16_f32 v84, v36, v37
  v_cvt_pk_bf16_f32 v85, v38, v39
  v_cvt_pk_bf16_f32 v86, v40, v41
  v_cvt_pk_bf16_f32 v87, v42, v43
  v_cvt_pk_bf16_f32 v88, v44, v45
  v_cvt_pk_bf16_f32 v89, v46, v47
  v_cvt_pk_bf16_f32 v90, v48, v49
  v_cvt_pk_bf16_f32 v91, v50, v51
  s_waitcnt lgkmcnt(1)
  s_nop 1
  v_mfma_f32_32x32x16_bf16 v[92:107], v[20:23], v[84:87], v[92:107]
  v_mfma_f32_32x32x16_bf16 v[92:107], v[24:27], v[88:91], v[92:107]
  ds_read_b128 v[28:31], v113 offset:0
  ds_read_b128 v[32:35], v113 offset:512
  v_add_u32 v113, v113, v115
  s_waitcnt lgkmcnt(2)
  v_mfma_f32_32x32x16_bf16 v[36:51], v[12:15], v[4:7], v[68:83]
  ds_read_b128 v[16:19], v112 offset:11264
  v_exp_f32 v52, v52
  v_exp_f32 v53, v53
  v_exp_f32 v54, v54
  v_exp_f32 v55, v55
  v_exp_f32 v56, v56
  v_exp_f32 v57, v57
  v_exp_f32 v58, v58
  v_exp_f32 v59, v59
  v_exp_f32 v60, v60
  v_exp_f32 v61, v61
  v_exp_f32 v62, v62
  v_exp_f32 v63, v63
  v_exp_f32 v64, v64
  v_exp_f32 v65, v65
  v_exp_f32 v66, v66
  v_exp_f32 v67, v67
  v_cvt_pk_bf16_f32 v84, v52, v53
  v_cvt_pk_bf16_f32 v85, v54, v55
  v_cvt_pk_bf16_f32 v86, v56, v57
  v_cvt_pk_bf16_f32 v87, v58, v59
  v_cvt_pk_bf16_f32 v88, v60, v61
  v_cvt_pk_bf16_f32 v89, v62, v63
  v_cvt_pk_bf16_f32 v90, v64, v65
  v_cvt_pk_bf16_f32 v91, v66, v67
  s_waitcnt lgkmcnt(1)
  s_nop 1
  v_mfma_f32_32x32x16_bf16 v[92:107], v[28:31], v[84:87], v[92:107]
  v_mfma_f32_32x32x16_bf16 v[92:107], v[32:35], v[88:91], v[92:107]
  ds_read_b128 v[20:23], v113 offset:0
  ds_read_b128 v[24:27], v113 offset:512
  v_add_u32 v113, v113, v115
  s_waitcnt lgkmcnt(2)
  v_mfma_f32_32x32x16_bf16 v[52:67], v[16:19], v[4:7], v[68:83]
  ds_read_b128 v[12:15], v112 offset:12288
  v_exp_f32 v36, v36
  v_exp_f32 v37, v37
  v_exp_f32 v38, v38
  v_exp_f32 v39, v39
  v_exp_f32 v40, v40
  v_exp_f32 v41, v41
  v_exp_f32 v42, v42
  v_exp_f32 v43, v43
  v_exp_f32 v44, v44
  v_exp_f32 v45, v45
  v_exp_f32 v46, v46
  v_exp_f32 v47, v47
  v_exp_f32 v48, v48
  v_exp_f32 v49, v49
  v_exp_f32 v50, v50
  v_exp_f32 v51, v51
  v_cvt_pk_bf16_f32 v84, v36, v37
  v_cvt_pk_bf16_f32 v85, v38, v39
  v_cvt_pk_bf16_f32 v86, v40, v41
  v_cvt_pk_bf16_f32 v87, v42, v43
  v_cvt_pk_bf16_f32 v88, v44, v45
  v_cvt_pk_bf16_f32 v89, v46, v47
  v_cvt_pk_bf16_f32 v90, v48, v49
  v_cvt_pk_bf16_f32 v91, v50, v51
  s_waitcnt lgkmcnt(1)
  s_nop 1
  v_mfma_f32_32x32x16_bf16 v[92:107], v[20:23], v[84:87], v[92:107]
  v_mfma_f32_32x32x16_bf16 v[92:107], v[24:27], v[88:91], v[92:107]
  ds_read_b128 v[28:31], v113 offset:0
  ds_read_b128 v[32:35], v113 offset:512
  v_add_u32 v113, v113, v115
  s_waitcnt lgkmcnt(2)
  v_mfma_f32_32x32x16_bf16 v[36:51], v[12:15], v[4:7], v[68:83]
  ds_read_b128 v[16:19], v112 offset:13312
  v_exp_f32 v52, v52
  v_exp_f32 v53, v53
  v_exp_f32 v54, v54
  v_exp_f32 v55, v55
  v_exp_f32 v56, v56
  v_exp_f32 v57, v57
  v_exp_f32 v58, v58
  v_exp_f32 v59, v59
  v_exp_f32 v60, v60
  v_exp_f32 v61, v61
  v_exp_f32 v62, v62
  v_exp_f32 v63, v63
  v_exp_f32 v64, v64
  v_exp_f32 v65, v65
  v_exp_f32 v66, v66
  v_exp_f32 v67, v67
  v_cvt_pk_bf16_f32 v84, v52, v53
  v_cvt_pk_bf16_f32 v85, v54, v55
  v_cvt_pk_bf16_f32 v86, v56, v57
  v_cvt_pk_bf16_f32 v87, v58, v59
  v_cvt_pk_bf16_f32 v88, v60, v61
  v_cvt_pk_bf16_f32 v89, v62, v63
  v_cvt_pk_bf16_f32 v90, v64, v65
  v_cvt_pk_bf16_f32 v91, v66, v67
  s_waitcnt lgkmcnt(1)
  s_nop 1
  v_mfma_f32_32x32x16_bf16 v[92:107], v[28:31], v[84:87], v[92:107]
  v_mfma_f32_32x32x16_bf16 v[92:107], v[32:35], v[88:91], v[92:107]
  ds_read_b128 v[20:23], v113 offset:0
  ds_read_b128 v[24:27], v113 offset:512
  v_add_u32 v113, v113, v115
  s_waitcnt lgkmcnt(2)
  v_mfma_f32_32x32x16_bf16 v[52:67], v[16:19], v[4:7], v[68:83]
  ds_read_b128 v[12:15], v112 offset:14336
  v_exp_f32 v36, v36
  v_exp_f32 v37, v37
  v_exp_f32 v38, v38
  v_exp_f32 v39, v39
  v_exp_f32 v40, v40
  v_exp_f32 v41, v41
  v_exp_f32 v42, v42
  v_exp_f32 v43, v43
  v_exp_f32 v44, v44
  v_exp_f32 v45, v45
  v_exp_f32 v46, v46
  v_exp_f32 v47, v47
  v_exp_f32 v48, v48
  v_exp_f32 v49, v49
  v_exp_f32 v50, v50
  v_exp_f32 v51, v51
  v_cvt_pk_bf16_f32 v84, v36, v37
  v_cvt_pk_bf16_f32 v85, v38, v39
  v_cvt_pk_bf16_f32 v86, v40, v41
  v_cvt_pk_bf16_f32 v87, v42, v43
  v_cvt_pk_bf16_f32 v88, v44, v45
  v_cvt_pk_bf16_f32 v89, v46, v47
  v_cvt_pk_bf16_f32 v90, v48, v49
  v_cvt_pk_bf16_f32 v91, v50, v51
  s_waitcnt lgkmcnt(1)
  s_nop 1
  v_mfma_f32_32x32x16_bf16 v[92:107], v[20:23], v[84:87], v[92:107]
  v_mfma_f32_32x32x16_bf16 v[92:107], v[24:27], v[88:91], v[92:107]
  ds_read_b128 v[28:31], v113 offset:0
  ds_read_b128 v[32:35], v113 offset:512
  v_add_u32 v113, v113, v115
  s_waitcnt lgkmcnt(2)
  v_mfma_f32_32x32x16_bf16 v[36:51], v[12:15], v[4:7], v[68:83]
  ds_read_b128 v[16:19], v112 offset:15360
  v_exp_f32 v52, v52
  v_exp_f32 v53, v53
  v_exp_f32 v54, v54
  v_exp_f32 v55, v55
  v_exp_f32 v56, v56
  v_exp_f32 v57, v57
  v_exp_f32 v58, v58
  v_exp_f32 v59, v59
  v_exp_f32 v60, v60
  v_exp_f32 v61, v61
  v_exp_f32 v62, v62
  v_exp_f32 v63, v63
  v_exp_f32 v64, v64
  v_exp_f32 v65, v65
  v_exp_f32 v66, v66
  v_exp_f32 v67, v67
  v_cvt_pk_bf16_f32 v84, v52, v53
  v_cvt_pk_bf16_f32 v85, v54, v55
  v_cvt_pk_bf16_f32 v86, v56, v57
  v_cvt_pk_bf16_f32 v87, v58, v59
  v_cvt_pk_bf16_f32 v88, v60, v61
  v_cvt_pk_bf16_f32 v89, v62, v63
  v_cvt_pk_bf16_f32 v90, v64, v65
  v_cvt_pk_bf16_f32 v91, v66, v67
  s_waitcnt lgkmcnt(1)
  s_nop 1
  v_mfma_f32_32x32x16_bf16 v[92:107], v[28:31], v[84:87], v[92:107]
  v_mfma_f32_32x32x16_bf16 v[92:107], v[32:35], v[88:91], v[92:107]
  ds_read_b128 v[20:23], v113 offset:0
  ds_read_b128 v[24:27], v113 offset:512
  v_add_u32 v113, v113, v115
  s_waitcnt lgkmcnt(2)
  v_mfma_f32_32x32x16_bf16 v[52:67], v[16:19], v[4:7], v[68:83]
  ds_read_b128 v[12:15], v112 offset:16384
  v_exp_f32 v36, v36
  v_exp_f32 v37, v37
  v_exp_f32 v38, v38
  v_exp_f32 v39, v39
  v_exp_f32 v40, v40
  v_exp_f32 v41, v41
  v_exp_f32 v42, v42
  v_exp_f32 v43, v43
  v_exp_f32 v44, v44
  v_exp_f32 v45, v45
  v_exp_f32 v46, v46
  v_exp_f32 v47, v47
  v_exp_f32 v48, v48
  v_exp_f32 v49, v49
  v_exp_f32 v50, v50
  v_exp_f32 v51, v51
  v_cvt_pk_bf16_f32 v84, v36, v37
  v_cvt_pk_bf16_f32 v85, v38, v39
  v_cvt_pk_bf16_f32 v86, v40, v41
  v_cvt_pk_bf16_f32 v87, v42, v43
  v_cvt_pk_bf16_f32 v88, v44, v45
  v_cvt_pk_bf16_f32 v89, v46, v47
  v_cvt_pk_bf16_f32 v90, v48, v49
  v_cvt_pk_bf16_f32 v91, v50, v51
  s_waitcnt lgkmcnt(1)
  s_nop 1
  v_mfma_f32_32x32x16_bf16 v[92:107], v[20:23], v[84:87], v[92:107]
  v_mfma_f32_32x32x16_bf16 v[92:107], v[24:27], v[88:91], v[92:107]
  ds_read_b128 v[28:31], v113 offset:0
  ds_read_b128 v[32:35], v113 offset:512
  v_add_u32 v113, v113, v115
  s_waitcnt lgkmcnt(2)
  v_mfma_f32_32x32x16_bf16 v[36:51], v[12:15], v[4:7], v[68:83]
  ds_read_b128 v[16:19], v112 offset:17408
  v_exp_f32 v52, v52
  v_exp_f32 v53, v53
  v_exp_f32 v54, v54
  v_exp_f32 v55, v55
  v_exp_f32 v56, v56
  v_exp_f32 v57, v57
  v_exp_f32 v58, v58
  v_exp_f32 v59, v59
  v_exp_f32 v60, v60
  v_exp_f32 v61, v61
  v_exp_f32 v62, v62
  v_exp_f32 v63, v63
  v_exp_f32 v64, v64
  v_exp_f32 v65, v65
  v_exp_f32 v66, v66
  v_exp_f32 v67, v67
  v_cvt_pk_bf16_f32 v84, v52, v53
  v_cvt_pk_bf16_f32 v85, v54, v55
  v_cvt_pk_bf16_f32 v86, v56, v57
  v_cvt_pk_bf16_f32 v87, v58, v59
  v_cvt_pk_bf16_f32 v88, v60, v61
  v_cvt_pk_bf16_f32 v89, v62, v63
  v_cvt_pk_bf16_f32 v90, v64, v65
  v_cvt_pk_bf16_f32 v91, v66, v67
  s_waitcnt lgkmcnt(1)
  s_nop 1
  v_mfma_f32_32x32x16_bf16 v[92:107], v[28:31], v[84:87], v[92:107]
  v_mfma_f32_32x32x16_bf16 v[92:107], v[32:35], v[88:91], v[92:107]
  ds_read_b128 v[20:23], v113 offset:0
  ds_read_b128 v[24:27], v113 offset:512
  v_add_u32 v113, v113, v115
  s_waitcnt lgkmcnt(2)
  v_mfma_f32_32x32x16_bf16 v[52:67], v[16:19], v[4:7], v[68:83]
  ds_read_b128 v[12:15], v112 offset:18432
  v_exp_f32 v36, v36
  v_exp_f32 v37, v37
  v_exp_f32 v38, v38
  v_exp_f32 v39, v39
  v_exp_f32 v40, v40
  v_exp_f32 v41, v41
  v_exp_f32 v42, v42
  v_exp_f32 v43, v43
  v_exp_f32 v44, v44
  v_exp_f32 v45, v45
  v_exp_f32 v46, v46
  v_exp_f32 v47, v47
  v_exp_f32 v48, v48
  v_exp_f32 v49, v49
  v_exp_f32 v50, v50
  v_exp_f32 v51, v51
  v_cvt_pk_bf16_f32 v84, v36, v37
  v_cvt_pk_bf16_f32 v85, v38, v39
  v_cvt_pk_bf16_f32 v86, v40, v41
  v_cvt_pk_bf16_f32 v87, v42, v43
  v_cvt_pk_bf16_f32 v88, v44, v45
  v_cvt_pk_bf16_f32 v89, v46, v47
  v_cvt_pk_bf16_f32 v90, v48, v49
  v_cvt_pk_bf16_f32 v91, v50, v51
  s_waitcnt lgkmcnt(1)
  s_nop 1
  v_mfma_f32_32x32x16_bf16 v[92:107], v[20:23], v[84:87], v[92:107]
  v_mfma_f32_32x32x16_bf16 v[92:107], v[24:27], v[88:91], v[92:107]
  ds_read_b128 v[28:31], v113 offset:0
  ds_read_b128 v[32:35], v113 offset:512
  v_add_u32 v113, v113, v115
  s_waitcnt lgkmcnt(2)
  v_mfma_f32_32x32x16_bf16 v[36:51], v[12:15], v[4:7], v[68:83]
  ds_read_b128 v[16:19], v112 offset:19456
  v_exp_f32 v52, v52
  v_exp_f32 v53, v53
  v_exp_f32 v54, v54
  v_exp_f32 v55, v55
  v_exp_f32 v56, v56
  v_exp_f32 v57, v57
  v_exp_f32 v58, v58
  v_exp_f32 v59, v59
  v_exp_f32 v60, v60
  v_exp_f32 v61, v61
  v_exp_f32 v62, v62
  v_exp_f32 v63, v63
  v_exp_f32 v64, v64
  v_exp_f32 v65, v65
  v_exp_f32 v66, v66
  v_exp_f32 v67, v67
  v_cvt_pk_bf16_f32 v84, v52, v53
  v_cvt_pk_bf16_f32 v85, v54, v55
  v_cvt_pk_bf16_f32 v86, v56, v57
  v_cvt_pk_bf16_f32 v87, v58, v59
  v_cvt_pk_bf16_f32 v88, v60, v61
  v_cvt_pk_bf16_f32 v89, v62, v63
  v_cvt_pk_bf16_f32 v90, v64, v65
  v_cvt_pk_bf16_f32 v91, v66, v67
  s_waitcnt lgkmcnt(1)
  s_nop 1
  v_mfma_f32_32x32x16_bf16 v[92:107], v[28:31], v[84:87], v[92:107]
  v_mfma_f32_32x32x16_bf16 v[92:107], v[32:35], v[88:91], v[92:107]
  ds_read_b128 v[20:23], v113 offset:0
  ds_read_b128 v[24:27], v113 offset:512
  v_add_u32 v113, v113, v115
  s_waitcnt lgkmcnt(2)
  v_mfma_f32_32x32x16_bf16 v[52:67], v[16:19], v[4:7], v[68:83]
  ds_read_b128 v[12:15], v112 offset:20480
  v_exp_f32 v36, v36
  v_exp_f32 v37, v37
  v_exp_f32 v38, v38
  v_exp_f32 v39, v39
  v_exp_f32 v40, v40
  v_exp_f32 v41, v41
  v_exp_f32 v42, v42
  v_exp_f32 v43, v43
  v_exp_f32 v44, v44
  v_exp_f32 v45, v45
  v_exp_f32 v46, v46
  v_exp_f32 v47, v47
  v_exp_f32 v48, v48
  v_exp_f32 v49, v49
  v_exp_f32 v50, v50
  v_exp_f32 v51, v51
  v_cvt_pk_bf16_f32 v84, v36, v37
  v_cvt_pk_bf16_f32 v85, v38, v39
  v_cvt_pk_bf16_f32 v86, v40, v41
  v_cvt_pk_bf16_f32 v87, v42, v43
  v_cvt_pk_bf16_f32 v88, v44, v45
  v_cvt_pk_bf16_f32 v89, v46, v47
  v_cvt_pk_bf16_f32 v90, v48, v49
  v_cvt_pk_bf16_f32 v91, v50, v51
  s_waitcnt lgkmcnt(1)
  s_nop 1
  v_mfma_f32_32x32x16_bf16 v[92:107], v[20:23], v[84:87], v[92:107]
  v_mfma_f32_32x32x16_bf16 v[92:107], v[24:27], v[88:91], v[92:107]
  ds_read_b128 v[28:31], v113 offset:0
  ds_read_b128 v[32:35], v113 offset:512
  v_add_u32 v113, v113, v115
  s_waitcnt lgkmcnt(2)
  v_mfma_f32_32x32x16_bf16 v[36:51], v[12:15], v[4:7], v[68:83]
  ds_read_b128 v[16:19], v112 offset:21504
  v_exp_f32 v52, v52
  v_exp_f32 v53, v53
  v_exp_f32 v54, v54
  v_exp_f32 v55, v55
  v_exp_f32 v56, v56
  v_exp_f32 v57, v57
  v_exp_f32 v58, v58
  v_exp_f32 v59, v59
  v_exp_f32 v60, v60
  v_exp_f32 v61, v61
  v_exp_f32 v62, v62
  v_exp_f32 v63, v63
  v_exp_f32 v64, v64
  v_exp_f32 v65, v65
  v_exp_f32 v66, v66
  v_exp_f32 v67, v67
  v_cvt_pk_bf16_f32 v84, v52, v53
  v_cvt_pk_bf16_f32 v85, v54, v55
  v_cvt_pk_bf16_f32 v86, v56, v57
  v_cvt_pk_bf16_f32 v87, v58, v59
  v_cvt_pk_bf16_f32 v88, v60, v61
  v_cvt_pk_bf16_f32 v89, v62, v63
  v_cvt_pk_bf16_f32 v90, v64, v65
  v_cvt_pk_bf16_f32 v91, v66, v67
  s_waitcnt lgkmcnt(1)
  s_nop 1
  v_mfma_f32_32x32x16_bf16 v[92:107], v[28:31], v[84:87], v[92:107]
  v_mfma_f32_32x32x16_bf16 v[92:107], v[32:35], v[88:91], v[92:107]
  ds_read_b128 v[20:23], v113 offset:0
  ds_read_b128 v[24:27], v113 offset:512
  v_add_u32 v113, v113, v115
  s_waitcnt lgkmcnt(2)
  v_mfma_f32_32x32x16_bf16 v[52:67], v[16:19], v[4:7], v[68:83]
  ds_read_b128 v[12:15], v112 offset:22528
  v_exp_f32 v36, v36
  v_exp_f32 v37, v37
  v_exp_f32 v38, v38
  v_exp_f32 v39, v39
  v_exp_f32 v40, v40
  v_exp_f32 v41, v41
  v_exp_f32 v42, v42
  v_exp_f32 v43, v43
  v_exp_f32 v44, v44
  v_exp_f32 v45, v45
  v_exp_f32 v46, v46
  v_exp_f32 v47, v47
  v_exp_f32 v48, v48
  v_exp_f32 v49, v49
  v_exp_f32 v50, v50
  v_exp_f32 v51, v51
  v_cvt_pk_bf16_f32 v84, v36, v37
  v_cvt_pk_bf16_f32 v85, v38, v39
  v_cvt_pk_bf16_f32 v86, v40, v41
  v_cvt_pk_bf16_f32 v87, v42, v43
  v_cvt_pk_bf16_f32 v88, v44, v45
  v_cvt_pk_bf16_f32 v89, v46, v47
  v_cvt_pk_bf16_f32 v90, v48, v49
  v_cvt_pk_bf16_f32 v91, v50, v51
  s_waitcnt lgkmcnt(1)
  s_nop 1
  v_mfma_f32_32x32x16_bf16 v[92:107], v[20:23], v[84:87], v[92:107]
  v_mfma_f32_32x32x16_bf16 v[92:107], v[24:27], v[88:91], v[92:107]
  ds_read_b128 v[28:31], v113 offset:0
  ds_read_b128 v[32:35], v113 offset:512
  v_add_u32 v113, v113, v115
  s_waitcnt lgkmcnt(2)
  v_mfma_f32_32x32x16_bf16 v[36:51], v[12:15], v[4:7], v[68:83]
  ds_read_b128 v[16:19], v112 offset:23552
  v_exp_f32 v52, v52
  v_exp_f32 v53, v53
  v_exp_f32 v54, v54
  v_exp_f32 v55, v55
  v_exp_f32 v56, v56
  v_exp_f32 v57, v57
  v_exp_f32 v58, v58
  v_exp_f32 v59, v59
  v_exp_f32 v60, v60
  v_exp_f32 v61, v61
  v_exp_f32 v62, v62
  v_exp_f32 v63, v63
  v_exp_f32 v64, v64
  v_exp_f32 v65, v65
  v_exp_f32 v66, v66
  v_exp_f32 v67, v67
  v_cvt_pk_bf16_f32 v84, v52, v53
  v_cvt_pk_bf16_f32 v85, v54, v55
  v_cvt_pk_bf16_f32 v86, v56, v57
  v_cvt_pk_bf16_f32 v87, v58, v59
  v_cvt_pk_bf16_f32 v88, v60, v61
  v_cvt_pk_bf16_f32 v89, v62, v63
  v_cvt_pk_bf16_f32 v90, v64, v65
  v_cvt_pk_bf16_f32 v91, v66, v67
  s_waitcnt lgkmcnt(1)
  s_nop 1
  v_mfma_f32_32x32x16_bf16 v[92:107], v[28:31], v[84:87], v[92:107]
  v_mfma_f32_32x32x16_bf16 v[92:107], v[32:35], v[88:91], v[92:107]
  ds_read_b128 v[20:23], v113 offset:0
  ds_read_b128 v[24:27], v113 offset:512
  v_add_u32 v113, v113, v115
  s_waitcnt lgkmcnt(2)
  v_mfma_f32_32x32x16_bf16 v[52:67], v[16:19], v[4:7], v[68:83]
  ds_read_b128 v[12:15], v112 offset:24576
  v_exp_f32 v36, v36
  v_exp_f32 v37, v37
  v_exp_f32 v38, v38
  v_exp_f32 v39, v39
  v_exp_f32 v40, v40
  v_exp_f32 v41, v41
  v_exp_f32 v42, v42
  v_exp_f32 v43, v43
  v_exp_f32 v44, v44
  v_exp_f32 v45, v45
  v_exp_f32 v46, v46
  v_exp_f32 v47, v47
  v_exp_f32 v48, v48
  v_exp_f32 v49, v49
  v_exp_f32 v50, v50
  v_exp_f32 v51, v51
  v_cvt_pk_bf16_f32 v84, v36, v37
  v_cvt_pk_bf16_f32 v85, v38, v39
  v_cvt_pk_bf16_f32 v86, v40, v41
  v_cvt_pk_bf16_f32 v87, v42, v43
  v_cvt_pk_bf16_f32 v88, v44, v45
  v_cvt_pk_bf16_f32 v89, v46, v47
  v_cvt_pk_bf16_f32 v90, v48, v49
  v_cvt_pk_bf16_f32 v91, v50, v51
  s_waitcnt lgkmcnt(1)
  s_nop 1
  v_mfma_f32_32x32x16_bf16 v[92:107], v[20:23], v[84:87], v[92:107]
  v_mfma_f32_32x32x16_bf16 v[92:107], v[24:27], v[88:91], v[92:107]
  ds_read_b128 v[28:31], v113 offset:0
  ds_read_b128 v[32:35], v113 offset:512
  v_add_u32 v113, v113, v115
  s_waitcnt lgkmcnt(2)
  v_mfma_f32_32x32x16_bf16 v[36:51], v[12:15], v[4:7], v[68:83]
  ds_read_b128 v[16:19], v112 offset:25600
  v_exp_f32 v52, v52
  v_exp_f32 v53, v53
  v_exp_f32 v54, v54
  v_exp_f32 v55, v55
  v_exp_f32 v56, v56
  v_exp_f32 v57, v57
  v_exp_f32 v58, v58
  v_exp_f32 v59, v59
  v_exp_f32 v60, v60
  v_exp_f32 v61, v61
  v_exp_f32 v62, v62
  v_exp_f32 v63, v63
  v_exp_f32 v64, v64
  v_exp_f32 v65, v65
  v_exp_f32 v66, v66
  v_exp_f32 v67, v67
  v_cvt_pk_bf16_f32 v84, v52, v53
  v_cvt_pk_bf16_f32 v85, v54, v55
  v_cvt_pk_bf16_f32 v86, v56, v57
  v_cvt_pk_bf16_f32 v87, v58, v59
  v_cvt_pk_bf16_f32 v88, v60, v61
  v_cvt_pk_bf16_f32 v89, v62, v63
  v_cvt_pk_bf16_f32 v90, v64, v65
  v_cvt_pk_bf16_f32 v91, v66, v67
  s_waitcnt lgkmcnt(1)
  s_nop 1
  v_mfma_f32_32x32x16_bf16 v[92:107], v[28:31], v[84:87], v[92:107]
  v_mfma_f32_32x32x16_bf16 v[92:107], v[32:35], v[88:91], v[92:107]
  ds_read_b128 v[20:23], v113 offset:0
  ds_read_b128 v[24:27], v113 offset:512
  v_add_u32 v113, v113, v115
  s_waitcnt lgkmcnt(2)
  v_mfma_f32_32x32x16_bf16 v[52:67], v[16:19], v[4:7], v[68:83]
  ds_read_b128 v[12:15], v112 offset:26624
  v_exp_f32 v36, v36
  v_exp_f32 v37, v37
  v_exp_f32 v38, v38
  v_exp_f32 v39, v39
  v_exp_f32 v40, v40
  v_exp_f32 v41, v41
  v_exp_f32 v42, v42
  v_exp_f32 v43, v43
  v_exp_f32 v44, v44
  v_exp_f32 v45, v45
  v_exp_f32 v46, v46
  v_exp_f32 v47, v47
  v_exp_f32 v48, v48
  v_exp_f32 v49, v49
  v_exp_f32 v50, v50
  v_exp_f32 v51, v51
  v_cvt_pk_bf16_f32 v84, v36, v37
  v_cvt_pk_bf16_f32 v85, v38, v39
  v_cvt_pk_bf16_f32 v86, v40, v41
  v_cvt_pk_bf16_f32 v87, v42, v43
  v_cvt_pk_bf16_f32 v88, v44, v45
  v_cvt_pk_bf16_f32 v89, v46, v47
  v_cvt_pk_bf16_f32 v90, v48, v49
  v_cvt_pk_bf16_f32 v91, v50, v51
  s_waitcnt lgkmcnt(1)
  s_nop 1
  v_mfma_f32_32x32x16_bf16 v[92:107], v[20:23], v[84:87], v[92:107]
  v_mfma_f32_32x32x16_bf16 v[92:107], v[24:27], v[88:91], v[92:107]
  ds_read_b128 v[28:31], v113 offset:0
  ds_read_b128 v[32:35], v113 offset:512
  v_add_u32 v113, v113, v115
  s_waitcnt lgkmcnt(2)
  v_mfma_f32_32x32x16_bf16 v[36:51], v[12:15], v[4:7], v[68:83]
  ds_read_b128 v[16:19], v112 offset:27648
  v_exp_f32 v52, v52
  v_exp_f32 v53, v53
  v_exp_f32 v54, v54
  v_exp_f32 v55, v55
  v_exp_f32 v56, v56
  v_exp_f32 v57, v57
  v_exp_f32 v58, v58
  v_exp_f32 v59, v59
  v_exp_f32 v60, v60
  v_exp_f32 v61, v61
  v_exp_f32 v62, v62
  v_exp_f32 v63, v63
  v_exp_f32 v64, v64
  v_exp_f32 v65, v65
  v_exp_f32 v66, v66
  v_exp_f32 v67, v67
  v_cvt_pk_bf16_f32 v84, v52, v53
  v_cvt_pk_bf16_f32 v85, v54, v55
  v_cvt_pk_bf16_f32 v86, v56, v57
  v_cvt_pk_bf16_f32 v87, v58, v59
  v_cvt_pk_bf16_f32 v88, v60, v61
  v_cvt_pk_bf16_f32 v89, v62, v63
  v_cvt_pk_bf16_f32 v90, v64, v65
  v_cvt_pk_bf16_f32 v91, v66, v67
  s_waitcnt lgkmcnt(1)
  s_nop 1
  v_mfma_f32_32x32x16_bf16 v[92:107], v[28:31], v[84:87], v[92:107]
  v_mfma_f32_32x32x16_bf16 v[92:107], v[32:35], v[88:91], v[92:107]
  ds_read_b128 v[20:23], v113 offset:0
  ds_read_b128 v[24:27], v113 offset:512
  v_add_u32 v113, v113, v115
  s_waitcnt lgkmcnt(2)
  v_mfma_f32_32x32x16_bf16 v[52:67], v[16:19], v[4:7], v[68:83]
  ds_read_b128 v[12:15], v112 offset:28672
  v_exp_f32 v36, v36
  v_exp_f32 v37, v37
  v_exp_f32 v38, v38
  v_exp_f32 v39, v39
  v_exp_f32 v40, v40
  v_exp_f32 v41, v41
  v_exp_f32 v42, v42
  v_exp_f32 v43, v43
  v_exp_f32 v44, v44
  v_exp_f32 v45, v45
  v_exp_f32 v46, v46
  v_exp_f32 v47, v47
  v_exp_f32 v48, v48
  v_exp_f32 v49, v49
  v_exp_f32 v50, v50
  v_exp_f32 v51, v51
  v_cvt_pk_bf16_f32 v84, v36, v37
  v_cvt_pk_bf16_f32 v85, v38, v39
  v_cvt_pk_bf16_f32 v86, v40, v41
  v_cvt_pk_bf16_f32 v87, v42, v43
  v_cvt_pk_bf16_f32 v88, v44, v45
  v_cvt_pk_bf16_f32 v89, v46, v47
  v_cvt_pk_bf16_f32 v90, v48, v49
  v_cvt_pk_bf16_f32 v91, v50, v51
  s_waitcnt lgkmcnt(1)
  s_nop 1
  v_mfma_f32_32x32x16_bf16 v[92:107], v[20:23], v[84:87], v[92:107]
  v_mfma_f32_32x32x16_bf16 v[92:107], v[24:27], v[88:91], v[92:107]
  ds_read_b128 v[28:31], v113 offset:0
  ds_read_b128 v[32:35], v113 offset:512
  v_add_u32 v113, v113, v115
  s_waitcnt lgkmcnt(2)
  v_mfma_f32_32x32x16_bf16 v[36:51], v[12:15], v[4:7], v[68:83]
  ds_read_b128 v[16:19], v112 offset:29696
  v_exp_f32 v52, v52
  v_exp_f32 v53, v53
  v_exp_f32 v54, v54
  v_exp_f32 v55, v55
  v_exp_f32 v56, v56
  v_exp_f32 v57, v57
  v_exp_f32 v58, v58
  v_exp_f32 v59, v59
  v_exp_f32 v60, v60
  v_exp_f32 v61, v61
  v_exp_f32 v62, v62
  v_exp_f32 v63, v63
  v_exp_f32 v64, v64
  v_exp_f32 v65, v65
  v_exp_f32 v66, v66
  v_exp_f32 v67, v67
  v_cvt_pk_bf16_f32 v84, v52, v53
  v_cvt_pk_bf16_f32 v85, v54, v55
  v_cvt_pk_bf16_f32 v86, v56, v57
  v_cvt_pk_bf16_f32 v87, v58, v59
  v_cvt_pk_bf16_f32 v88, v60, v61
  v_cvt_pk_bf16_f32 v89, v62, v63
  v_cvt_pk_bf16_f32 v90, v64, v65
  v_cvt_pk_bf16_f32 v91, v66, v67
  s_waitcnt lgkmcnt(1)
  s_nop 1
  v_mfma_f32_32x32x16_bf16 v[92:107], v[28:31], v[84:87], v[92:107]
  v_mfma_f32_32x32x16_bf16 v[92:107], v[32:35], v[88:91], v[92:107]
  ds_read_b128 v[20:23], v113 offset:0
  ds_read_b128 v[24:27], v113 offset:512
  v_add_u32 v113, v113, v115
  s_waitcnt lgkmcnt(2)
  v_mfma_f32_32x32x16_bf16 v[52:67], v[16:19], v[4:7], v[68:83]
  ds_read_b128 v[12:15], v112 offset:30720
  v_exp_f32 v36, v36
  v_exp_f32 v37, v37
  v_exp_f32 v38, v38
  v_exp_f32 v39, v39
  v_exp_f32 v40, v40
  v_exp_f32 v41, v41
  v_exp_f32 v42, v42
  v_exp_f32 v43, v43
  v_exp_f32 v44, v44
  v_exp_f32 v45, v45
  v_exp_f32 v46, v46
  v_exp_f32 v47, v47
  v_exp_f32 v48, v48
  v_exp_f32 v49, v49
  v_exp_f32 v50, v50
  v_exp_f32 v51, v51
  v_cvt_pk_bf16_f32 v84, v36, v37
  v_cvt_pk_bf16_f32 v85, v38, v39
  v_cvt_pk_bf16_f32 v86, v40, v41
  v_cvt_pk_bf16_f32 v87, v42, v43
  v_cvt_pk_bf16_f32 v88, v44, v45
  v_cvt_pk_bf16_f32 v89, v46, v47
  v_cvt_pk_bf16_f32 v90, v48, v49
  v_cvt_pk_bf16_f32 v91, v50, v51
  s_waitcnt lgkmcnt(1)
  s_nop 1
  v_mfma_f32_32x32x16_bf16 v[92:107], v[20:23], v[84:87], v[92:107]
  v_mfma_f32_32x32x16_bf16 v[92:107], v[24:27], v[88:91], v[92:107]
  ds_read_b128 v[28:31], v113 offset:0
  ds_read_b128 v[32:35], v113 offset:512
  v_add_u32 v113, v113, v115
  s_waitcnt lgkmcnt(2)
  v_mfma_f32_32x32x16_bf16 v[36:51], v[12:15], v[4:7], v[68:83]
  ds_read_b128 v[16:19], v112 offset:31744
  v_exp_f32 v52, v52
  v_exp_f32 v53, v53
  v_exp_f32 v54, v54
  v_exp_f32 v55, v55
  v_exp_f32 v56, v56
  v_exp_f32 v57, v57
  v_exp_f32 v58, v58
  v_exp_f32 v59, v59
  v_exp_f32 v60, v60
  v_exp_f32 v61, v61
  v_exp_f32 v62, v62
  v_exp_f32 v63, v63
  v_exp_f32 v64, v64
  v_exp_f32 v65, v65
  v_exp_f32 v66, v66
  v_exp_f32 v67, v67
  v_cvt_pk_bf16_f32 v84, v52, v53
  v_cvt_pk_bf16_f32 v85, v54, v55
  v_cvt_pk_bf16_f32 v86, v56, v57
  v_cvt_pk_bf16_f32 v87, v58, v59
  v_cvt_pk_bf16_f32 v88, v60, v61
  v_cvt_pk_bf16_f32 v89, v62, v63
  v_cvt_pk_bf16_f32 v90, v64, v65
  v_cvt_pk_bf16_f32 v91, v66, v67
  s_waitcnt lgkmcnt(1)
  s_nop 1
  v_mfma_f32_32x32x16_bf16 v[92:107], v[28:31], v[84:87], v[92:107]
  v_mfma_f32_32x32x16_bf16 v[92:107], v[32:35], v[88:91], v[92:107]
  ds_read_b128 v[20:23], v113 offset:0
  ds_read_b128 v[24:27], v113 offset:512
  v_add_u32 v113, v113, v115
  s_waitcnt lgkmcnt(2)
  v_mfma_f32_32x32x16_bf16 v[52:67], v[16:19], v[4:7], v[68:83]
  ds_read_b128 v[12:15], v112 offset:32768
  v_exp_f32 v36, v36
  v_exp_f32 v37, v37
  v_exp_f32 v38, v38
  v_exp_f32 v39, v39
  v_exp_f32 v40, v40
  v_exp_f32 v41, v41
  v_exp_f32 v42, v42
  v_exp_f32 v43, v43
  v_exp_f32 v44, v44
  v_exp_f32 v45, v45
  v_exp_f32 v46, v46
  v_exp_f32 v47, v47
  v_exp_f32 v48, v48
  v_exp_f32 v49, v49
  v_exp_f32 v50, v50
  v_exp_f32 v51, v51
  v_cvt_pk_bf16_f32 v84, v36, v37
  v_cvt_pk_bf16_f32 v85, v38, v39
  v_cvt_pk_bf16_f32 v86, v40, v41
  v_cvt_pk_bf16_f32 v87, v42, v43
  v_cvt_pk_bf16_f32 v88, v44, v45
  v_cvt_pk_bf16_f32 v89, v46, v47
  v_cvt_pk_bf16_f32 v90, v48, v49
  v_cvt_pk_bf16_f32 v91, v50, v51
  s_waitcnt lgkmcnt(1)
  s_nop 1
  v_mfma_f32_32x32x16_bf16 v[92:107], v[20:23], v[84:87], v[92:107]
  v_mfma_f32_32x32x16_bf16 v[92:107], v[24:27], v[88:91], v[92:107]
  ds_read_b128 v[28:31], v113 offset:0
  ds_read_b128 v[32:35], v113 offset:512
  v_add_u32 v113, v113, v115
  s_waitcnt lgkmcnt(2)
  v_mfma_f32_32x32x16_bf16 v[36:51], v[12:15], v[4:7], v[68:83]
  ds_read_b128 v[16:19], v112 offset:33792
  v_exp_f32 v52, v52
  v_exp_f32 v53, v53
  v_exp_f32 v54, v54
  v_exp_f32 v55, v55
  v_exp_f32 v56, v56
  v_exp_f32 v57, v57
  v_exp_f32 v58, v58
  v_exp_f32 v59, v59
  v_exp_f32 v60, v60
  v_exp_f32 v61, v61
  v_exp_f32 v62, v62
  v_exp_f32 v63, v63
  v_exp_f32 v64, v64
  v_exp_f32 v65, v65
  v_exp_f32 v66, v66
  v_exp_f32 v67, v67
  v_cvt_pk_bf16_f32 v84, v52, v53
  v_cvt_pk_bf16_f32 v85, v54, v55
  v_cvt_pk_bf16_f32 v86, v56, v57
  v_cvt_pk_bf16_f32 v87, v58, v59
  v_cvt_pk_bf16_f32 v88, v60, v61
  v_cvt_pk_bf16_f32 v89, v62, v63
  v_cvt_pk_bf16_f32 v90, v64, v65
  v_cvt_pk_bf16_f32 v91, v66, v67
  s_waitcnt lgkmcnt(1)
  s_nop 1
  v_mfma_f32_32x32x16_bf16 v[92:107], v[28:31], v[84:87], v[92:107]
  v_mfma_f32_32x32x16_bf16 v[92:107], v[32:35], v[88:91], v[92:107]
  ds_read_b128 v[20:23], v113 offset:0
  ds_read_b128 v[24:27], v113 offset:512
  v_add_u32 v113, v113, v115
  s_waitcnt lgkmcnt(2)
  v_mfma_f32_32x32x16_bf16 v[52:67], v[16:19], v[4:7], v[68:83]
  ds_read_b128 v[12:15], v112 offset:34816
  v_exp_f32 v36, v36
  v_exp_f32 v37, v37
  v_exp_f32 v38, v38
  v_exp_f32 v39, v39
  v_exp_f32 v40, v40
  v_exp_f32 v41, v41
  v_exp_f32 v42, v42
  v_exp_f32 v43, v43
  v_exp_f32 v44, v44
  v_exp_f32 v45, v45
  v_exp_f32 v46, v46
  v_exp_f32 v47, v47
  v_exp_f32 v48, v48
  v_exp_f32 v49, v49
  v_exp_f32 v50, v50
  v_exp_f32 v51, v51
  v_cvt_pk_bf16_f32 v84, v36, v37
  v_cvt_pk_bf16_f32 v85, v38, v39
  v_cvt_pk_bf16_f32 v86, v40, v41
  v_cvt_pk_bf16_f32 v87, v42, v43
  v_cvt_pk_bf16_f32 v88, v44, v45
  v_cvt_pk_bf16_f32 v89, v46, v47
  v_cvt_pk_bf16_f32 v90, v48, v49
  v_cvt_pk_bf16_f32 v91, v50, v51
  s_waitcnt lgkmcnt(1)
  s_nop 1
  v_mfma_f32_32x32x16_bf16 v[92:107], v[20:23], v[84:87], v[92:107]
  v_mfma_f32_32x32x16_bf16 v[92:107], v[24:27], v[88:91], v[92:107]
  ds_read_b128 v[28:31], v113 offset:0
  ds_read_b128 v[32:35], v113 offset:512
  v_add_u32 v113, v113, v115
  s_waitcnt lgkmcnt(2)
  v_mfma_f32_32x32x16_bf16 v[36:51], v[12:15], v[4:7], v[68:83]
  ds_read_b128 v[16:19], v112 offset:35840
  v_exp_f32 v52, v52
  v_exp_f32 v53, v53
  v_exp_f32 v54, v54
  v_exp_f32 v55, v55
  v_exp_f32 v56, v56
  v_exp_f32 v57, v57
  v_exp_f32 v58, v58
  v_exp_f32 v59, v59
  v_exp_f32 v60, v60
  v_exp_f32 v61, v61
  v_exp_f32 v62, v62
  v_exp_f32 v63, v63
  v_exp_f32 v64, v64
  v_exp_f32 v65, v65
  v_exp_f32 v66, v66
  v_exp_f32 v67, v67
  v_cvt_pk_bf16_f32 v84, v52, v53
  v_cvt_pk_bf16_f32 v85, v54, v55
  v_cvt_pk_bf16_f32 v86, v56, v57
  v_cvt_pk_bf16_f32 v87, v58, v59
  v_cvt_pk_bf16_f32 v88, v60, v61
  v_cvt_pk_bf16_f32 v89, v62, v63
  v_cvt_pk_bf16_f32 v90, v64, v65
  v_cvt_pk_bf16_f32 v91, v66, v67
  s_waitcnt lgkmcnt(1)
  s_nop 1
  v_mfma_f32_32x32x16_bf16 v[92:107], v[28:31], v[84:87], v[92:107]
  v_mfma_f32_32x32x16_bf16 v[92:107], v[32:35], v[88:91], v[92:107]
  ds_read_b128 v[20:23], v113 offset:0
  ds_read_b128 v[24:27], v113 offset:512
  v_add_u32 v113, v113, v115
  s_waitcnt lgkmcnt(2)
  v_mfma_f32_32x32x16_bf16 v[52:67], v[16:19], v[4:7], v[68:83]
  ds_read_b128 v[12:15], v112 offset:36864
  v_exp_f32 v36, v36
  v_exp_f32 v37, v37
  v_exp_f32 v38, v38
  v_exp_f32 v39, v39
  v_exp_f32 v40, v40
  v_exp_f32 v41, v41
  v_exp_f32 v42, v42
  v_exp_f32 v43, v43
  v_exp_f32 v44, v44
  v_exp_f32 v45, v45
  v_exp_f32 v46, v46
  v_exp_f32 v47, v47
  v_exp_f32 v48, v48
  v_exp_f32 v49, v49
  v_exp_f32 v50, v50
  v_exp_f32 v51, v51
  v_cvt_pk_bf16_f32 v84, v36, v37
  v_cvt_pk_bf16_f32 v85, v38, v39
  v_cvt_pk_bf16_f32 v86, v40, v41
  v_cvt_pk_bf16_f32 v87, v42, v43
  v_cvt_pk_bf16_f32 v88, v44, v45
  v_cvt_pk_bf16_f32 v89, v46, v47
  v_cvt_pk_bf16_f32 v90, v48, v49
  v_cvt_pk_bf16_f32 v91, v50, v51
  s_waitcnt lgkmcnt(1)
  s_nop 1
  v_mfma_f32_32x32x16_bf16 v[92:107], v[20:23], v[84:87], v[92:107]
  v_mfma_f32_32x32x16_bf16 v[92:107], v[24:27], v[88:91], v[92:107]
  ds_read_b128 v[28:31], v113 offset:0
  ds_read_b128 v[32:35], v113 offset:512
  v_add_u32 v113, v113, v115
  s_waitcnt lgkmcnt(2)
  v_mfma_f32_32x32x16_bf16 v[36:51], v[12:15], v[4:7], v[68:83]
  ds_read_b128 v[16:19], v112 offset:37888
  v_exp_f32 v52, v52
  v_exp_f32 v53, v53
  v_exp_f32 v54, v54
  v_exp_f32 v55, v55
  v_exp_f32 v56, v56
  v_exp_f32 v57, v57
  v_exp_f32 v58, v58
  v_exp_f32 v59, v59
  v_exp_f32 v60, v60
  v_exp_f32 v61, v61
  v_exp_f32 v62, v62
  v_exp_f32 v63, v63
  v_exp_f32 v64, v64
  v_exp_f32 v65, v65
  v_exp_f32 v66, v66
  v_exp_f32 v67, v67
  v_cvt_pk_bf16_f32 v84, v52, v53
  v_cvt_pk_bf16_f32 v85, v54, v55
  v_cvt_pk_bf16_f32 v86, v56, v57
  v_cvt_pk_bf16_f32 v87, v58, v59
  v_cvt_pk_bf16_f32 v88, v60, v61
  v_cvt_pk_bf16_f32 v89, v62, v63
  v_cvt_pk_bf16_f32 v90, v64, v65
  v_cvt_pk_bf16_f32 v91, v66, v67
  s_waitcnt lgkmcnt(1)
  s_nop 1
  v_mfma_f32_32x32x16_bf16 v[92:107], v[28:31], v[84:87], v[92:107]
  v_mfma_f32_32x32x16_bf16 v[92:107], v[32:35], v[88:91], v[92:107]
  ds_read_b128 v[20:23], v113 offset:0
  ds_read_b128 v[24:27], v113 offset:512
  v_add_u32 v113, v113, v115
  s_waitcnt lgkmcnt(2)
  v_mfma_f32_32x32x16_bf16 v[52:67], v[16:19], v[4:7], v[68:83]
  ds_read_b128 v[12:15], v112 offset:38912
  v_exp_f32 v36, v36
  v_exp_f32 v37, v37
  v_exp_f32 v38, v38
  v_exp_f32 v39, v39
  v_exp_f32 v40, v40
  v_exp_f32 v41, v41
  v_exp_f32 v42, v42
  v_exp_f32 v43, v43
  v_exp_f32 v44, v44
  v_exp_f32 v45, v45
  v_exp_f32 v46, v46
  v_exp_f32 v47, v47
  v_exp_f32 v48, v48
  v_exp_f32 v49, v49
  v_exp_f32 v50, v50
  v_exp_f32 v51, v51
  v_cvt_pk_bf16_f32 v84, v36, v37
  v_cvt_pk_bf16_f32 v85, v38, v39
  v_cvt_pk_bf16_f32 v86, v40, v41
  v_cvt_pk_bf16_f32 v87, v42, v43
  v_cvt_pk_bf16_f32 v88, v44, v45
  v_cvt_pk_bf16_f32 v89, v46, v47
  v_cvt_pk_bf16_f32 v90, v48, v49
  v_cvt_pk_bf16_f32 v91, v50, v51
  s_waitcnt lgkmcnt(1)
  s_nop 1
  v_mfma_f32_32x32x16_bf16 v[92:107], v[20:23], v[84:87], v[92:107]
  v_mfma_f32_32x32x16_bf16 v[92:107], v[24:27], v[88:91], v[92:107]
  ds_read_b128 v[28:31], v113 offset:0
  ds_read_b128 v[32:35], v113 offset:512
  v_add_u32 v113, v113, v115
  s_waitcnt lgkmcnt(2)
  v_mfma_f32_32x32x16_bf16 v[36:51], v[12:15], v[4:7], v[68:83]
  ds_read_b128 v[16:19], v112 offset:39936
  v_exp_f32 v52, v52
  v_exp_f32 v53, v53
  v_exp_f32 v54, v54
  v_exp_f32 v55, v55
  v_exp_f32 v56, v56
  v_exp_f32 v57, v57
  v_exp_f32 v58, v58
  v_exp_f32 v59, v59
  v_exp_f32 v60, v60
  v_exp_f32 v61, v61
  v_exp_f32 v62, v62
  v_exp_f32 v63, v63
  v_exp_f32 v64, v64
  v_exp_f32 v65, v65
  v_exp_f32 v66, v66
  v_exp_f32 v67, v67
  v_cvt_pk_bf16_f32 v84, v52, v53
  v_cvt_pk_bf16_f32 v85, v54, v55
  v_cvt_pk_bf16_f32 v86, v56, v57
  v_cvt_pk_bf16_f32 v87, v58, v59
  v_cvt_pk_bf16_f32 v88, v60, v61
  v_cvt_pk_bf16_f32 v89, v62, v63
  v_cvt_pk_bf16_f32 v90, v64, v65
  v_cvt_pk_bf16_f32 v91, v66, v67
  s_waitcnt lgkmcnt(1)
  s_nop 1
  v_mfma_f32_32x32x16_bf16 v[92:107], v[28:31], v[84:87], v[92:107]
  v_mfma_f32_32x32x16_bf16 v[92:107], v[32:35], v[88:91], v[92:107]
  ds_read_b128 v[20:23], v113 offset:0
  ds_read_b128 v[24:27], v113 offset:512
  v_add_u32 v113, v113, v115
  s_waitcnt lgkmcnt(2)
  v_mfma_f32_32x32x16_bf16 v[52:67], v[16:19], v[4:7], v[68:83]
  ds_read_b128 v[12:15], v112 offset:40960
  v_exp_f32 v36, v36
  v_exp_f32 v37, v37
  v_exp_f32 v38, v38
  v_exp_f32 v39, v39
  v_exp_f32 v40, v40
  v_exp_f32 v41, v41
  v_exp_f32 v42, v42
  v_exp_f32 v43, v43
  v_exp_f32 v44, v44
  v_exp_f32 v45, v45
  v_exp_f32 v46, v46
  v_exp_f32 v47, v47
  v_exp_f32 v48, v48
  v_exp_f32 v49, v49
  v_exp_f32 v50, v50
  v_exp_f32 v51, v51
  v_cvt_pk_bf16_f32 v84, v36, v37
  v_cvt_pk_bf16_f32 v85, v38, v39
  v_cvt_pk_bf16_f32 v86, v40, v41
  v_cvt_pk_bf16_f32 v87, v42, v43
  v_cvt_pk_bf16_f32 v88, v44, v45
  v_cvt_pk_bf16_f32 v89, v46, v47
  v_cvt_pk_bf16_f32 v90, v48, v49
  v_cvt_pk_bf16_f32 v91, v50, v51
  s_waitcnt lgkmcnt(1)
  s_nop 1
  v_mfma_f32_32x32x16_bf16 v[92:107], v[20:23], v[84:87], v[92:107]
  v_mfma_f32_32x32x16_bf16 v[92:107], v[24:27], v[88:91], v[92:107]
  ds_read_b128 v[28:31], v113 offset:0
  ds_read_b128 v[32:35], v113 offset:512
  v_add_u32 v113, v113, v115
  s_waitcnt lgkmcnt(2)
  v_mfma_f32_32x32x16_bf16 v[36:51], v[12:15], v[4:7], v[68:83]
  ds_read_b128 v[16:19], v112 offset:41984
  v_exp_f32 v52, v52
  v_exp_f32 v53, v53
  v_exp_f32 v54, v54
  v_exp_f32 v55, v55
  v_exp_f32 v56, v56
  v_exp_f32 v57, v57
  v_exp_f32 v58, v58
  v_exp_f32 v59, v59
  v_exp_f32 v60, v60
  v_exp_f32 v61, v61
  v_exp_f32 v62, v62
  v_exp_f32 v63, v63
  v_exp_f32 v64, v64
  v_exp_f32 v65, v65
  v_exp_f32 v66, v66
  v_exp_f32 v67, v67
  v_cvt_pk_bf16_f32 v84, v52, v53
  v_cvt_pk_bf16_f32 v85, v54, v55
  v_cvt_pk_bf16_f32 v86, v56, v57
  v_cvt_pk_bf16_f32 v87, v58, v59
  v_cvt_pk_bf16_f32 v88, v60, v61
  v_cvt_pk_bf16_f32 v89, v62, v63
  v_cvt_pk_bf16_f32 v90, v64, v65
  v_cvt_pk_bf16_f32 v91, v66, v67
  s_waitcnt lgkmcnt(1)
  s_nop 1
  v_mfma_f32_32x32x16_bf16 v[92:107], v[28:31], v[84:87], v[92:107]
  v_mfma_f32_32x32x16_bf16 v[92:107], v[32:35], v[88:91], v[92:107]
  ds_read_b128 v[20:23], v113 offset:0
  ds_read_b128 v[24:27], v113 offset:512
  v_add_u32 v113, v113, v115
  s_waitcnt lgkmcnt(2)
  v_mfma_f32_32x32x16_bf16 v[52:67], v[16:19], v[4:7], v[68:83]
  ds_read_b128 v[12:15], v112 offset:43008
  v_exp_f32 v36, v36
  v_exp_f32 v37, v37
  v_exp_f32 v38, v38
  v_exp_f32 v39, v39
  v_exp_f32 v40, v40
  v_exp_f32 v41, v41
  v_exp_f32 v42, v42
  v_exp_f32 v43, v43
  v_exp_f32 v44, v44
  v_exp_f32 v45, v45
  v_exp_f32 v46, v46
  v_exp_f32 v47, v47
  v_exp_f32 v48, v48
  v_exp_f32 v49, v49
  v_exp_f32 v50, v50
  v_exp_f32 v51, v51
  v_cvt_pk_bf16_f32 v84, v36, v37
  v_cvt_pk_bf16_f32 v85, v38, v39
  v_cvt_pk_bf16_f32 v86, v40, v41
  v_cvt_pk_bf16_f32 v87, v42, v43
  v_cvt_pk_bf16_f32 v88, v44, v45
  v_cvt_pk_bf16_f32 v89, v46, v47
  v_cvt_pk_bf16_f32 v90, v48, v49
  v_cvt_pk_bf16_f32 v91, v50, v51
  s_waitcnt lgkmcnt(1)
  s_nop 1
  v_mfma_f32_32x32x16_bf16 v[92:107], v[20:23], v[84:87], v[92:107]
  v_mfma_f32_32x32x16_bf16 v[92:107], v[24:27], v[88:91], v[92:107]
  ds_read_b128 v[28:31], v113 offset:0
  ds_read_b128 v[32:35], v113 offset:512
  v_add_u32 v113, v113, v115
  s_waitcnt lgkmcnt(2)
  v_mfma_f32_32x32x16_bf16 v[36:51], v[12:15], v[4:7], v[68:83]
  ds_read_b128 v[16:19], v112 offset:44032
  v_exp_f32 v52, v52
  v_exp_f32 v53, v53
  v_exp_f32 v54, v54
  v_exp_f32 v55, v55
  v_exp_f32 v56, v56
  v_exp_f32 v57, v57
  v_exp_f32 v58, v58
  v_exp_f32 v59, v59
  v_exp_f32 v60, v60
  v_exp_f32 v61, v61
  v_exp_f32 v62, v62
  v_exp_f32 v63, v63
  v_exp_f32 v64, v64
  v_exp_f32 v65, v65
  v_exp_f32 v66, v66
  v_exp_f32 v67, v67
  v_cvt_pk_bf16_f32 v84, v52, v53
  v_cvt_pk_bf16_f32 v85, v54, v55
  v_cvt_pk_bf16_f32 v86, v56, v57
  v_cvt_pk_bf16_f32 v87, v58, v59
  v_cvt_pk_bf16_f32 v88, v60, v61
  v_cvt_pk_bf16_f32 v89, v62, v63
  v_cvt_pk_bf16_f32 v90, v64, v65
  v_cvt_pk_bf16_f32 v91, v66, v67
  s_waitcnt lgkmcnt(1)
  s_nop 1
  v_mfma_f32_32x32x16_bf16 v[92:107], v[28:31], v[84:87], v[92:107]
  v_mfma_f32_32x32x16_bf16 v[92:107], v[32:35], v[88:91], v[92:107]
  ds_read_b128 v[20:23], v113 offset:0
  ds_read_b128 v[24:27], v113 offset:512
  v_add_u32 v113, v113, v115
  s_waitcnt lgkmcnt(2)
  v_mfma_f32_32x32x16_bf16 v[52:67], v[16:19], v[4:7], v[68:83]
  ds_read_b128 v[12:15], v112 offset:45056
  v_exp_f32 v36, v36
  v_exp_f32 v37, v37
  v_exp_f32 v38, v38
  v_exp_f32 v39, v39
  v_exp_f32 v40, v40
  v_exp_f32 v41, v41
  v_exp_f32 v42, v42
  v_exp_f32 v43, v43
  v_exp_f32 v44, v44
  v_exp_f32 v45, v45
  v_exp_f32 v46, v46
  v_exp_f32 v47, v47
  v_exp_f32 v48, v48
  v_exp_f32 v49, v49
  v_exp_f32 v50, v50
  v_exp_f32 v51, v51
  v_cvt_pk_bf16_f32 v84, v36, v37
  v_cvt_pk_bf16_f32 v85, v38, v39
  v_cvt_pk_bf16_f32 v86, v40, v41
  v_cvt_pk_bf16_f32 v87, v42, v43
  v_cvt_pk_bf16_f32 v88, v44, v45
  v_cvt_pk_bf16_f32 v89, v46, v47
  v_cvt_pk_bf16_f32 v90, v48, v49
  v_cvt_pk_bf16_f32 v91, v50, v51
  s_waitcnt lgkmcnt(1)
  s_nop 1
  v_mfma_f32_32x32x16_bf16 v[92:107], v[20:23], v[84:87], v[92:107]
  v_mfma_f32_32x32x16_bf16 v[92:107], v[24:27], v[88:91], v[92:107]
  ds_read_b128 v[28:31], v113 offset:0
  ds_read_b128 v[32:35], v113 offset:512
  v_add_u32 v113, v113, v115
  s_waitcnt lgkmcnt(2)
  v_mfma_f32_32x32x16_bf16 v[36:51], v[12:15], v[4:7], v[68:83]
  ds_read_b128 v[16:19], v112 offset:46080
  v_exp_f32 v52, v52
  v_exp_f32 v53, v53
  v_exp_f32 v54, v54
  v_exp_f32 v55, v55
  v_exp_f32 v56, v56
  v_exp_f32 v57, v57
  v_exp_f32 v58, v58
  v_exp_f32 v59, v59
  v_exp_f32 v60, v60
  v_exp_f32 v61, v61
  v_exp_f32 v62, v62
  v_exp_f32 v63, v63
  v_exp_f32 v64, v64
  v_exp_f32 v65, v65
  v_exp_f32 v66, v66
  v_exp_f32 v67, v67
  v_cvt_pk_bf16_f32 v84, v52, v53
  v_cvt_pk_bf16_f32 v85, v54, v55
  v_cvt_pk_bf16_f32 v86, v56, v57
  v_cvt_pk_bf16_f32 v87, v58, v59
  v_cvt_pk_bf16_f32 v88, v60, v61
  v_cvt_pk_bf16_f32 v89, v62, v63
  v_cvt_pk_bf16_f32 v90, v64, v65
  v_cvt_pk_bf16_f32 v91, v66, v67
  s_waitcnt lgkmcnt(1)
  s_nop 1
  v_mfma_f32_32x32x16_bf16 v[92:107], v[28:31], v[84:87], v[92:107]
  v_mfma_f32_32x32x16_bf16 v[92:107], v[32:35], v[88:91], v[92:107]
  ds_read_b128 v[20:23], v113 offset:0
  ds_read_b128 v[24:27], v113 offset:512
  v_add_u32 v113, v113, v115
  s_waitcnt lgkmcnt(2)
  v_mfma_f32_32x32x16_bf16 v[52:67], v[16:19], v[4:7], v[68:83]
  ds_read_b128 v[12:15], v112 offset:47104
  v_exp_f32 v36, v36
  v_exp_f32 v37, v37
  v_exp_f32 v38, v38
  v_exp_f32 v39, v39
  v_exp_f32 v40, v40
  v_exp_f32 v41, v41
  v_exp_f32 v42, v42
  v_exp_f32 v43, v43
  v_exp_f32 v44, v44
  v_exp_f32 v45, v45
  v_exp_f32 v46, v46
  v_exp_f32 v47, v47
  v_exp_f32 v48, v48
  v_exp_f32 v49, v49
  v_exp_f32 v50, v50
  v_exp_f32 v51, v51
  v_cvt_pk_bf16_f32 v84, v36, v37
  v_cvt_pk_bf16_f32 v85, v38, v39
  v_cvt_pk_bf16_f32 v86, v40, v41
  v_cvt_pk_bf16_f32 v87, v42, v43
  v_cvt_pk_bf16_f32 v88, v44, v45
  v_cvt_pk_bf16_f32 v89, v46, v47
  v_cvt_pk_bf16_f32 v90, v48, v49
  v_cvt_pk_bf16_f32 v91, v50, v51
  s_waitcnt lgkmcnt(1)
  s_nop 1
  v_mfma_f32_32x32x16_bf16 v[92:107], v[20:23], v[84:87], v[92:107]
  v_mfma_f32_32x32x16_bf16 v[92:107], v[24:27], v[88:91], v[92:107]
  ds_read_b128 v[28:31], v113 offset:0
  ds_read_b128 v[32:35], v113 offset:512
  v_add_u32 v113, v113, v115
  s_waitcnt lgkmcnt(2)
  v_mfma_f32_32x32x16_bf16 v[36:51], v[12:15], v[4:7], v[68:83]
  ds_read_b128 v[16:19], v112 offset:48128
  v_exp_f32 v52, v52
  v_exp_f32 v53, v53
  v_exp_f32 v54, v54
  v_exp_f32 v55, v55
  v_exp_f32 v56, v56
  v_exp_f32 v57, v57
  v_exp_f32 v58, v58
  v_exp_f32 v59, v59
  v_exp_f32 v60, v60
  v_exp_f32 v61, v61
  v_exp_f32 v62, v62
  v_exp_f32 v63, v63
  v_exp_f32 v64, v64
  v_exp_f32 v65, v65
  v_exp_f32 v66, v66
  v_exp_f32 v67, v67
  v_cvt_pk_bf16_f32 v84, v52, v53
  v_cvt_pk_bf16_f32 v85, v54, v55
  v_cvt_pk_bf16_f32 v86, v56, v57
  v_cvt_pk_bf16_f32 v87, v58, v59
  v_cvt_pk_bf16_f32 v88, v60, v61
  v_cvt_pk_bf16_f32 v89, v62, v63
  v_cvt_pk_bf16_f32 v90, v64, v65
  v_cvt_pk_bf16_f32 v91, v66, v67
  s_waitcnt lgkmcnt(1)
  s_nop 1
  v_mfma_f32_32x32x16_bf16 v[92:107], v[28:31], v[84:87], v[92:107]
  v_mfma_f32_32x32x16_bf16 v[92:107], v[32:35], v[88:91], v[92:107]
  ds_read_b128 v[20:23], v113 offset:0
  ds_read_b128 v[24:27], v113 offset:512
  v_add_u32 v113, v113, v115
  s_waitcnt lgkmcnt(2)
  v_mfma_f32_32x32x16_bf16 v[52:67], v[16:19], v[4:7], v[68:83]
  ds_read_b128 v[12:15], v112 offset:49152
  v_exp_f32 v36, v36
  v_exp_f32 v37, v37
  v_exp_f32 v38, v38
  v_exp_f32 v39, v39
  v_exp_f32 v40, v40
  v_exp_f32 v41, v41
  v_exp_f32 v42, v42
  v_exp_f32 v43, v43
  v_exp_f32 v44, v44
  v_exp_f32 v45, v45
  v_exp_f32 v46, v46
  v_exp_f32 v47, v47
  v_exp_f32 v48, v48
  v_exp_f32 v49, v49
  v_exp_f32 v50, v50
  v_exp_f32 v51, v51
  v_cvt_pk_bf16_f32 v84, v36, v37
  v_cvt_pk_bf16_f32 v85, v38, v39
  v_cvt_pk_bf16_f32 v86, v40, v41
  v_cvt_pk_bf16_f32 v87, v42, v43
  v_cvt_pk_bf16_f32 v88, v44, v45
  v_cvt_pk_bf16_f32 v89, v46, v47
  v_cvt_pk_bf16_f32 v90, v48, v49
  v_cvt_pk_bf16_f32 v91, v50, v51
  s_waitcnt lgkmcnt(1)
  s_nop 1
  v_mfma_f32_32x32x16_bf16 v[92:107], v[20:23], v[84:87], v[92:107]
  v_mfma_f32_32x32x16_bf16 v[92:107], v[24:27], v[88:91], v[92:107]
  ds_read_b128 v[28:31], v113 offset:0
  ds_read_b128 v[32:35], v113 offset:512
  v_add_u32 v113, v113, v115
  s_waitcnt lgkmcnt(2)
  v_mfma_f32_32x32x16_bf16 v[36:51], v[12:15], v[4:7], v[68:83]
  ds_read_b128 v[16:19], v112 offset:50176
  v_exp_f32 v52, v52
  v_exp_f32 v53, v53
  v_exp_f32 v54, v54
  v_exp_f32 v55, v55
  v_exp_f32 v56, v56
  v_exp_f32 v57, v57
  v_exp_f32 v58, v58
  v_exp_f32 v59, v59
  v_exp_f32 v60, v60
  v_exp_f32 v61, v61
  v_exp_f32 v62, v62
  v_exp_f32 v63, v63
  v_exp_f32 v64, v64
  v_exp_f32 v65, v65
  v_exp_f32 v66, v66
  v_exp_f32 v67, v67
  v_cvt_pk_bf16_f32 v84, v52, v53
  v_cvt_pk_bf16_f32 v85, v54, v55
  v_cvt_pk_bf16_f32 v86, v56, v57
  v_cvt_pk_bf16_f32 v87, v58, v59
  v_cvt_pk_bf16_f32 v88, v60, v61
  v_cvt_pk_bf16_f32 v89, v62, v63
  v_cvt_pk_bf16_f32 v90, v64, v65
  v_cvt_pk_bf16_f32 v91, v66, v67
  s_waitcnt lgkmcnt(1)
  s_nop 1
  v_mfma_f32_32x32x16_bf16 v[92:107], v[28:31], v[84:87], v[92:107]
  v_mfma_f32_32x32x16_bf16 v[92:107], v[32:35], v[88:91], v[92:107]
  ds_read_b128 v[20:23], v113 offset:0
  ds_read_b128 v[24:27], v113 offset:512
  v_add_u32 v113, v113, v115
  s_waitcnt lgkmcnt(2)
  v_mfma_f32_32x32x16_bf16 v[52:67], v[16:19], v[4:7], v[68:83]
  ds_read_b128 v[12:15], v112 offset:51200
  v_exp_f32 v36, v36
  v_exp_f32 v37, v37
  v_exp_f32 v38, v38
  v_exp_f32 v39, v39
  v_exp_f32 v40, v40
  v_exp_f32 v41, v41
  v_exp_f32 v42, v42
  v_exp_f32 v43, v43
  v_exp_f32 v44, v44
  v_exp_f32 v45, v45
  v_exp_f32 v46, v46
  v_exp_f32 v47, v47
  v_exp_f32 v48, v48
  v_exp_f32 v49, v49
  v_exp_f32 v50, v50
  v_exp_f32 v51, v51
  v_cvt_pk_bf16_f32 v84, v36, v37
  v_cvt_pk_bf16_f32 v85, v38, v39
  v_cvt_pk_bf16_f32 v86, v40, v41
  v_cvt_pk_bf16_f32 v87, v42, v43
  v_cvt_pk_bf16_f32 v88, v44, v45
  v_cvt_pk_bf16_f32 v89, v46, v47
  v_cvt_pk_bf16_f32 v90, v48, v49
  v_cvt_pk_bf16_f32 v91, v50, v51
  s_waitcnt lgkmcnt(1)
  s_nop 1
  v_mfma_f32_32x32x16_bf16 v[92:107], v[20:23], v[84:87], v[92:107]
  v_mfma_f32_32x32x16_bf16 v[92:107], v[24:27], v[88:91], v[92:107]
  ds_read_b128 v[28:31], v113 offset:0
  ds_read_b128 v[32:35], v113 offset:512
  v_add_u32 v113, v113, v115
  s_waitcnt lgkmcnt(2)
  v_mfma_f32_32x32x16_bf16 v[36:51], v[12:15], v[4:7], v[68:83]
  ds_read_b128 v[16:19], v112 offset:52224
  v_exp_f32 v52, v52
  v_exp_f32 v53, v53
  v_exp_f32 v54, v54
  v_exp_f32 v55, v55
  v_exp_f32 v56, v56
  v_exp_f32 v57, v57
  v_exp_f32 v58, v58
  v_exp_f32 v59, v59
  v_exp_f32 v60, v60
  v_exp_f32 v61, v61
  v_exp_f32 v62, v62
  v_exp_f32 v63, v63
  v_exp_f32 v64, v64
  v_exp_f32 v65, v65
  v_exp_f32 v66, v66
  v_exp_f32 v67, v67
  v_cvt_pk_bf16_f32 v84, v52, v53
  v_cvt_pk_bf16_f32 v85, v54, v55
  v_cvt_pk_bf16_f32 v86, v56, v57
  v_cvt_pk_bf16_f32 v87, v58, v59
  v_cvt_pk_bf16_f32 v88, v60, v61
  v_cvt_pk_bf16_f32 v89, v62, v63
  v_cvt_pk_bf16_f32 v90, v64, v65
  v_cvt_pk_bf16_f32 v91, v66, v67
  s_waitcnt lgkmcnt(1)
  s_nop 1
  v_mfma_f32_32x32x16_bf16 v[92:107], v[28:31], v[84:87], v[92:107]
  v_mfma_f32_32x32x16_bf16 v[92:107], v[32:35], v[88:91], v[92:107]
  ds_read_b128 v[20:23], v113 offset:0
  ds_read_b128 v[24:27], v113 offset:512
  v_add_u32 v113, v113, v115
  s_waitcnt lgkmcnt(2)
  v_mfma_f32_32x32x16_bf16 v[52:67], v[16:19], v[4:7], v[68:83]
  ds_read_b128 v[12:15], v112 offset:53248
  v_exp_f32 v36, v36
  v_exp_f32 v37, v37
  v_exp_f32 v38, v38
  v_exp_f32 v39, v39
  v_exp_f32 v40, v40
  v_exp_f32 v41, v41
  v_exp_f32 v42, v42
  v_exp_f32 v43, v43
  v_exp_f32 v44, v44
  v_exp_f32 v45, v45
  v_exp_f32 v46, v46
  v_exp_f32 v47, v47
  v_exp_f32 v48, v48
  v_exp_f32 v49, v49
  v_exp_f32 v50, v50
  v_exp_f32 v51, v51
  v_cvt_pk_bf16_f32 v84, v36, v37
  v_cvt_pk_bf16_f32 v85, v38, v39
  v_cvt_pk_bf16_f32 v86, v40, v41
  v_cvt_pk_bf16_f32 v87, v42, v43
  v_cvt_pk_bf16_f32 v88, v44, v45
  v_cvt_pk_bf16_f32 v89, v46, v47
  v_cvt_pk_bf16_f32 v90, v48, v49
  v_cvt_pk_bf16_f32 v91, v50, v51
  s_waitcnt lgkmcnt(1)
  s_nop 1
  v_mfma_f32_32x32x16_bf16 v[92:107], v[20:23], v[84:87], v[92:107]
  v_mfma_f32_32x32x16_bf16 v[92:107], v[24:27], v[88:91], v[92:107]
  ds_read_b128 v[28:31], v113 offset:0
  ds_read_b128 v[32:35], v113 offset:512
  v_add_u32 v113, v113, v115
  s_waitcnt lgkmcnt(2)
  v_mfma_f32_32x32x16_bf16 v[36:51], v[12:15], v[4:7], v[68:83]
  ds_read_b128 v[16:19], v112 offset:54272
  v_exp_f32 v52, v52
  v_exp_f32 v53, v53
  v_exp_f32 v54, v54
  v_exp_f32 v55, v55
  v_exp_f32 v56, v56
  v_exp_f32 v57, v57
  v_exp_f32 v58, v58
  v_exp_f32 v59, v59
  v_exp_f32 v60, v60
  v_exp_f32 v61, v61
  v_exp_f32 v62, v62
  v_exp_f32 v63, v63
  v_exp_f32 v64, v64
  v_exp_f32 v65, v65
  v_exp_f32 v66, v66
  v_exp_f32 v67, v67
  v_cvt_pk_bf16_f32 v84, v52, v53
  v_cvt_pk_bf16_f32 v85, v54, v55
  v_cvt_pk_bf16_f32 v86, v56, v57
  v_cvt_pk_bf16_f32 v87, v58, v59
  v_cvt_pk_bf16_f32 v88, v60, v61
  v_cvt_pk_bf16_f32 v89, v62, v63
  v_cvt_pk_bf16_f32 v90, v64, v65
  v_cvt_pk_bf16_f32 v91, v66, v67
  s_waitcnt lgkmcnt(1)
  s_nop 1
  v_mfma_f32_32x32x16_bf16 v[92:107], v[28:31], v[84:87], v[92:107]
  v_mfma_f32_32x32x16_bf16 v[92:107], v[32:35], v[88:91], v[92:107]
  ds_read_b128 v[20:23], v113 offset:0
  ds_read_b128 v[24:27], v113 offset:512
  v_add_u32 v113, v113, v115
  s_waitcnt lgkmcnt(2)
  v_mfma_f32_32x32x16_bf16 v[52:67], v[16:19], v[4:7], v[68:83]
  ds_read_b128 v[12:15], v112 offset:55296
  v_exp_f32 v36, v36
  v_exp_f32 v37, v37
  v_exp_f32 v38, v38
  v_exp_f32 v39, v39
  v_exp_f32 v40, v40
  v_exp_f32 v41, v41
  v_exp_f32 v42, v42
  v_exp_f32 v43, v43
  v_exp_f32 v44, v44
  v_exp_f32 v45, v45
  v_exp_f32 v46, v46
  v_exp_f32 v47, v47
  v_exp_f32 v48, v48
  v_exp_f32 v49, v49
  v_exp_f32 v50, v50
  v_exp_f32 v51, v51
  v_cvt_pk_bf16_f32 v84, v36, v37
  v_cvt_pk_bf16_f32 v85, v38, v39
  v_cvt_pk_bf16_f32 v86, v40, v41
  v_cvt_pk_bf16_f32 v87, v42, v43
  v_cvt_pk_bf16_f32 v88, v44, v45
  v_cvt_pk_bf16_f32 v89, v46, v47
  v_cvt_pk_bf16_f32 v90, v48, v49
  v_cvt_pk_bf16_f32 v91, v50, v51
  s_waitcnt lgkmcnt(1)
  s_nop 1
  v_mfma_f32_32x32x16_bf16 v[92:107], v[20:23], v[84:87], v[92:107]
  v_mfma_f32_32x32x16_bf16 v[92:107], v[24:27], v[88:91], v[92:107]
  ds_read_b128 v[28:31], v113 offset:0
  ds_read_b128 v[32:35], v113 offset:512
  v_add_u32 v113, v113, v115
  s_waitcnt lgkmcnt(2)
  v_mfma_f32_32x32x16_bf16 v[36:51], v[12:15], v[4:7], v[68:83]
  ds_read_b128 v[16:19], v112 offset:56320
  v_exp_f32 v52, v52
  v_exp_f32 v53, v53
  v_exp_f32 v54, v54
  v_exp_f32 v55, v55
  v_exp_f32 v56, v56
  v_exp_f32 v57, v57
  v_exp_f32 v58, v58
  v_exp_f32 v59, v59
  v_exp_f32 v60, v60
  v_exp_f32 v61, v61
  v_exp_f32 v62, v62
  v_exp_f32 v63, v63
  v_exp_f32 v64, v64
  v_exp_f32 v65, v65
  v_exp_f32 v66, v66
  v_exp_f32 v67, v67
  v_cvt_pk_bf16_f32 v84, v52, v53
  v_cvt_pk_bf16_f32 v85, v54, v55
  v_cvt_pk_bf16_f32 v86, v56, v57
  v_cvt_pk_bf16_f32 v87, v58, v59
  v_cvt_pk_bf16_f32 v88, v60, v61
  v_cvt_pk_bf16_f32 v89, v62, v63
  v_cvt_pk_bf16_f32 v90, v64, v65
  v_cvt_pk_bf16_f32 v91, v66, v67
  s_waitcnt lgkmcnt(1)
  s_nop 1
  v_mfma_f32_32x32x16_bf16 v[92:107], v[28:31], v[84:87], v[92:107]
  v_mfma_f32_32x32x16_bf16 v[92:107], v[32:35], v[88:91], v[92:107]
  ds_read_b128 v[20:23], v113 offset:0
  ds_read_b128 v[24:27], v113 offset:512
  v_add_u32 v113, v113, v115
  s_waitcnt lgkmcnt(2)
  v_mfma_f32_32x32x16_bf16 v[52:67], v[16:19], v[4:7], v[68:83]
  ds_read_b128 v[12:15], v112 offset:57344
  v_exp_f32 v36, v36
  v_exp_f32 v37, v37
  v_exp_f32 v38, v38
  v_exp_f32 v39, v39
  v_exp_f32 v40, v40
  v_exp_f32 v41, v41
  v_exp_f32 v42, v42
  v_exp_f32 v43, v43
  v_exp_f32 v44, v44
  v_exp_f32 v45, v45
  v_exp_f32 v46, v46
  v_exp_f32 v47, v47
  v_exp_f32 v48, v48
  v_exp_f32 v49, v49
  v_exp_f32 v50, v50
  v_exp_f32 v51, v51
  v_cvt_pk_bf16_f32 v84, v36, v37
  v_cvt_pk_bf16_f32 v85, v38, v39
  v_cvt_pk_bf16_f32 v86, v40, v41
  v_cvt_pk_bf16_f32 v87, v42, v43
  v_cvt_pk_bf16_f32 v88, v44, v45
  v_cvt_pk_bf16_f32 v89, v46, v47
  v_cvt_pk_bf16_f32 v90, v48, v49
  v_cvt_pk_bf16_f32 v91, v50, v51
  s_waitcnt lgkmcnt(1)
  s_nop 1
  v_mfma_f32_32x32x16_bf16 v[92:107], v[20:23], v[84:87], v[92:107]
  v_mfma_f32_32x32x16_bf16 v[92:107], v[24:27], v[88:91], v[92:107]
  ds_read_b128 v[28:31], v113 offset:0
  ds_read_b128 v[32:35], v113 offset:512
  v_add_u32 v113, v113, v115
  s_waitcnt lgkmcnt(2)
  v_mfma_f32_32x32x16_bf16 v[36:51], v[12:15], v[4:7], v[68:83]
  ds_read_b128 v[16:19], v112 offset:58368
  v_exp_f32 v52, v52
  v_exp_f32 v53, v53
  v_exp_f32 v54, v54
  v_exp_f32 v55, v55
  v_exp_f32 v56, v56
  v_exp_f32 v57, v57
  v_exp_f32 v58, v58
  v_exp_f32 v59, v59
  v_exp_f32 v60, v60
  v_exp_f32 v61, v61
  v_exp_f32 v62, v62
  v_exp_f32 v63, v63
  v_exp_f32 v64, v64
  v_exp_f32 v65, v65
  v_exp_f32 v66, v66
  v_exp_f32 v67, v67
  v_cvt_pk_bf16_f32 v84, v52, v53
  v_cvt_pk_bf16_f32 v85, v54, v55
  v_cvt_pk_bf16_f32 v86, v56, v57
  v_cvt_pk_bf16_f32 v87, v58, v59
  v_cvt_pk_bf16_f32 v88, v60, v61
  v_cvt_pk_bf16_f32 v89, v62, v63
  v_cvt_pk_bf16_f32 v90, v64, v65
  v_cvt_pk_bf16_f32 v91, v66, v67
  s_waitcnt lgkmcnt(1)
  s_nop 1
  v_mfma_f32_32x32x16_bf16 v[92:107], v[28:31], v[84:87], v[92:107]
  v_mfma_f32_32x32x16_bf16 v[92:107], v[32:35], v[88:91], v[92:107]
  ds_read_b128 v[20:23], v113 offset:0
  ds_read_b128 v[24:27], v113 offset:512
  v_add_u32 v113, v113, v115
  s_waitcnt lgkmcnt(2)
  v_mfma_f32_32x32x16_bf16 v[52:67], v[16:19], v[4:7], v[68:83]
  ds_read_b128 v[12:15], v112 offset:59392
  v_exp_f32 v36, v36
  v_exp_f32 v37, v37
  v_exp_f32 v38, v38
  v_exp_f32 v39, v39
  v_exp_f32 v40, v40
  v_exp_f32 v41, v41
  v_exp_f32 v42, v42
  v_exp_f32 v43, v43
  v_exp_f32 v44, v44
  v_exp_f32 v45, v45
  v_exp_f32 v46, v46
  v_exp_f32 v47, v47
  v_exp_f32 v48, v48
  v_exp_f32 v49, v49
  v_exp_f32 v50, v50
  v_exp_f32 v51, v51
  v_cvt_pk_bf16_f32 v84, v36, v37
  v_cvt_pk_bf16_f32 v85, v38, v39
  v_cvt_pk_bf16_f32 v86, v40, v41
  v_cvt_pk_bf16_f32 v87, v42, v43
  v_cvt_pk_bf16_f32 v88, v44, v45
  v_cvt_pk_bf16_f32 v89, v46, v47
  v_cvt_pk_bf16_f32 v90, v48, v49
  v_cvt_pk_bf16_f32 v91, v50, v51
  s_waitcnt lgkmcnt(1)
  s_nop 1
  v_mfma_f32_32x32x16_bf16 v[92:107], v[20:23], v[84:87], v[92:107]
  v_mfma_f32_32x32x16_bf16 v[92:107], v[24:27], v[88:91], v[92:107]
  ds_read_b128 v[28:31], v113 offset:0
  ds_read_b128 v[32:35], v113 offset:512
  v_add_u32 v113, v113, v115
  s_waitcnt lgkmcnt(2)
  v_mfma_f32_32x32x16_bf16 v[36:51], v[12:15], v[4:7], v[68:83]
  ds_read_b128 v[16:19], v112 offset:60416
  v_exp_f32 v52, v52
  v_exp_f32 v53, v53
  v_exp_f32 v54, v54
  v_exp_f32 v55, v55
  v_exp_f32 v56, v56
  v_exp_f32 v57, v57
  v_exp_f32 v58, v58
  v_exp_f32 v59, v59
  v_exp_f32 v60, v60
  v_exp_f32 v61, v61
  v_exp_f32 v62, v62
  v_exp_f32 v63, v63
  v_exp_f32 v64, v64
  v_exp_f32 v65, v65
  v_exp_f32 v66, v66
  v_exp_f32 v67, v67
  v_cvt_pk_bf16_f32 v84, v52, v53
  v_cvt_pk_bf16_f32 v85, v54, v55
  v_cvt_pk_bf16_f32 v86, v56, v57
  v_cvt_pk_bf16_f32 v87, v58, v59
  v_cvt_pk_bf16_f32 v88, v60, v61
  v_cvt_pk_bf16_f32 v89, v62, v63
  v_cvt_pk_bf16_f32 v90, v64, v65
  v_cvt_pk_bf16_f32 v91, v66, v67
  s_waitcnt lgkmcnt(1)
  s_nop 1
  v_mfma_f32_32x32x16_bf16 v[92:107], v[28:31], v[84:87], v[92:107]
  v_mfma_f32_32x32x16_bf16 v[92:107], v[32:35], v[88:91], v[92:107]
  ds_read_b128 v[20:23], v113 offset:0
  ds_read_b128 v[24:27], v113 offset:512
  v_add_u32 v113, v113, v115
  s_waitcnt lgkmcnt(2)
  v_mfma_f32_32x32x16_bf16 v[52:67], v[16:19], v[4:7], v[68:83]
  ds_read_b128 v[12:15], v112 offset:61440
  v_exp_f32 v36, v36
  v_exp_f32 v37, v37
  v_exp_f32 v38, v38
  v_exp_f32 v39, v39
  v_exp_f32 v40, v40
  v_exp_f32 v41, v41
  v_exp_f32 v42, v42
  v_exp_f32 v43, v43
  v_exp_f32 v44, v44
  v_exp_f32 v45, v45
  v_exp_f32 v46, v46
  v_exp_f32 v47, v47
  v_exp_f32 v48, v48
  v_exp_f32 v49, v49
  v_exp_f32 v50, v50
  v_exp_f32 v51, v51
  v_cvt_pk_bf16_f32 v84, v36, v37
  v_cvt_pk_bf16_f32 v85, v38, v39
  v_cvt_pk_bf16_f32 v86, v40, v41
  v_cvt_pk_bf16_f32 v87, v42, v43
  v_cvt_pk_bf16_f32 v88, v44, v45
  v_cvt_pk_bf16_f32 v89, v46, v47
  v_cvt_pk_bf16_f32 v90, v48, v49
  v_cvt_pk_bf16_f32 v91, v50, v51
  s_waitcnt lgkmcnt(1)
  s_nop 1
  v_mfma_f32_32x32x16_bf16 v[92:107], v[20:23], v[84:87], v[92:107]
  v_mfma_f32_32x32x16_bf16 v[92:107], v[24:27], v[88:91], v[92:107]
  ds_read_b128 v[28:31], v113 offset:0
  ds_read_b128 v[32:35], v113 offset:512
  v_add_u32 v113, v113, v115
  s_waitcnt lgkmcnt(2)
  v_mfma_f32_32x32x16_bf16 v[36:51], v[12:15], v[4:7], v[68:83]
  ds_read_b128 v[16:19], v112 offset:62464
  v_exp_f32 v52, v52
  v_exp_f32 v53, v53
  v_exp_f32 v54, v54
  v_exp_f32 v55, v55
  v_exp_f32 v56, v56
  v_exp_f32 v57, v57
  v_exp_f32 v58, v58
  v_exp_f32 v59, v59
  v_exp_f32 v60, v60
  v_exp_f32 v61, v61
  v_exp_f32 v62, v62
  v_exp_f32 v63, v63
  v_exp_f32 v64, v64
  v_exp_f32 v65, v65
  v_exp_f32 v66, v66
  v_exp_f32 v67, v67
  v_cvt_pk_bf16_f32 v84, v52, v53
  v_cvt_pk_bf16_f32 v85, v54, v55
  v_cvt_pk_bf16_f32 v86, v56, v57
  v_cvt_pk_bf16_f32 v87, v58, v59
  v_cvt_pk_bf16_f32 v88, v60, v61
  v_cvt_pk_bf16_f32 v89, v62, v63
  v_cvt_pk_bf16_f32 v90, v64, v65
  v_cvt_pk_bf16_f32 v91, v66, v67
  s_waitcnt lgkmcnt(1)
  s_nop 1
  v_mfma_f32_32x32x16_bf16 v[92:107], v[28:31], v[84:87], v[92:107]
  v_mfma_f32_32x32x16_bf16 v[92:107], v[32:35], v[88:91], v[92:107]
  ds_read_b128 v[20:23], v113 offset:0
  ds_read_b128 v[24:27], v113 offset:512
  v_add_u32 v113, v113, v115
  s_waitcnt lgkmcnt(2)
  v_mfma_f32_32x32x16_bf16 v[52:67], v[16:19], v[4:7], v[68:83]
  ds_read_b128 v[12:15], v112 offset:63488
  v_exp_f32 v36, v36
  v_exp_f32 v37, v37
  v_exp_f32 v38, v38
  v_exp_f32 v39, v39
  v_exp_f32 v40, v40
  v_exp_f32 v41, v41
  v_exp_f32 v42, v42
  v_exp_f32 v43, v43
  v_exp_f32 v44, v44
  v_exp_f32 v45, v45
  v_exp_f32 v46, v46
  v_exp_f32 v47, v47
  v_exp_f32 v48, v48
  v_exp_f32 v49, v49
  v_exp_f32 v50, v50
  v_exp_f32 v51, v51
  v_cvt_pk_bf16_f32 v84, v36, v37
  v_cvt_pk_bf16_f32 v85, v38, v39
  v_cvt_pk_bf16_f32 v86, v40, v41
  v_cvt_pk_bf16_f32 v87, v42, v43
  v_cvt_pk_bf16_f32 v88, v44, v45
  v_cvt_pk_bf16_f32 v89, v46, v47
  v_cvt_pk_bf16_f32 v90, v48, v49
  v_cvt_pk_bf16_f32 v91, v50, v51
  s_waitcnt lgkmcnt(1)
  s_nop 1
  v_mfma_f32_32x32x16_bf16 v[92:107], v[20:23], v[84:87], v[92:107]
  v_mfma_f32_32x32x16_bf16 v[92:107], v[24:27], v[88:91], v[92:107]
  ds_read_b128 v[28:31], v113 offset:0
  ds_read_b128 v[32:35], v113 offset:512
  v_add_u32 v113, v113, v115
  s_waitcnt lgkmcnt(2)
  v_mfma_f32_32x32x16_bf16 v[36:51], v[12:15], v[4:7], v[68:83]
  ds_read_b128 v[16:19], v112 offset:64512
  v_exp_f32 v52, v52
  v_exp_f32 v53, v53
  v_exp_f32 v54, v54
  v_exp_f32 v55, v55
  v_exp_f32 v56, v56
  v_exp_f32 v57, v57
  v_exp_f32 v58, v58
  v_exp_f32 v59, v59
  v_exp_f32 v60, v60
  v_exp_f32 v61, v61
  v_exp_f32 v62, v62
  v_exp_f32 v63, v63
  v_exp_f32 v64, v64
  v_exp_f32 v65, v65
  v_exp_f32 v66, v66
  v_exp_f32 v67, v67
  v_cvt_pk_bf16_f32 v84, v52, v53
  v_cvt_pk_bf16_f32 v85, v54, v55
  v_cvt_pk_bf16_f32 v86, v56, v57
  v_cvt_pk_bf16_f32 v87, v58, v59
  v_cvt_pk_bf16_f32 v88, v60, v61
  v_cvt_pk_bf16_f32 v89, v62, v63
  v_cvt_pk_bf16_f32 v90, v64, v65
  v_cvt_pk_bf16_f32 v91, v66, v67
  s_waitcnt lgkmcnt(1)
  s_nop 1
  v_mfma_f32_32x32x16_bf16 v[92:107], v[28:31], v[84:87], v[92:107]
  v_mfma_f32_32x32x16_bf16 v[92:107], v[32:35], v[88:91], v[92:107]
  ds_read_b128 v[20:23], v113 offset:0
  ds_read_b128 v[24:27], v113 offset:512
  v_add_u32 v113, v113, v115
  s_waitcnt lgkmcnt(2)
  v_mfma_f32_32x32x16_bf16 v[52:67], v[16:19], v[4:7], v[68:83]
  v_exp_f32 v36, v36
  v_exp_f32 v37, v37
  v_exp_f32 v38, v38
  v_exp_f32 v39, v39
  v_exp_f32 v40, v40
  v_exp_f32 v41, v41
  v_exp_f32 v42, v42
  v_exp_f32 v43, v43
  v_exp_f32 v44, v44
  v_exp_f32 v45, v45
  v_exp_f32 v46, v46
  v_exp_f32 v47, v47
  v_exp_f32 v48, v48
  v_exp_f32 v49, v49
  v_exp_f32 v50, v50
  v_exp_f32 v51, v51
  v_cvt_pk_bf16_f32 v84, v36, v37
  v_cvt_pk_bf16_f32 v85, v38, v39
  v_cvt_pk_bf16_f32 v86, v40, v41
  v_cvt_pk_bf16_f32 v87, v42, v43
  v_cvt_pk_bf16_f32 v88, v44, v45
  v_cvt_pk_bf16_f32 v89, v46, v47
  v_cvt_pk_bf16_f32 v90, v48, v49
  v_cvt_pk_bf16_f32 v91, v50, v51
  s_waitcnt lgkmcnt(0)
  s_nop 1
  v_mfma_f32_32x32x16_bf16 v[92:107], v[20:23], v[84:87], v[92:107]
  v_mfma_f32_32x32x16_bf16 v[92:107], v[24:27], v[88:91], v[92:107]
  ds_read_b128 v[28:31], v113 offset:0
  ds_read_b128 v[32:35], v113 offset:512
  v_add_u32 v113, v113, v115
  s_nop 7
  v_exp_f32 v52, v52
  v_exp_f32 v53, v53
  v_exp_f32 v54, v54
  v_exp_f32 v55, v55
  v_exp_f32 v56, v56
  v_exp_f32 v57, v57
  v_exp_f32 v58, v58
  v_exp_f32 v59, v59
  v_exp_f32 v60, v60
  v_exp_f32 v61, v61
  v_exp_f32 v62, v62
  v_exp_f32 v63, v63
  v_exp_f32 v64, v64
  v_exp_f32 v65, v65
  v_exp_f32 v66, v66
  v_exp_f32 v67, v67
  v_cvt_pk_bf16_f32 v84, v52, v53
  v_cvt_pk_bf16_f32 v85, v54, v55
  v_cvt_pk_bf16_f32 v86, v56, v57
  v_cvt_pk_bf16_f32 v87, v58, v59
  v_cvt_pk_bf16_f32 v88, v60, v61
  v_cvt_pk_bf16_f32 v89, v62, v63
  v_cvt_pk_bf16_f32 v90, v64, v65
  v_cvt_pk_bf16_f32 v91, v66, v67
  s_waitcnt lgkmcnt(0)
  s_nop 1
  v_mfma_f32_32x32x16_bf16 v[92:107], v[28:31], v[84:87], v[92:107]
  v_mfma_f32_32x32x16_bf16 v[92:107], v[32:35], v[88:91], v[92:107]
  s_nop 15
  v_rcp_f32 v36, v100
  s_nop 0
  v_mul_f32 v92, v92, v36
  v_mul_f32 v93, v93, v36
  v_mul_f32 v94, v94, v36
  v_mul_f32 v95, v95, v36
  v_mul_f32 v96, v96, v36
  v_mul_f32 v97, v97, v36
  v_mul_f32 v98, v98, v36
  v_mul_f32 v99, v99, v36
  v_cvt_pk_bf16_f32 v40, v92, v93
  v_cvt_pk_bf16_f32 v41, v94, v95
  v_cvt_pk_bf16_f32 v42, v96, v97
  v_cvt_pk_bf16_f32 v43, v98, v99
  v_lshl_add_u32 v37, v111, 3, v110
  buffer_store_dwordx2 v[40:41], v37, s[12:15], 0 offen
  buffer_store_dwordx2 v[42:43], v37, s[12:15], 0 offen offset:16
L_attn_kernel_end:
  s_endpgm
.p2align 8
.globl oproj_kernel
.type oproj_kernel,@function
oproj_kernel:
  s_cmp_ge_u32 s2, 256
  s_cbranch_scc1 L_oproj_kernel_end
  s_and_b32 s24, s2, 31
  s_lshl_b32 s24, s24, 6
  s_lshr_b32 s25, s2, 5
  s_lshl_b32 s25, s25, 6
  s_load_dwordx2 s[4:5], s[0:1], 88
  s_load_dwordx2 s[8:9], s[0:1], 32
  s_load_dwordx2 s[16:17], s[0:1], 88
  s_load_dwordx2 s[20:21], s[0:1], 0
  s_waitcnt lgkmcnt(0)
  s_add_u32 s4, s4, 3145728
  s_addc_u32 s5, s5, 0
  s_mov_b32 s6, 2097152
  s_mov_b32 s7, 0x00020000
  s_mov_b32 s10, 524288
  s_mov_b32 s11, 0x00020000
  s_add_u32 s16, s16, 5242880
  s_addc_u32 s17, s17, 0
  s_mov_b32 s18, 2097152
  s_mov_b32 s19, 0x00020000
  s_mov_b32 s22, 2097152
  s_mov_b32 s23, 0x00020000
  s_mov_b32 s26, 1024
  s_mov_b32 s27, 1024
  v_and_b32 v1, 63, v0
  v_lshrrev_b32 v2, 6, v0
  v_lshrrev_b32 v3, 5, v1
  v_and_b32 v4, 31, v1
  v_lshrrev_b32 v5, 3, v0
  v_and_b32 v6, 7, v0
  v_add_u32 v7, s24, v5
  v_mul_lo_u32 v7, v7, s26
  v_lshl_add_u32 v8, v6, 4, v7
  v_add_u32 v9, 32768, v8
  v_mul_u32_u24 v10, 144, v5
  v_lshl_add_u32 v10, v6, 4, v10
  v_lshrrev_b32 v5, 3, v0
  v_and_b32 v6, 7, v0
  v_mul_lo_u32 v7, v5, s27
  v_lshl_add_u32 v7, v6, 4, v7
  s_lshl_b32 s28, s25, 1
  v_add_u32 v11, s28, v7
  v_add_u32 v12, 32768, v11
  v_mul_u32_u24 v13, 160, v5
  v_lshl_add_u32 v13, v6, 4, v13
  v_lshrrev_b32 v5, 1, v2
  v_and_b32 v6, 1, v2
  v_lshl_add_u32 v7, v5, 5, v4
  v_mul_u32_u24 v14, 144, v7
  v_lshl_add_u32 v14, v3, 4, v14
  v_and_b32 v7, 15, v1
  v_lshrrev_b32 v7, 2, v7
  v_lshl_add_u32 v7, v3, 3, v7
  v_mul_u32_u24 v15, 160, v7
  v_lshl_add_u32 v15, v6, 6, v15
  v_lshrrev_b32 v7, 4, v1
  v_and_b32 v7, 1, v7
  v_lshl_add_u32 v15, v7, 5, v15
  v_and_b32 v7, 3, v1
  v_lshl_add_u32 v15, v7, 3, v15
  buffer_load_dwordx4 v[136:139], v8, s[4:7], 0 offen offset:0
  buffer_load_dwordx4 v[140:143], v9, s[4:7], 0 offen offset:0
  s_mov_b32 s29, 0
  buffer_load_dwordx4 v[144:147], v11, s[8:11], s29 offen
  buffer_load_dwordx4 v[148:151], v12, s[8:11], s29 offen
  buffer_load_dwordx4 v[152:155], v8, s[4:7], 0 offen offset:128
  buffer_load_dwordx4 v[156:159], v9, s[4:7], 0 offen offset:128
  s_mov_b32 s29, 65536
  buffer_load_dwordx4 v[160:163], v11, s[8:11], s29 offen
  buffer_load_dwordx4 v[164:167], v12, s[8:11], s29 offen
  buffer_load_dwordx4 v[168:171], v8, s[4:7], 0 offen offset:256
  buffer_load_dwordx4 v[172:175], v9, s[4:7], 0 offen offset:256
  s_mov_b32 s29, 131072
  buffer_load_dwordx4 v[176:179], v11, s[8:11], s29 offen
  buffer_load_dwordx4 v[180:183], v12, s[8:11], s29 offen
  s_waitcnt vmcnt(8)
  ds_write_b128 v10, v[136:139] offset:512
  ds_write_b128 v10, v[140:143] offset:5120
  ds_write_b128 v13, v[144:147] offset:9728
  ds_write_b128 v13, v[148:151] offset:14848
  s_waitcnt lgkmcnt(0)
  s_barrier
  buffer_load_dwordx4 v[136:139], v8, s[4:7], 0 offen offset:384
  buffer_load_dwordx4 v[140:143], v9, s[4:7], 0 offen offset:384
  s_mov_b32 s29, 196608
  buffer_load_dwordx4 v[144:147], v11, s[8:11], s29 offen
  buffer_load_dwordx4 v[148:151], v12, s[8:11], s29 offen
  ds_read_b128 v[88:91], v14 offset:512
  ds_read_b64_tr_b16 v[104:105], v15 offset:9728
  ds_read_b64_tr_b16 v[106:107], v15 offset:10368
  ds_read_b128 v[92:95], v14 offset:544
  ds_read_b64_tr_b16 v[108:109], v15 offset:12288
  ds_read_b64_tr_b16 v[110:111], v15 offset:12928
  ds_read_b128 v[96:99], v14 offset:576
  ds_read_b64_tr_b16 v[112:113], v15 offset:14848
  ds_read_b64_tr_b16 v[114:115], v15 offset:15488
  ds_read_b128 v[100:103], v14 offset:608
  ds_read_b64_tr_b16 v[116:117], v15 offset:17408
  ds_read_b64_tr_b16 v[118:119], v15 offset:18048
  s_waitcnt lgkmcnt(9)
  v_mfma_f32_32x32x16_bf16 v[32:47], v[88:91], v[104:107], 0
  s_waitcnt lgkmcnt(6)
  v_mfma_f32_32x32x16_bf16 v[32:47], v[92:95], v[108:111], v[32:47]
  s_waitcnt lgkmcnt(3)
  v_mfma_f32_32x32x16_bf16 v[32:47], v[96:99], v[112:115], v[32:47]
  s_waitcnt lgkmcnt(0)
  v_mfma_f32_32x32x16_bf16 v[32:47], v[100:103], v[116:119], v[32:47]
  s_waitcnt vmcnt(8)
  ds_write_b128 v10, v[152:155] offset:19968
  ds_write_b128 v10, v[156:159] offset:24576
  ds_write_b128 v13, v[160:163] offset:29184
  ds_write_b128 v13, v[164:167] offset:34304
  s_waitcnt lgkmcnt(0)
  s_barrier
  buffer_load_dwordx4 v[152:155], v8, s[4:7], 0 offen offset:512
  buffer_load_dwordx4 v[156:159], v9, s[4:7], 0 offen offset:512
  s_mov_b32 s29, 262144
  buffer_load_dwordx4 v[160:163], v11, s[8:11], s29 offen
  buffer_load_dwordx4 v[164:167], v12, s[8:11], s29 offen
  ds_read_b128 v[88:91], v14 offset:19968
  ds_read_b64_tr_b16 v[104:105], v15 offset:29184
  ds_read_b64_tr_b16 v[106:107], v15 offset:29824
  ds_read_b128 v[92:95], v14 offset:20000
  ds_read_b64_tr_b16 v[108:109], v15 offset:31744
  ds_read_b64_tr_b16 v[110:111], v15 offset:32384
  ds_read_b128 v[96:99], v14 offset:20032
  ds_read_b64_tr_b16 v[112:113], v15 offset:34304
  ds_read_b64_tr_b16 v[114:115], v15 offset:34944
  ds_read_b128 v[100:103], v14 offset:20064
  ds_read_b64_tr_b16 v[116:117], v15 offset:36864
  ds_read_b64_tr_b16 v[118:119], v15 offset:37504
  s_waitcnt lgkmcnt(9)
  v_mfma_f32_32x32x16_bf16 v[32:47], v[88:91], v[104:107], v[32:47]
  s_waitcnt lgkmcnt(6)
  v_mfma_f32_32x32x16_bf16 v[32:47], v[92:95], v[108:111], v[32:47]
  s_waitcnt lgkmcnt(3)
  v_mfma_f32_32x32x16_bf16 v[32:47], v[96:99], v[112:115], v[32:47]
  s_waitcnt lgkmcnt(0)
  v_mfma_f32_32x32x16_bf16 v[32:47], v[100:103], v[116:119], v[32:47]
  s_waitcnt vmcnt(8)
  ds_write_b128 v10, v[168:171] offset:512
  ds_write_b128 v10, v[172:175] offset:5120
  ds_write_b128 v13, v[176:179] offset:9728
  ds_write_b128 v13, v[180:183] offset:14848
  s_waitcnt lgkmcnt(0)
  s_barrier
  buffer_load_dwordx4 v[168:171], v8, s[4:7], 0 offen offset:640
  buffer_load_dwordx4 v[172:175], v9, s[4:7], 0 offen offset:640
  s_mov_b32 s29, 327680
  buffer_load_dwordx4 v[176:179], v11, s[8:11], s29 offen
  buffer_load_dwordx4 v[180:183], v12, s[8:11], s29 offen
  ds_read_b128 v[88:91], v14 offset:512
  ds_read_b64_tr_b16 v[104:105], v15 offset:9728
  ds_read_b64_tr_b16 v[106:107], v15 offset:10368
  ds_read_b128 v[92:95], v14 offset:544
  ds_read_b64_tr_b16 v[108:109], v15 offset:12288
  ds_read_b64_tr_b16 v[110:111], v15 offset:12928
  ds_read_b128 v[96:99], v14 offset:576
  ds_read_b64_tr_b16 v[112:113], v15 offset:14848
  ds_read_b64_tr_b16 v[114:115], v15 offset:15488
  ds_read_b128 v[100:103], v14 offset:608
  ds_read_b64_tr_b16 v[116:117], v15 offset:17408
  ds_read_b64_tr_b16 v[118:119], v15 offset:18048
  s_waitcnt lgkmcnt(9)
  v_mfma_f32_32x32x16_bf16 v[32:47], v[88:91], v[104:107], v[32:47]
  s_waitcnt lgkmcnt(6)
  v_mfma_f32_32x32x16_bf16 v[32:47], v[92:95], v[108:111], v[32:47]
  s_waitcnt lgkmcnt(3)
  v_mfma_f32_32x32x16_bf16 v[32:47], v[96:99], v[112:115], v[32:47]
  s_waitcnt lgkmcnt(0)
  v_mfma_f32_32x32x16_bf16 v[32:47], v[100:103], v[116:119], v[32:47]
  s_waitcnt vmcnt(8)
  ds_write_b128 v10, v[136:139] offset:19968
  ds_write_b128 v10, v[140:143] offset:24576
  ds_write_b128 v13, v[144:147] offset:29184
  ds_write_b128 v13, v[148:151] offset:34304
  s_waitcnt lgkmcnt(0)
  s_barrier
  buffer_load_dwordx4 v[136:139], v8, s[4:7], 0 offen offset:768
  buffer_load_dwordx4 v[140:143], v9, s[4:7], 0 offen offset:768
  s_mov_b32 s29, 393216
  buffer_load_dwordx4 v[144:147], v11, s[8:11], s29 offen
  buffer_load_dwordx4 v[148:151], v12, s[8:11], s29 offen
  ds_read_b128 v[88:91], v14 offset:19968
  ds_read_b64_tr_b16 v[104:105], v15 offset:29184
  ds_read_b64_tr_b16 v[106:107], v15 offset:29824
  ds_read_b128 v[92:95], v14 offset:20000
  ds_read_b64_tr_b16 v[108:109], v15 offset:31744
  ds_read_b64_tr_b16 v[110:111], v15 offset:32384
  ds_read_b128 v[96:99], v14 offset:20032
  ds_read_b64_tr_b16 v[112:113], v15 offset:34304
  ds_read_b64_tr_b16 v[114:115], v15 offset:34944
  ds_read_b128 v[100:103], v14 offset:20064
  ds_read_b64_tr_b16 v[116:117], v15 offset:36864
  ds_read_b64_tr_b16 v[118:119], v15 offset:37504
  s_waitcnt lgkmcnt(9)
  v_mfma_f32_32x32x16_bf16 v[32:47], v[88:91], v[104:107], v[32:47]
  s_waitcnt lgkmcnt(6)
  v_mfma_f32_32x32x16_bf16 v[32:47], v[92:95], v[108:111], v[32:47]
  s_waitcnt lgkmcnt(3)
  v_mfma_f32_32x32x16_bf16 v[32:47], v[96:99], v[112:115], v[32:47]
  s_waitcnt lgkmcnt(0)
  v_mfma_f32_32x32x16_bf16 v[32:47], v[100:103], v[116:119], v[32:47]
  s_waitcnt vmcnt(8)
  ds_write_b128 v10, v[152:155] offset:512
  ds_write_b128 v10, v[156:159] offset:5120
  ds_write_b128 v13, v[160:163] offset:9728
  ds_write_b128 v13, v[164:167] offset:14848
  s_waitcnt lgkmcnt(0)
  s_barrier
  buffer_load_dwordx4 v[152:155], v8, s[4:7], 0 offen offset:896
  buffer_load_dwordx4 v[156:159], v9, s[4:7], 0 offen offset:896
  s_mov_b32 s29, 458752
  buffer_load_dwordx4 v[160:163], v11, s[8:11], s29 offen
  buffer_load_dwordx4 v[164:167], v12, s[8:11], s29 offen
  ds_read_b128 v[88:91], v14 offset:512
  ds_read_b64_tr_b16 v[104:105], v15 offset:9728
  ds_read_b64_tr_b16 v[106:107], v15 offset:10368
  ds_read_b128 v[92:95], v14 offset:544
  ds_read_b64_tr_b16 v[108:109], v15 offset:12288
  ds_read_b64_tr_b16 v[110:111], v15 offset:12928
  ds_read_b128 v[96:99], v14 offset:576
  ds_read_b64_tr_b16 v[112:113], v15 offset:14848
  ds_read_b64_tr_b16 v[114:115], v15 offset:15488
  ds_read_b128 v[100:103], v14 offset:608
  ds_read_b64_tr_b16 v[116:117], v15 offset:17408
  ds_read_b64_tr_b16 v[118:119], v15 offset:18048
  s_waitcnt lgkmcnt(9)
  v_mfma_f32_32x32x16_bf16 v[32:47], v[88:91], v[104:107], v[32:47]
  s_waitcnt lgkmcnt(6)
  v_mfma_f32_32x32x16_bf16 v[32:47], v[92:95], v[108:111], v[32:47]
  s_waitcnt lgkmcnt(3)
  v_mfma_f32_32x32x16_bf16 v[32:47], v[96:99], v[112:115], v[32:47]
  s_waitcnt lgkmcnt(0)
  v_mfma_f32_32x32x16_bf16 v[32:47], v[100:103], v[116:119], v[32:47]
  s_waitcnt vmcnt(8)
  ds_write_b128 v10, v[168:171] offset:19968
  ds_write_b128 v10, v[172:175] offset:24576
  ds_write_b128 v13, v[176:179] offset:29184
  ds_write_b128 v13, v[180:183] offset:34304
  s_waitcnt lgkmcnt(0)
  s_barrier
  ds_read_b128 v[88:91], v14 offset:19968
  ds_read_b64_tr_b16 v[104:105], v15 offset:29184
  ds_read_b64_tr_b16 v[106:107], v15 offset:29824
  ds_read_b128 v[92:95], v14 offset:20000
  ds_read_b64_tr_b16 v[108:109], v15 offset:31744
  ds_read_b64_tr_b16 v[110:111], v15 offset:32384
  ds_read_b128 v[96:99], v14 offset:20032
  ds_read_b64_tr_b16 v[112:113], v15 offset:34304
  ds_read_b64_tr_b16 v[114:115], v15 offset:34944
  ds_read_b128 v[100:103], v14 offset:20064
  ds_read_b64_tr_b16 v[116:117], v15 offset:36864
  ds_read_b64_tr_b16 v[118:119], v15 offset:37504
  s_waitcnt lgkmcnt(9)
  v_mfma_f32_32x32x16_bf16 v[32:47], v[88:91], v[104:107], v[32:47]
  s_waitcnt lgkmcnt(6)
  v_mfma_f32_32x32x16_bf16 v[32:47], v[92:95], v[108:111], v[32:47]
  s_waitcnt lgkmcnt(3)
  v_mfma_f32_32x32x16_bf16 v[32:47], v[96:99], v[112:115], v[32:47]
  s_waitcnt lgkmcnt(0)
  v_mfma_f32_32x32x16_bf16 v[32:47], v[100:103], v[116:119], v[32:47]
  s_waitcnt vmcnt(4)
  ds_write_b128 v10, v[136:139] offset:512
  ds_write_b128 v10, v[140:143] offset:5120
  ds_write_b128 v13, v[144:147] offset:9728
  ds_write_b128 v13, v[148:151] offset:14848
  s_waitcnt lgkmcnt(0)
  s_barrier
  ds_read_b128 v[88:91], v14 offset:512
  ds_read_b64_tr_b16 v[104:105], v15 offset:9728
  ds_read_b64_tr_b16 v[106:107], v15 offset:10368
  ds_read_b128 v[92:95], v14 offset:544
  ds_read_b64_tr_b16 v[108:109], v15 offset:12288
  ds_read_b64_tr_b16 v[110:111], v15 offset:12928
  ds_read_b128 v[96:99], v14 offset:576
  ds_read_b64_tr_b16 v[112:113], v15 offset:14848
  ds_read_b64_tr_b16 v[114:115], v15 offset:15488
  ds_read_b128 v[100:103], v14 offset:608
  ds_read_b64_tr_b16 v[116:117], v15 offset:17408
  ds_read_b64_tr_b16 v[118:119], v15 offset:18048
  s_waitcnt lgkmcnt(9)
  v_mfma_f32_32x32x16_bf16 v[32:47], v[88:91], v[104:107], v[32:47]
  s_waitcnt lgkmcnt(6)
  v_mfma_f32_32x32x16_bf16 v[32:47], v[92:95], v[108:111], v[32:47]
  s_waitcnt lgkmcnt(3)
  v_mfma_f32_32x32x16_bf16 v[32:47], v[96:99], v[112:115], v[32:47]
  s_waitcnt lgkmcnt(0)
  v_mfma_f32_32x32x16_bf16 v[32:47], v[100:103], v[116:119], v[32:47]
  s_waitcnt vmcnt(0)
  ds_write_b128 v10, v[152:155] offset:19968
  ds_write_b128 v10, v[156:159] offset:24576
  ds_write_b128 v13, v[160:163] offset:29184
  ds_write_b128 v13, v[164:167] offset:34304
  s_waitcnt lgkmcnt(0)
  s_barrier
  ds_read_b128 v[88:91], v14 offset:19968
  ds_read_b64_tr_b16 v[104:105], v15 offset:29184
  ds_read_b64_tr_b16 v[106:107], v15 offset:29824
  ds_read_b128 v[92:95], v14 offset:20000
  ds_read_b64_tr_b16 v[108:109], v15 offset:31744
  ds_read_b64_tr_b16 v[110:111], v15 offset:32384
  ds_read_b128 v[96:99], v14 offset:20032
  ds_read_b64_tr_b16 v[112:113], v15 offset:34304
  ds_read_b64_tr_b16 v[114:115], v15 offset:34944
  ds_read_b128 v[100:103], v14 offset:20064
  ds_read_b64_tr_b16 v[116:117], v15 offset:36864
  ds_read_b64_tr_b16 v[118:119], v15 offset:37504
  s_waitcnt lgkmcnt(9)
  v_mfma_f32_32x32x16_bf16 v[32:47], v[88:91], v[104:107], v[32:47]
  s_waitcnt lgkmcnt(6)
  v_mfma_f32_32x32x16_bf16 v[32:47], v[92:95], v[108:111], v[32:47]
  s_waitcnt lgkmcnt(3)
  v_mfma_f32_32x32x16_bf16 v[32:47], v[96:99], v[112:115], v[32:47]
  s_waitcnt lgkmcnt(0)
  v_mfma_f32_32x32x16_bf16 v[32:47], v[100:103], v[116:119], v[32:47]
  s_nop 15
  v_lshrrev_b32 v5, 1, v2
  v_and_b32 v6, 1, v2
  v_lshlrev_b32 v7, 5, v5
  v_lshl_add_u32 v7, v3, 2, v7
  v_add_u32 v7, s24, v7
  s_mov_b32 s28, 1024
  v_mul_lo_u32 v8, v7, s28
  v_lshl_add_u32 v9, v6, 5, v4
  v_add_u32 v9, s25, v9
  v_lshl_add_u32 v8, v9, 1, v8
  s_mov_b32 s29, 0
  buffer_load_ushort v64, v8, s[20:23], s29 offen
  s_mov_b32 s29, 1024
  buffer_load_ushort v65, v8, s[20:23], s29 offen
  s_mov_b32 s29, 2048
  buffer_load_ushort v66, v8, s[20:23], s29 offen
  s_mov_b32 s29, 3072
  buffer_load_ushort v67, v8, s[20:23], s29 offen
  s_mov_b32 s29, 8192
  buffer_load_ushort v68, v8, s[20:23], s29 offen
  s_mov_b32 s29, 9216
  buffer_load_ushort v69, v8, s[20:23], s29 offen
  s_mov_b32 s29, 10240
  buffer_load_ushort v70, v8, s[20:23], s29 offen
  s_mov_b32 s29, 11264
  buffer_load_ushort v71, v8, s[20:23], s29 offen
  s_mov_b32 s29, 16384
  buffer_load_ushort v72, v8, s[20:23], s29 offen
  s_mov_b32 s29, 17408
  buffer_load_ushort v73, v8, s[20:23], s29 offen
  s_mov_b32 s29, 18432
  buffer_load_ushort v74, v8, s[20:23], s29 offen
  s_mov_b32 s29, 19456
  buffer_load_ushort v75, v8, s[20:23], s29 offen
  s_mov_b32 s29, 24576
  buffer_load_ushort v76, v8, s[20:23], s29 offen
  s_mov_b32 s29, 25600
  buffer_load_ushort v77, v8, s[20:23], s29 offen
  s_mov_b32 s29, 26624
  buffer_load_ushort v78, v8, s[20:23], s29 offen
  s_mov_b32 s29, 27648
  buffer_load_ushort v79, v8, s[20:23], s29 offen
  s_waitcnt vmcnt(0)
  v_lshlrev_b32 v64, 16, v64
  v_add_f32 v32, v32, v64
  v_lshlrev_b32 v65, 16, v65
  v_add_f32 v33, v33, v65
  v_lshlrev_b32 v66, 16, v66
  v_add_f32 v34, v34, v66
  v_lshlrev_b32 v67, 16, v67
  v_add_f32 v35, v35, v67
  v_lshlrev_b32 v68, 16, v68
  v_add_f32 v36, v36, v68
  v_lshlrev_b32 v69, 16, v69
  v_add_f32 v37, v37, v69
  v_lshlrev_b32 v70, 16, v70
  v_add_f32 v38, v38, v70
  v_lshlrev_b32 v71, 16, v71
  v_add_f32 v39, v39, v71
  v_lshlrev_b32 v72, 16, v72
  v_add_f32 v40, v40, v72
  v_lshlrev_b32 v73, 16, v73
  v_add_f32 v41, v41, v73
  v_lshlrev_b32 v74, 16, v74
  v_add_f32 v42, v42, v74
  v_lshlrev_b32 v75, 16, v75
  v_add_f32 v43, v43, v75
  v_lshlrev_b32 v76, 16, v76
  v_add_f32 v44, v44, v76
  v_lshlrev_b32 v77, 16, v77
  v_add_f32 v45, v45, v77
  v_lshlrev_b32 v78, 16, v78
  v_add_f32 v46, v46, v78
  v_lshlrev_b32 v79, 16, v79
  v_add_f32 v47, v47, v79
  v_cvt_pk_bf16_f32 v32, v32, v32
  s_mov_b32 s29, 0
  buffer_store_short v32, v8, s[16:19], s29 offen
  v_cvt_pk_bf16_f32 v33, v33, v33
  s_mov_b32 s29, 1024
  buffer_store_short v33, v8, s[16:19], s29 offen
  v_cvt_pk_bf16_f32 v34, v34, v34
  s_mov_b32 s29, 2048
  buffer_store_short v34, v8, s[16:19], s29 offen
  v_cvt_pk_bf16_f32 v35, v35, v35
  s_mov_b32 s29, 3072
  buffer_store_short v35, v8, s[16:19], s29 offen
  v_cvt_pk_bf16_f32 v36, v36, v36
  s_mov_b32 s29, 8192
  buffer_store_short v36, v8, s[16:19], s29 offen
  v_cvt_pk_bf16_f32 v37, v37, v37
  s_mov_b32 s29, 9216
  buffer_store_short v37, v8, s[16:19], s29 offen
  v_cvt_pk_bf16_f32 v38, v38, v38
  s_mov_b32 s29, 10240
  buffer_store_short v38, v8, s[16:19], s29 offen
  v_cvt_pk_bf16_f32 v39, v39, v39
  s_mov_b32 s29, 11264
  buffer_store_short v39, v8, s[16:19], s29 offen
  v_cvt_pk_bf16_f32 v40, v40, v40
  s_mov_b32 s29, 16384
  buffer_store_short v40, v8, s[16:19], s29 offen
  v_cvt_pk_bf16_f32 v41, v41, v41
  s_mov_b32 s29, 17408
  buffer_store_short v41, v8, s[16:19], s29 offen
  v_cvt_pk_bf16_f32 v42, v42, v42
  s_mov_b32 s29, 18432
  buffer_store_short v42, v8, s[16:19], s29 offen
  v_cvt_pk_bf16_f32 v43, v43, v43
  s_mov_b32 s29, 19456
  buffer_store_short v43, v8, s[16:19], s29 offen
  v_cvt_pk_bf16_f32 v44, v44, v44
  s_mov_b32 s29, 24576
  buffer_store_short v44, v8, s[16:19], s29 offen
  v_cvt_pk_bf16_f32 v45, v45, v45
  s_mov_b32 s29, 25600
  buffer_store_short v45, v8, s[16:19], s29 offen
  v_cvt_pk_bf16_f32 v46, v46, v46
  s_mov_b32 s29, 26624
  buffer_store_short v46, v8, s[16:19], s29 offen
  v_cvt_pk_bf16_f32 v47, v47, v47
  s_mov_b32 s29, 27648
  buffer_store_short v47, v8, s[16:19], s29 offen
L_oproj_kernel_end:
  s_endpgm
.p2align 8
.globl glu_kernel
.type glu_kernel,@function
glu_kernel:
  s_cmp_ge_u32 s2, 704
  s_cbranch_scc1 L_glu_kernel_end
  s_and_b32 s24, s2, 31
  s_lshl_b32 s24, s24, 6
  s_lshr_b32 s25, s2, 5
  s_lshl_b32 s25, s25, 6
  s_load_dwordx2 s[4:5], s[0:1], 88
  s_load_dwordx2 s[8:9], s[0:1], 48
  s_load_dwordx2 s[12:13], s[0:1], 56
  s_load_dwordx2 s[16:17], s[0:1], 88
  s_waitcnt lgkmcnt(0)
  s_add_u32 s4, s4, 5242880
  s_addc_u32 s5, s5, 0
  s_mov_b32 s6, 2097152
  s_mov_b32 s7, 0x00020000
  s_mov_b32 s10, 1409024
  s_mov_b32 s11, 0x00020000
  s_mov_b32 s14, 1409024
  s_mov_b32 s15, 0x00020000
  s_add_u32 s16, s16, 7340032
  s_addc_u32 s17, s17, 0
  s_mov_b32 s18, 5636096
  s_mov_b32 s19, 0x00020000
  s_mov_b32 s26, 1024
  s_mov_b32 s27, 2752
  v_and_b32 v1, 63, v0
  v_lshrrev_b32 v2, 6, v0
  v_lshrrev_b32 v3, 5, v1
  v_and_b32 v4, 31, v1
  v_lshrrev_b32 v5, 4, v1
  v_lshl_add_u32 v5, v2, 4, v5
  v_add_u32 v5, s24, v5
  v_mul_lo_u32 v5, v5, s26
  v_and_b32 v6, 15, v1
  v_lshl_add_u32 v5, v6, 4, v5
  s_mov_b32 s30, 0
  buffer_load_dwordx4 v[64:67], v5, s[4:7], s30 offen offset:0
  s_mov_b32 s30, 0
  buffer_load_dwordx4 v[68:71], v5, s[4:7], s30 offen offset:256
  s_mov_b32 s30, 0
  buffer_load_dwordx4 v[72:75], v5, s[4:7], s30 offen offset:512
  s_mov_b32 s30, 0
  buffer_load_dwordx4 v[76:79], v5, s[4:7], s30 offen offset:768
  s_mov_b32 s30, 4096
  buffer_load_dwordx4 v[80:83], v5, s[4:7], s30 offen offset:0
  s_mov_b32 s30, 4096
  buffer_load_dwordx4 v[84:87], v5, s[4:7], s30 offen offset:256
  s_mov_b32 s30, 4096
  buffer_load_dwordx4 v[88:91], v5, s[4:7], s30 offen offset:512
  s_mov_b32 s30, 4096
  buffer_load_dwordx4 v[92:95], v5, s[4:7], s30 offen offset:768
  s_mov_b32 s30, 8192
  buffer_load_dwordx4 v[96:99], v5, s[4:7], s30 offen offset:0
  s_mov_b32 s30, 8192
  buffer_load_dwordx4 v[100:103], v5, s[4:7], s30 offen offset:256
  s_mov_b32 s30, 8192
  buffer_load_dwordx4 v[104:107], v5, s[4:7], s30 offen offset:512
  s_mov_b32 s30, 8192
  buffer_load_dwordx4 v[108:111], v5, s[4:7], s30 offen offset:768
  s_mov_b32 s30, 12288
  buffer_load_dwordx4 v[112:115], v5, s[4:7], s30 offen offset:0
  s_mov_b32 s30, 12288
  buffer_load_dwordx4 v[116:119], v5, s[4:7], s30 offen offset:256
  s_mov_b32 s30, 12288
  buffer_load_dwordx4 v[120:123], v5, s[4:7], s30 offen offset:512
  s_mov_b32 s30, 12288
  buffer_load_dwordx4 v[124:127], v5, s[4:7], s30 offen offset:768
  s_mov_b32 s31, 0x3f803f80
  s_waitcnt vmcnt(0)
  v_dot2_f32_bf16 v8, v64, s31, 0
  v_dot2_f32_bf16 v9, v64, v64, 0
  v_dot2_f32_bf16 v8, v65, s31, v8
  v_dot2_f32_bf16 v9, v65, v65, v9
  v_dot2_f32_bf16 v8, v66, s31, v8
  v_dot2_f32_bf16 v9, v66, v66, v9
  v_dot2_f32_bf16 v8, v67, s31, v8
  v_dot2_f32_bf16 v9, v67, v67, v9
  v_dot2_f32_bf16 v8, v68, s31, v8
  v_dot2_f32_bf16 v9, v68, v68, v9
  v_dot2_f32_bf16 v8, v69, s31, v8
  v_dot2_f32_bf16 v9, v69, v69, v9
  v_dot2_f32_bf16 v8, v70, s31, v8
  v_dot2_f32_bf16 v9, v70, v70, v9
  v_dot2_f32_bf16 v8, v71, s31, v8
  v_dot2_f32_bf16 v9, v71, v71, v9
  v_dot2_f32_bf16 v8, v72, s31, v8
  v_dot2_f32_bf16 v9, v72, v72, v9
  v_dot2_f32_bf16 v8, v73, s31, v8
  v_dot2_f32_bf16 v9, v73, v73, v9
  v_dot2_f32_bf16 v8, v74, s31, v8
  v_dot2_f32_bf16 v9, v74, v74, v9
  v_dot2_f32_bf16 v8, v75, s31, v8
  v_dot2_f32_bf16 v9, v75, v75, v9
  v_dot2_f32_bf16 v8, v76, s31, v8
  v_dot2_f32_bf16 v9, v76, v76, v9
  v_dot2_f32_bf16 v8, v77, s31, v8
  v_dot2_f32_bf16 v9, v77, v77, v9
  v_dot2_f32_bf16 v8, v78, s31, v8
  v_dot2_f32_bf16 v9, v78, v78, v9
  v_dot2_f32_bf16 v8, v79, s31, v8
  v_dot2_f32_bf16 v9, v79, v79, v9
  v_dot2_f32_bf16 v10, v80, s31, 0
  v_dot2_f32_bf16 v11, v80, v80, 0
  v_dot2_f32_bf16 v10, v81, s31, v10
  v_dot2_f32_bf16 v11, v81, v81, v11
  v_dot2_f32_bf16 v10, v82, s31, v10
  v_dot2_f32_bf16 v11, v82, v82, v11
  v_dot2_f32_bf16 v10, v83, s31, v10
  v_dot2_f32_bf16 v11, v83, v83, v11
  v_dot2_f32_bf16 v10, v84, s31, v10
  v_dot2_f32_bf16 v11, v84, v84, v11
  v_dot2_f32_bf16 v10, v85, s31, v10
  v_dot2_f32_bf16 v11, v85, v85, v11
  v_dot2_f32_bf16 v10, v86, s31, v10
  v_dot2_f32_bf16 v11, v86, v86, v11
  v_dot2_f32_bf16 v10, v87, s31, v10
  v_dot2_f32_bf16 v11, v87, v87, v11
  v_dot2_f32_bf16 v10, v88, s31, v10
  v_dot2_f32_bf16 v11, v88, v88, v11
  v_dot2_f32_bf16 v10, v89, s31, v10
  v_dot2_f32_bf16 v11, v89, v89, v11
  v_dot2_f32_bf16 v10, v90, s31, v10
  v_dot2_f32_bf16 v11, v90, v90, v11
  v_dot2_f32_bf16 v10, v91, s31, v10
  v_dot2_f32_bf16 v11, v91, v91, v11
  v_dot2_f32_bf16 v10, v92, s31, v10
  v_dot2_f32_bf16 v11, v92, v92, v11
  v_dot2_f32_bf16 v10, v93, s31, v10
  v_dot2_f32_bf16 v11, v93, v93, v11
  v_dot2_f32_bf16 v10, v94, s31, v10
  v_dot2_f32_bf16 v11, v94, v94, v11
  v_dot2_f32_bf16 v10, v95, s31, v10
  v_dot2_f32_bf16 v11, v95, v95, v11
  v_dot2_f32_bf16 v12, v96, s31, 0
  v_dot2_f32_bf16 v13, v96, v96, 0
  v_dot2_f32_bf16 v12, v97, s31, v12
  v_dot2_f32_bf16 v13, v97, v97, v13
  v_dot2_f32_bf16 v12, v98, s31, v12
  v_dot2_f32_bf16 v13, v98, v98, v13
  v_dot2_f32_bf16 v12, v99, s31, v12
  v_dot2_f32_bf16 v13, v99, v99, v13
  v_dot2_f32_bf16 v12, v100, s31, v12
  v_dot2_f32_bf16 v13, v100, v100, v13
  v_dot2_f32_bf16 v12, v101, s31, v12
  v_dot2_f32_bf16 v13, v101, v101, v13
  v_dot2_f32_bf16 v12, v102, s31, v12
  v_dot2_f32_bf16 v13, v102, v102, v13
  v_dot2_f32_bf16 v12, v103, s31, v12
  v_dot2_f32_bf16 v13, v103, v103, v13
  v_dot2_f32_bf16 v12, v104, s31, v12
  v_dot2_f32_bf16 v13, v104, v104, v13
  v_dot2_f32_bf16 v12, v105, s31, v12
  v_dot2_f32_bf16 v13, v105, v105, v13
  v_dot2_f32_bf16 v12, v106, s31, v12
  v_dot2_f32_bf16 v13, v106, v106, v13
  v_dot2_f32_bf16 v12, v107, s31, v12
  v_dot2_f32_bf16 v13, v107, v107, v13
  v_dot2_f32_bf16 v12, v108, s31, v12
  v_dot2_f32_bf16 v13, v108, v108, v13
  v_dot2_f32_bf16 v12, v109, s31, v12
  v_dot2_f32_bf16 v13, v109, v109, v13
  v_dot2_f32_bf16 v12, v110, s31, v12
  v_dot2_f32_bf16 v13, v110, v110, v13
  v_dot2_f32_bf16 v12, v111, s31, v12
  v_dot2_f32_bf16 v13, v111, v111, v13
  v_dot2_f32_bf16 v14, v112, s31, 0
  v_dot2_f32_bf16 v15, v112, v112, 0
  v_dot2_f32_bf16 v14, v113, s31, v14
  v_dot2_f32_bf16 v15, v113, v113, v15
  v_dot2_f32_bf16 v14, v114, s31, v14
  v_dot2_f32_bf16 v15, v114, v114, v15
  v_dot2_f32_bf16 v14, v115, s31, v14
  v_dot2_f32_bf16 v15, v115, v115, v15
  v_dot2_f32_bf16 v14, v116, s31, v14
  v_dot2_f32_bf16 v15, v116, v116, v15
  v_dot2_f32_bf16 v14, v117, s31, v14
  v_dot2_f32_bf16 v15, v117, v117, v15
  v_dot2_f32_bf16 v14, v118, s31, v14
  v_dot2_f32_bf16 v15, v118, v118, v15
  v_dot2_f32_bf16 v14, v119, s31, v14
  v_dot2_f32_bf16 v15, v119, v119, v15
  v_dot2_f32_bf16 v14, v120, s31, v14
  v_dot2_f32_bf16 v15, v120, v120, v15
  v_dot2_f32_bf16 v14, v121, s31, v14
  v_dot2_f32_bf16 v15, v121, v121, v15
  v_dot2_f32_bf16 v14, v122, s31, v14
  v_dot2_f32_bf16 v15, v122, v122, v15
  v_dot2_f32_bf16 v14, v123, s31, v14
  v_dot2_f32_bf16 v15, v123, v123, v15
  v_dot2_f32_bf16 v14, v124, s31, v14
  v_dot2_f32_bf16 v15, v124, v124, v15
  v_dot2_f32_bf16 v14, v125, s31, v14
  v_dot2_f32_bf16 v15, v125, v125, v15
  v_dot2_f32_bf16 v14, v126, s31, v14
  v_dot2_f32_bf16 v15, v126, v126, v15
  v_dot2_f32_bf16 v14, v127, s31, v14
  v_dot2_f32_bf16 v15, v127, v127, v15
  v_add_f32_dpp v16, v8, v8 row_ror:1 row_mask:0xf bank_mask:0xf
  v_add_f32_dpp v17, v9, v9 row_ror:1 row_mask:0xf bank_mask:0xf
  v_add_f32_dpp v18, v10, v10 row_ror:1 row_mask:0xf bank_mask:0xf
  v_add_f32_dpp v19, v11, v11 row_ror:1 row_mask:0xf bank_mask:0xf
  v_add_f32_dpp v20, v12, v12 row_ror:1 row_mask:0xf bank_mask:0xf
  v_add_f32_dpp v21, v13, v13 row_ror:1 row_mask:0xf bank_mask:0xf
  v_add_f32_dpp v22, v14, v14 row_ror:1 row_mask:0xf bank_mask:0xf
  v_add_f32_dpp v23, v15, v15 row_ror:1 row_mask:0xf bank_mask:0xf
  v_mov_b32 v8, v16
  v_mov_b32 v9, v17
  v_mov_b32 v10, v18
  v_mov_b32 v11, v19
  v_mov_b32 v12, v20
  v_mov_b32 v13, v21
  v_mov_b32 v14, v22
  v_mov_b32 v15, v23
  v_add_f32_dpp v16, v8, v8 row_ror:2 row_mask:0xf bank_mask:0xf
  v_add_f32_dpp v17, v9, v9 row_ror:2 row_mask:0xf bank_mask:0xf
  v_add_f32_dpp v18, v10, v10 row_ror:2 row_mask:0xf bank_mask:0xf
  v_add_f32_dpp v19, v11, v11 row_ror:2 row_mask:0xf bank_mask:0xf
  v_add_f32_dpp v20, v12, v12 row_ror:2 row_mask:0xf bank_mask:0xf
  v_add_f32_dpp v21, v13, v13 row_ror:2 row_mask:0xf bank_mask:0xf
  v_add_f32_dpp v22, v14, v14 row_ror:2 row_mask:0xf bank_mask:0xf
  v_add_f32_dpp v23, v15, v15 row_ror:2 row_mask:0xf bank_mask:0xf
  v_mov_b32 v8, v16
  v_mov_b32 v9, v17
  v_mov_b32 v10, v18
  v_mov_b32 v11, v19
  v_mov_b32 v12, v20
  v_mov_b32 v13, v21
  v_mov_b32 v14, v22
  v_mov_b32 v15, v23
  v_add_f32_dpp v16, v8, v8 row_ror:4 row_mask:0xf bank_mask:0xf
  v_add_f32_dpp v17, v9, v9 row_ror:4 row_mask:0xf bank_mask:0xf
  v_add_f32_dpp v18, v10, v10 row_ror:4 row_mask:0xf bank_mask:0xf
  v_add_f32_dpp v19, v11, v11 row_ror:4 row_mask:0xf bank_mask:0xf
  v_add_f32_dpp v20, v12, v12 row_ror:4 row_mask:0xf bank_mask:0xf
  v_add_f32_dpp v21, v13, v13 row_ror:4 row_mask:0xf bank_mask:0xf
  v_add_f32_dpp v22, v14, v14 row_ror:4 row_mask:0xf bank_mask:0xf
  v_add_f32_dpp v23, v15, v15 row_ror:4 row_mask:0xf bank_mask:0xf
  v_mov_b32 v8, v16
  v_mov_b32 v9, v17
  v_mov_b32 v10, v18
  v_mov_b32 v11, v19
  v_mov_b32 v12, v20
  v_mov_b32 v13, v21
  v_mov_b32 v14, v22
  v_mov_b32 v15, v23
  v_add_f32_dpp v16, v8, v8 row_ror:8 row_mask:0xf bank_mask:0xf
  v_add_f32_dpp v17, v9, v9 row_ror:8 row_mask:0xf bank_mask:0xf
  v_add_f32_dpp v18, v10, v10 row_ror:8 row_mask:0xf bank_mask:0xf
  v_add_f32_dpp v19, v11, v11 row_ror:8 row_mask:0xf bank_mask:0xf
  v_add_f32_dpp v20, v12, v12 row_ror:8 row_mask:0xf bank_mask:0xf
  v_add_f32_dpp v21, v13, v13 row_ror:8 row_mask:0xf bank_mask:0xf
  v_add_f32_dpp v22, v14, v14 row_ror:8 row_mask:0xf bank_mask:0xf
  v_add_f32_dpp v23, v15, v15 row_ror:8 row_mask:0xf bank_mask:0xf
  v_mov_b32 v8, v16
  v_mov_b32 v9, v17
  v_mov_b32 v10, v18
  v_mov_b32 v11, v19
  v_mov_b32 v12, v20
  v_mov_b32 v13, v21
  v_mov_b32 v14, v22
  v_mov_b32 v15, v23
  s_mov_b32 s31, 989855744
  s_mov_b32 s30, 925353388
  v_lshrrev_b32 v6, 4, v1
  v_lshl_add_u32 v6, v2, 4, v6
  v_lshlrev_b32 v6, 3, v6
  v_mul_f32 v8, s31, v8
  v_mul_f32 v9, s31, v9
  v_fma_f32 v9, -v8, v8, v9
  v_max_f32 v9, 0, v9
  v_add_f32 v9, s30, v9
  v_rsq_f32 v9, v9
  s_nop 0
  v_mul_f32 v8, v8, v9
  v_sub_f32 v8, 0, v8
  ds_write_b64 v6, v[8:9] offset:0
  v_mul_f32 v10, s31, v10
  v_mul_f32 v11, s31, v11
  v_fma_f32 v11, -v10, v10, v11
  v_max_f32 v11, 0, v11
  v_add_f32 v11, s30, v11
  v_rsq_f32 v11, v11
  s_nop 0
  v_mul_f32 v10, v10, v11
  v_sub_f32 v10, 0, v10
  ds_write_b64 v6, v[10:11] offset:32
  v_mul_f32 v12, s31, v12
  v_mul_f32 v13, s31, v13
  v_fma_f32 v13, -v12, v12, v13
  v_max_f32 v13, 0, v13
  v_add_f32 v13, s30, v13
  v_rsq_f32 v13, v13
  s_nop 0
  v_mul_f32 v12, v12, v13
  v_sub_f32 v12, 0, v12
  ds_write_b64 v6, v[12:13] offset:64
  v_mul_f32 v14, s31, v14
  v_mul_f32 v15, s31, v15
  v_fma_f32 v15, -v14, v14, v15
  v_max_f32 v15, 0, v15
  v_add_f32 v15, s30, v15
  v_rsq_f32 v15, v15
  s_nop 0
  v_mul_f32 v14, v14, v15
  v_sub_f32 v14, 0, v14
  ds_write_b64 v6, v[14:15] offset:96
  s_waitcnt lgkmcnt(0)
  s_barrier
  v_lshrrev_b32 v6, 3, v0
  v_lshlrev_b32 v6, 3, v6
  ds_read_b64 v[24:25], v6 offset:0
  ds_read_b64 v[26:27], v6 offset:256
  v_lshrrev_b32 v5, 3, v0
  v_and_b32 v6, 7, v0
  v_add_u32 v7, s24, v5
  v_mul_lo_u32 v7, v7, s26
  v_lshl_add_u32 v8, v6, 4, v7
  v_add_u32 v9, 32768, v8
  v_mul_u32_u24 v10, 144, v5
  v_lshl_add_u32 v10, v6, 4, v10
  v_lshrrev_b32 v5, 3, v0
  v_and_b32 v6, 7, v0
  v_mul_lo_u32 v7, v5, s27
  v_lshl_add_u32 v7, v6, 4, v7
  s_lshl_b32 s28, s25, 1
  v_add_u32 v11, s28, v7
  v_add_u32 v12, 88064, v11
  v_mul_u32_u24 v13, 160, v5
  v_lshl_add_u32 v13, v6, 4, v13
  v_lshrrev_b32 v5, 1, v2
  v_and_b32 v6, 1, v2
  v_lshl_add_u32 v7, v5, 5, v4
  v_mul_u32_u24 v14, 144, v7
  v_lshl_add_u32 v14, v3, 4, v14
  v_and_b32 v7, 15, v1
  v_lshrrev_b32 v7, 2, v7
  v_lshl_add_u32 v7, v3, 3, v7
  v_mul_u32_u24 v15, 160, v7
  v_lshl_add_u32 v15, v6, 6, v15
  v_lshrrev_b32 v7, 4, v1
  v_and_b32 v7, 1, v7
  v_lshl_add_u32 v15, v7, 5, v15
  v_and_b32 v7, 3, v1
  v_lshl_add_u32 v15, v7, 3, v15
  s_waitcnt lgkmcnt(0)
  buffer_load_dwordx4 v[136:139], v8, s[4:7], 0 offen offset:0
  buffer_load_dwordx4 v[140:143], v9, s[4:7], 0 offen offset:0
  s_mov_b32 s29, 0
  buffer_load_dwordx4 v[144:147], v11, s[8:11], s29 offen
  buffer_load_dwordx4 v[148:151], v12, s[8:11], s29 offen
  buffer_load_dwordx4 v[152:155], v11, s[12:15], s29 offen
  buffer_load_dwordx4 v[156:159], v12, s[12:15], s29 offen
  buffer_load_dwordx4 v[160:163], v8, s[4:7], 0 offen offset:128
  buffer_load_dwordx4 v[164:167], v9, s[4:7], 0 offen offset:128
  s_mov_b32 s29, 176128
  buffer_load_dwordx4 v[168:171], v11, s[8:11], s29 offen
  buffer_load_dwordx4 v[172:175], v12, s[8:11], s29 offen
  buffer_load_dwordx4 v[176:179], v11, s[12:15], s29 offen
  buffer_load_dwordx4 v[180:183], v12, s[12:15], s29 offen
  s_waitcnt vmcnt(6)
  v_lshlrev_b32 v28, 16, v136
  v_and_b32 v29, 0xffff0000, v136
  v_fma_f32 v28, v28, v25, v24
  v_fma_f32 v29, v29, v25, v24
  v_cvt_pk_bf16_f32 v136, v28, v29
  v_lshlrev_b32 v28, 16, v137
  v_and_b32 v29, 0xffff0000, v137
  v_fma_f32 v28, v28, v25, v24
  v_fma_f32 v29, v29, v25, v24
  v_cvt_pk_bf16_f32 v137, v28, v29
  v_lshlrev_b32 v28, 16, v138
  v_and_b32 v29, 0xffff0000, v138
  v_fma_f32 v28, v28, v25, v24
  v_fma_f32 v29, v29, v25, v24
  v_cvt_pk_bf16_f32 v138, v28, v29
  v_lshlrev_b32 v28, 16, v139
  v_and_b32 v29, 0xffff0000, v139
  v_fma_f32 v28, v28, v25, v24
  v_fma_f32 v29, v29, v25, v24
  v_cvt_pk_bf16_f32 v139, v28, v29
  v_lshlrev_b32 v28, 16, v140
  v_and_b32 v29, 0xffff0000, v140
  v_fma_f32 v28, v28, v27, v26
  v_fma_f32 v29, v29, v27, v26
  v_cvt_pk_bf16_f32 v140, v28, v29
  v_lshlrev_b32 v28, 16, v141
  v_and_b32 v29, 0xffff0000, v141
  v_fma_f32 v28, v28, v27, v26
  v_fma_f32 v29, v29, v27, v26
  v_cvt_pk_bf16_f32 v141, v28, v29
  v_lshlrev_b32 v28, 16, v142
  v_and_b32 v29, 0xffff0000, v142
  v_fma_f32 v28, v28, v27, v26
  v_fma_f32 v29, v29, v27, v26
  v_cvt_pk_bf16_f32 v142, v28, v29
  v_lshlrev_b32 v28, 16, v143
  v_and_b32 v29, 0xffff0000, v143
  v_fma_f32 v28, v28, v27, v26
  v_fma_f32 v29, v29, v27, v26
  v_cvt_pk_bf16_f32 v143, v28, v29
  ds_write_b128 v10, v[136:139] offset:512
  ds_write_b128 v10, v[140:143] offset:5120
  ds_write_b128 v13, v[144:147] offset:9728
  ds_write_b128 v13, v[148:151] offset:14848
  ds_write_b128 v13, v[152:155] offset:19968
  ds_write_b128 v13, v[156:159] offset:25088
  s_waitcnt lgkmcnt(0)
  s_barrier
  buffer_load_dwordx4 v[136:139], v8, s[4:7], 0 offen offset:256
  buffer_load_dwordx4 v[140:143], v9, s[4:7], 0 offen offset:256
  s_mov_b32 s29, 352256
  buffer_load_dwordx4 v[144:147], v11, s[8:11], s29 offen
  buffer_load_dwordx4 v[148:151], v12, s[8:11], s29 offen
  buffer_load_dwordx4 v[152:155], v11, s[12:15], s29 offen
  buffer_load_dwordx4 v[156:159], v12, s[12:15], s29 offen
  ds_read_b128 v[88:91], v14 offset:512
  ds_read_b64_tr_b16 v[104:105], v15 offset:9728
  ds_read_b64_tr_b16 v[106:107], v15 offset:10368
  ds_read_b64_tr_b16 v[120:121], v15 offset:19968
  ds_read_b64_tr_b16 v[122:123], v15 offset:20608
  ds_read_b128 v[92:95], v14 offset:544
  ds_read_b64_tr_b16 v[108:109], v15 offset:12288
  ds_read_b64_tr_b16 v[110:111], v15 offset:12928
  ds_read_b64_tr_b16 v[124:125], v15 offset:22528
  ds_read_b64_tr_b16 v[126:127], v15 offset:23168
  ds_read_b128 v[96:99], v14 offset:576
  ds_read_b64_tr_b16 v[112:113], v15 offset:14848
  ds_read_b64_tr_b16 v[114:115], v15 offset:15488
  ds_read_b64_tr_b16 v[128:129], v15 offset:25088
  ds_read_b64_tr_b16 v[130:131], v15 offset:25728
  ds_read_b128 v[100:103], v14 offset:608
  ds_read_b64_tr_b16 v[116:117], v15 offset:17408
  ds_read_b64_tr_b16 v[118:119], v15 offset:18048
  ds_read_b64_tr_b16 v[132:133], v15 offset:27648
  ds_read_b64_tr_b16 v[134:135], v15 offset:28288
  s_waitcnt lgkmcnt(15)
  v_mfma_f32_32x32x16_bf16 v[32:47], v[88:91], v[104:107], 0
  v_mfma_f32_32x32x16_bf16 v[48:63], v[88:91], v[120:123], 0
  s_waitcnt lgkmcnt(10)
  v_mfma_f32_32x32x16_bf16 v[32:47], v[92:95], v[108:111], v[32:47]
  v_mfma_f32_32x32x16_bf16 v[48:63], v[92:95], v[124:127], v[48:63]
  s_waitcnt lgkmcnt(5)
  v_mfma_f32_32x32x16_bf16 v[32:47], v[96:99], v[112:115], v[32:47]
  v_mfma_f32_32x32x16_bf16 v[48:63], v[96:99], v[128:131], v[48:63]
  s_waitcnt lgkmcnt(0)
  v_mfma_f32_32x32x16_bf16 v[32:47], v[100:103], v[116:119], v[32:47]
  v_mfma_f32_32x32x16_bf16 v[48:63], v[100:103], v[132:135], v[48:63]
  s_waitcnt vmcnt(6)
  v_lshlrev_b32 v28, 16, v160
  v_and_b32 v29, 0xffff0000, v160
  v_fma_f32 v28, v28, v25, v24
  v_fma_f32 v29, v29, v25, v24
  v_cvt_pk_bf16_f32 v160, v28, v29
  v_lshlrev_b32 v28, 16, v161
  v_and_b32 v29, 0xffff0000, v161
  v_fma_f32 v28, v28, v25, v24
  v_fma_f32 v29, v29, v25, v24
  v_cvt_pk_bf16_f32 v161, v28, v29
  v_lshlrev_b32 v28, 16, v162
  v_and_b32 v29, 0xffff0000, v162
  v_fma_f32 v28, v28, v25, v24
  v_fma_f32 v29, v29, v25, v24
  v_cvt_pk_bf16_f32 v162, v28, v29
  v_lshlrev_b32 v28, 16, v163
  v_and_b32 v29, 0xffff0000, v163
  v_fma_f32 v28, v28, v25, v24
  v_fma_f32 v29, v29, v25, v24
  v_cvt_pk_bf16_f32 v163, v28, v29
  v_lshlrev_b32 v28, 16, v164
  v_and_b32 v29, 0xffff0000, v164
  v_fma_f32 v28, v28, v27, v26
  v_fma_f32 v29, v29, v27, v26
  v_cvt_pk_bf16_f32 v164, v28, v29
  v_lshlrev_b32 v28, 16, v165
  v_and_b32 v29, 0xffff0000, v165
  v_fma_f32 v28, v28, v27, v26
  v_fma_f32 v29, v29, v27, v26
  v_cvt_pk_bf16_f32 v165, v28, v29
  v_lshlrev_b32 v28, 16, v166
  v_and_b32 v29, 0xffff0000, v166
  v_fma_f32 v28, v28, v27, v26
  v_fma_f32 v29, v29, v27, v26
  v_cvt_pk_bf16_f32 v166, v28, v29
  v_lshlrev_b32 v28, 16, v167
  v_and_b32 v29, 0xffff0000, v167
  v_fma_f32 v28, v28, v27, v26
  v_fma_f32 v29, v29, v27, v26
  v_cvt_pk_bf16_f32 v167, v28, v29
  ds_write_b128 v10, v[160:163] offset:30208
  ds_write_b128 v10, v[164:167] offset:34816
  ds_write_b128 v13, v[168:171] offset:39424
  ds_write_b128 v13, v[172:175] offset:44544
  ds_write_b128 v13, v[176:179] offset:49664
  ds_write_b128 v13, v[180:183] offset:54784
  s_waitcnt lgkmcnt(0)
  s_barrier
  buffer_load_dwordx4 v[160:163], v8, s[4:7], 0 offen offset:384
  buffer_load_dwordx4 v[164:167], v9, s[4:7], 0 offen offset:384
  s_mov_b32 s29, 528384
  buffer_load_dwordx4 v[168:171], v11, s[8:11], s29 offen
  buffer_load_dwordx4 v[172:175], v12, s[8:11], s29 offen
  buffer_load_dwordx4 v[176:179], v11, s[12:15], s29 offen
  buffer_load_dwordx4 v[180:183], v12, s[12:15], s29 offen
  ds_read_b128 v[88:91], v14 offset:30208
  ds_read_b64_tr_b16 v[104:105], v15 offset:39424
  ds_read_b64_tr_b16 v[106:107], v15 offset:40064
  ds_read_b64_tr_b16 v[120:121], v15 offset:49664
  ds_read_b64_tr_b16 v[122:123], v15 offset:50304
  ds_read_b128 v[92:95], v14 offset:30240
  ds_read_b64_tr_b16 v[108:109], v15 offset:41984
  ds_read_b64_tr_b16 v[110:111], v15 offset:42624
  ds_read_b64_tr_b16 v[124:125], v15 offset:52224
  ds_read_b64_tr_b16 v[126:127], v15 offset:52864
  ds_read_b128 v[96:99], v14 offset:30272
  ds_read_b64_tr_b16 v[112:113], v15 offset:44544
  ds_read_b64_tr_b16 v[114:115], v15 offset:45184
  ds_read_b64_tr_b16 v[128:129], v15 offset:54784
  ds_read_b64_tr_b16 v[130:131], v15 offset:55424
  ds_read_b128 v[100:103], v14 offset:30304
  ds_read_b64_tr_b16 v[116:117], v15 offset:47104
  ds_read_b64_tr_b16 v[118:119], v15 offset:47744
  ds_read_b64_tr_b16 v[132:133], v15 offset:57344
  ds_read_b64_tr_b16 v[134:135], v15 offset:57984
  s_waitcnt lgkmcnt(15)
  v_mfma_f32_32x32x16_bf16 v[32:47], v[88:91], v[104:107], v[32:47]
  v_mfma_f32_32x32x16_bf16 v[48:63], v[88:91], v[120:123], v[48:63]
  s_waitcnt lgkmcnt(10)
  v_mfma_f32_32x32x16_bf16 v[32:47], v[92:95], v[108:111], v[32:47]
  v_mfma_f32_32x32x16_bf16 v[48:63], v[92:95], v[124:127], v[48:63]
  s_waitcnt lgkmcnt(5)
  v_mfma_f32_32x32x16_bf16 v[32:47], v[96:99], v[112:115], v[32:47]
  v_mfma_f32_32x32x16_bf16 v[48:63], v[96:99], v[128:131], v[48:63]
  s_waitcnt lgkmcnt(0)
  v_mfma_f32_32x32x16_bf16 v[32:47], v[100:103], v[116:119], v[32:47]
  v_mfma_f32_32x32x16_bf16 v[48:63], v[100:103], v[132:135], v[48:63]
  s_waitcnt vmcnt(6)
  v_lshlrev_b32 v28, 16, v136
  v_and_b32 v29, 0xffff0000, v136
  v_fma_f32 v28, v28, v25, v24
  v_fma_f32 v29, v29, v25, v24
  v_cvt_pk_bf16_f32 v136, v28, v29
  v_lshlrev_b32 v28, 16, v137
  v_and_b32 v29, 0xffff0000, v137
  v_fma_f32 v28, v28, v25, v24
  v_fma_f32 v29, v29, v25, v24
  v_cvt_pk_bf16_f32 v137, v28, v29
  v_lshlrev_b32 v28, 16, v138
  v_and_b32 v29, 0xffff0000, v138
  v_fma_f32 v28, v28, v25, v24
  v_fma_f32 v29, v29, v25, v24
  v_cvt_pk_bf16_f32 v138, v28, v29
  v_lshlrev_b32 v28, 16, v139
  v_and_b32 v29, 0xffff0000, v139
  v_fma_f32 v28, v28, v25, v24
  v_fma_f32 v29, v29, v25, v24
  v_cvt_pk_bf16_f32 v139, v28, v29
  v_lshlrev_b32 v28, 16, v140
  v_and_b32 v29, 0xffff0000, v140
  v_fma_f32 v28, v28, v27, v26
  v_fma_f32 v29, v29, v27, v26
  v_cvt_pk_bf16_f32 v140, v28, v29
  v_lshlrev_b32 v28, 16, v141
  v_and_b32 v29, 0xffff0000, v141
  v_fma_f32 v28, v28, v27, v26
  v_fma_f32 v29, v29, v27, v26
  v_cvt_pk_bf16_f32 v141, v28, v29
  v_lshlrev_b32 v28, 16, v142
  v_and_b32 v29, 0xffff0000, v142
  v_fma_f32 v28, v28, v27, v26
  v_fma_f32 v29, v29, v27, v26
  v_cvt_pk_bf16_f32 v142, v28, v29
  v_lshlrev_b32 v28, 16, v143
  v_and_b32 v29, 0xffff0000, v143
  v_fma_f32 v28, v28, v27, v26
  v_fma_f32 v29, v29, v27, v26
  v_cvt_pk_bf16_f32 v143, v28, v29
  ds_write_b128 v10, v[136:139] offset:512
  ds_write_b128 v10, v[140:143] offset:5120
  ds_write_b128 v13, v[144:147] offset:9728
  ds_write_b128 v13, v[148:151] offset:14848
  ds_write_b128 v13, v[152:155] offset:19968
  ds_write_b128 v13, v[156:159] offset:25088
  s_waitcnt lgkmcnt(0)
  s_barrier
  buffer_load_dwordx4 v[136:139], v8, s[4:7], 0 offen offset:512
  buffer_load_dwordx4 v[140:143], v9, s[4:7], 0 offen offset:512
  s_mov_b32 s29, 704512
  buffer_load_dwordx4 v[144:147], v11, s[8:11], s29 offen
  buffer_load_dwordx4 v[148:151], v12, s[8:11], s29 offen
  buffer_load_dwordx4 v[152:155], v11, s[12:15], s29 offen
  buffer_load_dwordx4 v[156:159], v12, s[12:15], s29 offen
  ds_read_b128 v[88:91], v14 offset:512
  ds_read_b64_tr_b16 v[104:105], v15 offset:9728
  ds_read_b64_tr_b16 v[106:107], v15 offset:10368
  ds_read_b64_tr_b16 v[120:121], v15 offset:19968
  ds_read_b64_tr_b16 v[122:123], v15 offset:20608
  ds_read_b128 v[92:95], v14 offset:544
  ds_read_b64_tr_b16 v[108:109], v15 offset:12288
  ds_read_b64_tr_b16 v[110:111], v15 offset:12928
  ds_read_b64_tr_b16 v[124:125], v15 offset:22528
  ds_read_b64_tr_b16 v[126:127], v15 offset:23168
  ds_read_b128 v[96:99], v14 offset:576
  ds_read_b64_tr_b16 v[112:113], v15 offset:14848
  ds_read_b64_tr_b16 v[114:115], v15 offset:15488
  ds_read_b64_tr_b16 v[128:129], v15 offset:25088
  ds_read_b64_tr_b16 v[130:131], v15 offset:25728
  ds_read_b128 v[100:103], v14 offset:608
  ds_read_b64_tr_b16 v[116:117], v15 offset:17408
  ds_read_b64_tr_b16 v[118:119], v15 offset:18048
  ds_read_b64_tr_b16 v[132:133], v15 offset:27648
  ds_read_b64_tr_b16 v[134:135], v15 offset:28288
  s_waitcnt lgkmcnt(15)
  v_mfma_f32_32x32x16_bf16 v[32:47], v[88:91], v[104:107], v[32:47]
  v_mfma_f32_32x32x16_bf16 v[48:63], v[88:91], v[120:123], v[48:63]
  s_waitcnt lgkmcnt(10)
  v_mfma_f32_32x32x16_bf16 v[32:47], v[92:95], v[108:111], v[32:47]
  v_mfma_f32_32x32x16_bf16 v[48:63], v[92:95], v[124:127], v[48:63]
  s_waitcnt lgkmcnt(5)
  v_mfma_f32_32x32x16_bf16 v[32:47], v[96:99], v[112:115], v[32:47]
  v_mfma_f32_32x32x16_bf16 v[48:63], v[96:99], v[128:131], v[48:63]
  s_waitcnt lgkmcnt(0)
  v_mfma_f32_32x32x16_bf16 v[32:47], v[100:103], v[116:119], v[32:47]
  v_mfma_f32_32x32x16_bf16 v[48:63], v[100:103], v[132:135], v[48:63]
  s_waitcnt vmcnt(6)
  v_lshlrev_b32 v28, 16, v160
  v_and_b32 v29, 0xffff0000, v160
  v_fma_f32 v28, v28, v25, v24
  v_fma_f32 v29, v29, v25, v24
  v_cvt_pk_bf16_f32 v160, v28, v29
  v_lshlrev_b32 v28, 16, v161
  v_and_b32 v29, 0xffff0000, v161
  v_fma_f32 v28, v28, v25, v24
  v_fma_f32 v29, v29, v25, v24
  v_cvt_pk_bf16_f32 v161, v28, v29
  v_lshlrev_b32 v28, 16, v162
  v_and_b32 v29, 0xffff0000, v162
  v_fma_f32 v28, v28, v25, v24
  v_fma_f32 v29, v29, v25, v24
  v_cvt_pk_bf16_f32 v162, v28, v29
  v_lshlrev_b32 v28, 16, v163
  v_and_b32 v29, 0xffff0000, v163
  v_fma_f32 v28, v28, v25, v24
  v_fma_f32 v29, v29, v25, v24
  v_cvt_pk_bf16_f32 v163, v28, v29
  v_lshlrev_b32 v28, 16, v164
  v_and_b32 v29, 0xffff0000, v164
  v_fma_f32 v28, v28, v27, v26
  v_fma_f32 v29, v29, v27, v26
  v_cvt_pk_bf16_f32 v164, v28, v29
  v_lshlrev_b32 v28, 16, v165
  v_and_b32 v29, 0xffff0000, v165
  v_fma_f32 v28, v28, v27, v26
  v_fma_f32 v29, v29, v27, v26
  v_cvt_pk_bf16_f32 v165, v28, v29
  v_lshlrev_b32 v28, 16, v166
  v_and_b32 v29, 0xffff0000, v166
  v_fma_f32 v28, v28, v27, v26
  v_fma_f32 v29, v29, v27, v26
  v_cvt_pk_bf16_f32 v166, v28, v29
  v_lshlrev_b32 v28, 16, v167
  v_and_b32 v29, 0xffff0000, v167
  v_fma_f32 v28, v28, v27, v26
  v_fma_f32 v29, v29, v27, v26
  v_cvt_pk_bf16_f32 v167, v28, v29
  ds_write_b128 v10, v[160:163] offset:30208
  ds_write_b128 v10, v[164:167] offset:34816
  ds_write_b128 v13, v[168:171] offset:39424
  ds_write_b128 v13, v[172:175] offset:44544
  ds_write_b128 v13, v[176:179] offset:49664
  ds_write_b128 v13, v[180:183] offset:54784
  s_waitcnt lgkmcnt(0)
  s_barrier
  buffer_load_dwordx4 v[160:163], v8, s[4:7], 0 offen offset:640
  buffer_load_dwordx4 v[164:167], v9, s[4:7], 0 offen offset:640
  s_mov_b32 s29, 880640
  buffer_load_dwordx4 v[168:171], v11, s[8:11], s29 offen
  buffer_load_dwordx4 v[172:175], v12, s[8:11], s29 offen
  buffer_load_dwordx4 v[176:179], v11, s[12:15], s29 offen
  buffer_load_dwordx4 v[180:183], v12, s[12:15], s29 offen
  ds_read_b128 v[88:91], v14 offset:30208
  ds_read_b64_tr_b16 v[104:105], v15 offset:39424
  ds_read_b64_tr_b16 v[106:107], v15 offset:40064
  ds_read_b64_tr_b16 v[120:121], v15 offset:49664
  ds_read_b64_tr_b16 v[122:123], v15 offset:50304
  ds_read_b128 v[92:95], v14 offset:30240
  ds_read_b64_tr_b16 v[108:109], v15 offset:41984
  ds_read_b64_tr_b16 v[110:111], v15 offset:42624
  ds_read_b64_tr_b16 v[124:125], v15 offset:52224
  ds_read_b64_tr_b16 v[126:127], v15 offset:52864
  ds_read_b128 v[96:99], v14 offset:30272
  ds_read_b64_tr_b16 v[112:113], v15 offset:44544
  ds_read_b64_tr_b16 v[114:115], v15 offset:45184
  ds_read_b64_tr_b16 v[128:129], v15 offset:54784
  ds_read_b64_tr_b16 v[130:131], v15 offset:55424
  ds_read_b128 v[100:103], v14 offset:30304
  ds_read_b64_tr_b16 v[116:117], v15 offset:47104
  ds_read_b64_tr_b16 v[118:119], v15 offset:47744
  ds_read_b64_tr_b16 v[132:133], v15 offset:57344
  ds_read_b64_tr_b16 v[134:135], v15 offset:57984
  s_waitcnt lgkmcnt(15)
  v_mfma_f32_32x32x16_bf16 v[32:47], v[88:91], v[104:107], v[32:47]
  v_mfma_f32_32x32x16_bf16 v[48:63], v[88:91], v[120:123], v[48:63]
  s_waitcnt lgkmcnt(10)
  v_mfma_f32_32x32x16_bf16 v[32:47], v[92:95], v[108:111], v[32:47]
  v_mfma_f32_32x32x16_bf16 v[48:63], v[92:95], v[124:127], v[48:63]
  s_waitcnt lgkmcnt(5)
  v_mfma_f32_32x32x16_bf16 v[32:47], v[96:99], v[112:115], v[32:47]
  v_mfma_f32_32x32x16_bf16 v[48:63], v[96:99], v[128:131], v[48:63]
  s_waitcnt lgkmcnt(0)
  v_mfma_f32_32x32x16_bf16 v[32:47], v[100:103], v[116:119], v[32:47]
  v_mfma_f32_32x32x16_bf16 v[48:63], v[100:103], v[132:135], v[48:63]
  s_waitcnt vmcnt(6)
  v_lshlrev_b32 v28, 16, v136
  v_and_b32 v29, 0xffff0000, v136
  v_fma_f32 v28, v28, v25, v24
  v_fma_f32 v29, v29, v25, v24
  v_cvt_pk_bf16_f32 v136, v28, v29
  v_lshlrev_b32 v28, 16, v137
  v_and_b32 v29, 0xffff0000, v137
  v_fma_f32 v28, v28, v25, v24
  v_fma_f32 v29, v29, v25, v24
  v_cvt_pk_bf16_f32 v137, v28, v29
  v_lshlrev_b32 v28, 16, v138
  v_and_b32 v29, 0xffff0000, v138
  v_fma_f32 v28, v28, v25, v24
  v_fma_f32 v29, v29, v25, v24
  v_cvt_pk_bf16_f32 v138, v28, v29
  v_lshlrev_b32 v28, 16, v139
  v_and_b32 v29, 0xffff0000, v139
  v_fma_f32 v28, v28, v25, v24
  v_fma_f32 v29, v29, v25, v24
  v_cvt_pk_bf16_f32 v139, v28, v29
  v_lshlrev_b32 v28, 16, v140
  v_and_b32 v29, 0xffff0000, v140
  v_fma_f32 v28, v28, v27, v26
  v_fma_f32 v29, v29, v27, v26
  v_cvt_pk_bf16_f32 v140, v28, v29
  v_lshlrev_b32 v28, 16, v141
  v_and_b32 v29, 0xffff0000, v141
  v_fma_f32 v28, v28, v27, v26
  v_fma_f32 v29, v29, v27, v26
  v_cvt_pk_bf16_f32 v141, v28, v29
  v_lshlrev_b32 v28, 16, v142
  v_and_b32 v29, 0xffff0000, v142
  v_fma_f32 v28, v28, v27, v26
  v_fma_f32 v29, v29, v27, v26
  v_cvt_pk_bf16_f32 v142, v28, v29
  v_lshlrev_b32 v28, 16, v143
  v_and_b32 v29, 0xffff0000, v143
  v_fma_f32 v28, v28, v27, v26
  v_fma_f32 v29, v29, v27, v26
  v_cvt_pk_bf16_f32 v143, v28, v29
  ds_write_b128 v10, v[136:139] offset:512
  ds_write_b128 v10, v[140:143] offset:5120
  ds_write_b128 v13, v[144:147] offset:9728
  ds_write_b128 v13, v[148:151] offset:14848
  ds_write_b128 v13, v[152:155] offset:19968
  ds_write_b128 v13, v[156:159] offset:25088
  s_waitcnt lgkmcnt(0)
  s_barrier
  buffer_load_dwordx4 v[136:139], v8, s[4:7], 0 offen offset:768
  buffer_load_dwordx4 v[140:143], v9, s[4:7], 0 offen offset:768
  s_mov_b32 s29, 1056768
  buffer_load_dwordx4 v[144:147], v11, s[8:11], s29 offen
  buffer_load_dwordx4 v[148:151], v12, s[8:11], s29 offen
  buffer_load_dwordx4 v[152:155], v11, s[12:15], s29 offen
  buffer_load_dwordx4 v[156:159], v12, s[12:15], s29 offen
  ds_read_b128 v[88:91], v14 offset:512
  ds_read_b64_tr_b16 v[104:105], v15 offset:9728
  ds_read_b64_tr_b16 v[106:107], v15 offset:10368
  ds_read_b64_tr_b16 v[120:121], v15 offset:19968
  ds_read_b64_tr_b16 v[122:123], v15 offset:20608
  ds_read_b128 v[92:95], v14 offset:544
  ds_read_b64_tr_b16 v[108:109], v15 offset:12288
  ds_read_b64_tr_b16 v[110:111], v15 offset:12928
  ds_read_b64_tr_b16 v[124:125], v15 offset:22528
  ds_read_b64_tr_b16 v[126:127], v15 offset:23168
  ds_read_b128 v[96:99], v14 offset:576
  ds_read_b64_tr_b16 v[112:113], v15 offset:14848
  ds_read_b64_tr_b16 v[114:115], v15 offset:15488
  ds_read_b64_tr_b16 v[128:129], v15 offset:25088
  ds_read_b64_tr_b16 v[130:131], v15 offset:25728
  ds_read_b128 v[100:103], v14 offset:608
  ds_read_b64_tr_b16 v[116:117], v15 offset:17408
  ds_read_b64_tr_b16 v[118:119], v15 offset:18048
  ds_read_b64_tr_b16 v[132:133], v15 offset:27648
  ds_read_b64_tr_b16 v[134:135], v15 offset:28288
  s_waitcnt lgkmcnt(15)
  v_mfma_f32_32x32x16_bf16 v[32:47], v[88:91], v[104:107], v[32:47]
  v_mfma_f32_32x32x16_bf16 v[48:63], v[88:91], v[120:123], v[48:63]
  s_waitcnt lgkmcnt(10)
  v_mfma_f32_32x32x16_bf16 v[32:47], v[92:95], v[108:111], v[32:47]
  v_mfma_f32_32x32x16_bf16 v[48:63], v[92:95], v[124:127], v[48:63]
  s_waitcnt lgkmcnt(5)
  v_mfma_f32_32x32x16_bf16 v[32:47], v[96:99], v[112:115], v[32:47]
  v_mfma_f32_32x32x16_bf16 v[48:63], v[96:99], v[128:131], v[48:63]
  s_waitcnt lgkmcnt(0)
  v_mfma_f32_32x32x16_bf16 v[32:47], v[100:103], v[116:119], v[32:47]
  v_mfma_f32_32x32x16_bf16 v[48:63], v[100:103], v[132:135], v[48:63]
  s_waitcnt vmcnt(6)
  v_lshlrev_b32 v28, 16, v160
  v_and_b32 v29, 0xffff0000, v160
  v_fma_f32 v28, v28, v25, v24
  v_fma_f32 v29, v29, v25, v24
  v_cvt_pk_bf16_f32 v160, v28, v29
  v_lshlrev_b32 v28, 16, v161
  v_and_b32 v29, 0xffff0000, v161
  v_fma_f32 v28, v28, v25, v24
  v_fma_f32 v29, v29, v25, v24
  v_cvt_pk_bf16_f32 v161, v28, v29
  v_lshlrev_b32 v28, 16, v162
  v_and_b32 v29, 0xffff0000, v162
  v_fma_f32 v28, v28, v25, v24
  v_fma_f32 v29, v29, v25, v24
  v_cvt_pk_bf16_f32 v162, v28, v29
  v_lshlrev_b32 v28, 16, v163
  v_and_b32 v29, 0xffff0000, v163
  v_fma_f32 v28, v28, v25, v24
  v_fma_f32 v29, v29, v25, v24
  v_cvt_pk_bf16_f32 v163, v28, v29
  v_lshlrev_b32 v28, 16, v164
  v_and_b32 v29, 0xffff0000, v164
  v_fma_f32 v28, v28, v27, v26
  v_fma_f32 v29, v29, v27, v26
  v_cvt_pk_bf16_f32 v164, v28, v29
  v_lshlrev_b32 v28, 16, v165
  v_and_b32 v29, 0xffff0000, v165
  v_fma_f32 v28, v28, v27, v26
  v_fma_f32 v29, v29, v27, v26
  v_cvt_pk_bf16_f32 v165, v28, v29
  v_lshlrev_b32 v28, 16, v166
  v_and_b32 v29, 0xffff0000, v166
  v_fma_f32 v28, v28, v27, v26
  v_fma_f32 v29, v29, v27, v26
  v_cvt_pk_bf16_f32 v166, v28, v29
  v_lshlrev_b32 v28, 16, v167
  v_and_b32 v29, 0xffff0000, v167
  v_fma_f32 v28, v28, v27, v26
  v_fma_f32 v29, v29, v27, v26
  v_cvt_pk_bf16_f32 v167, v28, v29
  ds_write_b128 v10, v[160:163] offset:30208
  ds_write_b128 v10, v[164:167] offset:34816
  ds_write_b128 v13, v[168:171] offset:39424
  ds_write_b128 v13, v[172:175] offset:44544
  ds_write_b128 v13, v[176:179] offset:49664
  ds_write_b128 v13, v[180:183] offset:54784
  s_waitcnt lgkmcnt(0)
  s_barrier
  buffer_load_dwordx4 v[160:163], v8, s[4:7], 0 offen offset:896
  buffer_load_dwordx4 v[164:167], v9, s[4:7], 0 offen offset:896
  s_mov_b32 s29, 1232896
  buffer_load_dwordx4 v[168:171], v11, s[8:11], s29 offen
  buffer_load_dwordx4 v[172:175], v12, s[8:11], s29 offen
  buffer_load_dwordx4 v[176:179], v11, s[12:15], s29 offen
  buffer_load_dwordx4 v[180:183], v12, s[12:15], s29 offen
  ds_read_b128 v[88:91], v14 offset:30208
  ds_read_b64_tr_b16 v[104:105], v15 offset:39424
  ds_read_b64_tr_b16 v[106:107], v15 offset:40064
  ds_read_b64_tr_b16 v[120:121], v15 offset:49664
  ds_read_b64_tr_b16 v[122:123], v15 offset:50304
  ds_read_b128 v[92:95], v14 offset:30240
  ds_read_b64_tr_b16 v[108:109], v15 offset:41984
  ds_read_b64_tr_b16 v[110:111], v15 offset:42624
  ds_read_b64_tr_b16 v[124:125], v15 offset:52224
  ds_read_b64_tr_b16 v[126:127], v15 offset:52864
  ds_read_b128 v[96:99], v14 offset:30272
  ds_read_b64_tr_b16 v[112:113], v15 offset:44544
  ds_read_b64_tr_b16 v[114:115], v15 offset:45184
  ds_read_b64_tr_b16 v[128:129], v15 offset:54784
  ds_read_b64_tr_b16 v[130:131], v15 offset:55424
  ds_read_b128 v[100:103], v14 offset:30304
  ds_read_b64_tr_b16 v[116:117], v15 offset:47104
  ds_read_b64_tr_b16 v[118:119], v15 offset:47744
  ds_read_b64_tr_b16 v[132:133], v15 offset:57344
  ds_read_b64_tr_b16 v[134:135], v15 offset:57984
  s_waitcnt lgkmcnt(15)
  v_mfma_f32_32x32x16_bf16 v[32:47], v[88:91], v[104:107], v[32:47]
  v_mfma_f32_32x32x16_bf16 v[48:63], v[88:91], v[120:123], v[48:63]
  s_waitcnt lgkmcnt(10)
  v_mfma_f32_32x32x16_bf16 v[32:47], v[92:95], v[108:111], v[32:47]
  v_mfma_f32_32x32x16_bf16 v[48:63], v[92:95], v[124:127], v[48:63]
  s_waitcnt lgkmcnt(5)
  v_mfma_f32_32x32x16_bf16 v[32:47], v[96:99], v[112:115], v[32:47]
  v_mfma_f32_32x32x16_bf16 v[48:63], v[96:99], v[128:131], v[48:63]
  s_waitcnt lgkmcnt(0)
  v_mfma_f32_32x32x16_bf16 v[32:47], v[100:103], v[116:119], v[32:47]
  v_mfma_f32_32x32x16_bf16 v[48:63], v[100:103], v[132:135], v[48:63]
  s_waitcnt vmcnt(6)
  v_lshlrev_b32 v28, 16, v136
  v_and_b32 v29, 0xffff0000, v136
  v_fma_f32 v28, v28, v25, v24
  v_fma_f32 v29, v29, v25, v24
  v_cvt_pk_bf16_f32 v136, v28, v29
  v_lshlrev_b32 v28, 16, v137
  v_and_b32 v29, 0xffff0000, v137
  v_fma_f32 v28, v28, v25, v24
  v_fma_f32 v29, v29, v25, v24
  v_cvt_pk_bf16_f32 v137, v28, v29
  v_lshlrev_b32 v28, 16, v138
  v_and_b32 v29, 0xffff0000, v138
  v_fma_f32 v28, v28, v25, v24
  v_fma_f32 v29, v29, v25, v24
  v_cvt_pk_bf16_f32 v138, v28, v29
  v_lshlrev_b32 v28, 16, v139
  v_and_b32 v29, 0xffff0000, v139
  v_fma_f32 v28, v28, v25, v24
  v_fma_f32 v29, v29, v25, v24
  v_cvt_pk_bf16_f32 v139, v28, v29
  v_lshlrev_b32 v28, 16, v140
  v_and_b32 v29, 0xffff0000, v140
  v_fma_f32 v28, v28, v27, v26
  v_fma_f32 v29, v29, v27, v26
  v_cvt_pk_bf16_f32 v140, v28, v29
  v_lshlrev_b32 v28, 16, v141
  v_and_b32 v29, 0xffff0000, v141
  v_fma_f32 v28, v28, v27, v26
  v_fma_f32 v29, v29, v27, v26
  v_cvt_pk_bf16_f32 v141, v28, v29
  v_lshlrev_b32 v28, 16, v142
  v_and_b32 v29, 0xffff0000, v142
  v_fma_f32 v28, v28, v27, v26
  v_fma_f32 v29, v29, v27, v26
  v_cvt_pk_bf16_f32 v142, v28, v29
  v_lshlrev_b32 v28, 16, v143
  v_and_b32 v29, 0xffff0000, v143
  v_fma_f32 v28, v28, v27, v26
  v_fma_f32 v29, v29, v27, v26
  v_cvt_pk_bf16_f32 v143, v28, v29
  ds_write_b128 v10, v[136:139] offset:512
  ds_write_b128 v10, v[140:143] offset:5120
  ds_write_b128 v13, v[144:147] offset:9728
  ds_write_b128 v13, v[148:151] offset:14848
  ds_write_b128 v13, v[152:155] offset:19968
  ds_write_b128 v13, v[156:159] offset:25088
  s_waitcnt lgkmcnt(0)
  s_barrier
  ds_read_b128 v[88:91], v14 offset:512
  ds_read_b64_tr_b16 v[104:105], v15 offset:9728
  ds_read_b64_tr_b16 v[106:107], v15 offset:10368
  ds_read_b64_tr_b16 v[120:121], v15 offset:19968
  ds_read_b64_tr_b16 v[122:123], v15 offset:20608
  ds_read_b128 v[92:95], v14 offset:544
  ds_read_b64_tr_b16 v[108:109], v15 offset:12288
  ds_read_b64_tr_b16 v[110:111], v15 offset:12928
  ds_read_b64_tr_b16 v[124:125], v15 offset:22528
  ds_read_b64_tr_b16 v[126:127], v15 offset:23168
  ds_read_b128 v[96:99], v14 offset:576
  ds_read_b64_tr_b16 v[112:113], v15 offset:14848
  ds_read_b64_tr_b16 v[114:115], v15 offset:15488
  ds_read_b64_tr_b16 v[128:129], v15 offset:25088
  ds_read_b64_tr_b16 v[130:131], v15 offset:25728
  ds_read_b128 v[100:103], v14 offset:608
  ds_read_b64_tr_b16 v[116:117], v15 offset:17408
  ds_read_b64_tr_b16 v[118:119], v15 offset:18048
  ds_read_b64_tr_b16 v[132:133], v15 offset:27648
  ds_read_b64_tr_b16 v[134:135], v15 offset:28288
  s_waitcnt lgkmcnt(15)
  v_mfma_f32_32x32x16_bf16 v[32:47], v[88:91], v[104:107], v[32:47]
  v_mfma_f32_32x32x16_bf16 v[48:63], v[88:91], v[120:123], v[48:63]
  s_waitcnt lgkmcnt(10)
  v_mfma_f32_32x32x16_bf16 v[32:47], v[92:95], v[108:111], v[32:47]
  v_mfma_f32_32x32x16_bf16 v[48:63], v[92:95], v[124:127], v[48:63]
  s_waitcnt lgkmcnt(5)
  v_mfma_f32_32x32x16_bf16 v[32:47], v[96:99], v[112:115], v[32:47]
  v_mfma_f32_32x32x16_bf16 v[48:63], v[96:99], v[128:131], v[48:63]
  s_waitcnt lgkmcnt(0)
  v_mfma_f32_32x32x16_bf16 v[32:47], v[100:103], v[116:119], v[32:47]
  v_mfma_f32_32x32x16_bf16 v[48:63], v[100:103], v[132:135], v[48:63]
  s_waitcnt vmcnt(0)
  v_lshlrev_b32 v28, 16, v160
  v_and_b32 v29, 0xffff0000, v160
  v_fma_f32 v28, v28, v25, v24
  v_fma_f32 v29, v29, v25, v24
  v_cvt_pk_bf16_f32 v160, v28, v29
  v_lshlrev_b32 v28, 16, v161
  v_and_b32 v29, 0xffff0000, v161
  v_fma_f32 v28, v28, v25, v24
  v_fma_f32 v29, v29, v25, v24
  v_cvt_pk_bf16_f32 v161, v28, v29
  v_lshlrev_b32 v28, 16, v162
  v_and_b32 v29, 0xffff0000, v162
  v_fma_f32 v28, v28, v25, v24
  v_fma_f32 v29, v29, v25, v24
  v_cvt_pk_bf16_f32 v162, v28, v29
  v_lshlrev_b32 v28, 16, v163
  v_and_b32 v29, 0xffff0000, v163
  v_fma_f32 v28, v28, v25, v24
  v_fma_f32 v29, v29, v25, v24
  v_cvt_pk_bf16_f32 v163, v28, v29
  v_lshlrev_b32 v28, 16, v164
  v_and_b32 v29, 0xffff0000, v164
  v_fma_f32 v28, v28, v27, v26
  v_fma_f32 v29, v29, v27, v26
  v_cvt_pk_bf16_f32 v164, v28, v29
  v_lshlrev_b32 v28, 16, v165
  v_and_b32 v29, 0xffff0000, v165
  v_fma_f32 v28, v28, v27, v26
  v_fma_f32 v29, v29, v27, v26
  v_cvt_pk_bf16_f32 v165, v28, v29
  v_lshlrev_b32 v28, 16, v166
  v_and_b32 v29, 0xffff0000, v166
  v_fma_f32 v28, v28, v27, v26
  v_fma_f32 v29, v29, v27, v26
  v_cvt_pk_bf16_f32 v166, v28, v29
  v_lshlrev_b32 v28, 16, v167
  v_and_b32 v29, 0xffff0000, v167
  v_fma_f32 v28, v28, v27, v26
  v_fma_f32 v29, v29, v27, v26
  v_cvt_pk_bf16_f32 v167, v28, v29
  ds_write_b128 v10, v[160:163] offset:30208
  ds_write_b128 v10, v[164:167] offset:34816
  ds_write_b128 v13, v[168:171] offset:39424
  ds_write_b128 v13, v[172:175] offset:44544
  ds_write_b128 v13, v[176:179] offset:49664
  ds_write_b128 v13, v[180:183] offset:54784
  s_waitcnt lgkmcnt(0)
  s_barrier
  ds_read_b128 v[88:91], v14 offset:30208
  ds_read_b64_tr_b16 v[104:105], v15 offset:39424
  ds_read_b64_tr_b16 v[106:107], v15 offset:40064
  ds_read_b64_tr_b16 v[120:121], v15 offset:49664
  ds_read_b64_tr_b16 v[122:123], v15 offset:50304
  ds_read_b128 v[92:95], v14 offset:30240
  ds_read_b64_tr_b16 v[108:109], v15 offset:41984
  ds_read_b64_tr_b16 v[110:111], v15 offset:42624
  ds_read_b64_tr_b16 v[124:125], v15 offset:52224
  ds_read_b64_tr_b16 v[126:127], v15 offset:52864
  ds_read_b128 v[96:99], v14 offset:30272
  ds_read_b64_tr_b16 v[112:113], v15 offset:44544
  ds_read_b64_tr_b16 v[114:115], v15 offset:45184
  ds_read_b64_tr_b16 v[128:129], v15 offset:54784
  ds_read_b64_tr_b16 v[130:131], v15 offset:55424
  ds_read_b128 v[100:103], v14 offset:30304
  ds_read_b64_tr_b16 v[116:117], v15 offset:47104
  ds_read_b64_tr_b16 v[118:119], v15 offset:47744
  ds_read_b64_tr_b16 v[132:133], v15 offset:57344
  ds_read_b64_tr_b16 v[134:135], v15 offset:57984
  s_waitcnt lgkmcnt(15)
  v_mfma_f32_32x32x16_bf16 v[32:47], v[88:91], v[104:107], v[32:47]
  v_mfma_f32_32x32x16_bf16 v[48:63], v[88:91], v[120:123], v[48:63]
  s_waitcnt lgkmcnt(10)
  v_mfma_f32_32x32x16_bf16 v[32:47], v[92:95], v[108:111], v[32:47]
  v_mfma_f32_32x32x16_bf16 v[48:63], v[92:95], v[124:127], v[48:63]
  s_waitcnt lgkmcnt(5)
  v_mfma_f32_32x32x16_bf16 v[32:47], v[96:99], v[112:115], v[32:47]
  v_mfma_f32_32x32x16_bf16 v[48:63], v[96:99], v[128:131], v[48:63]
  s_waitcnt lgkmcnt(0)
  v_mfma_f32_32x32x16_bf16 v[32:47], v[100:103], v[116:119], v[32:47]
  v_mfma_f32_32x32x16_bf16 v[48:63], v[100:103], v[132:135], v[48:63]
  s_nop 15
  v_lshrrev_b32 v5, 1, v2
  v_and_b32 v6, 1, v2
  v_lshlrev_b32 v7, 5, v5
  v_lshl_add_u32 v7, v3, 2, v7
  v_add_u32 v7, s24, v7
  s_mov_b32 s28, 2752
  v_mul_lo_u32 v8, v7, s28
  v_lshl_add_u32 v9, v6, 5, v4
  v_add_u32 v9, s25, v9
  v_lshl_add_u32 v8, v9, 1, v8
  v_mov_b32 v10, 0xfffffff0
  v_cmp_gt_u32 vcc, 1376, v9
  s_nop 1
  v_cndmask_b32 v8, v10, v8, vcc
  s_mov_b32 s28, 3216550459
  v_mul_f32 v64, s28, v32
  v_exp_f32 v64, v64
  s_nop 0
  v_add_f32 v64, 1.0, v64
  v_rcp_f32 v64, v64
  s_nop 0
  v_mul_f32 v32, v32, v64
  v_mul_f32 v32, v32, v48
  v_mul_f32 v65, s28, v33
  v_exp_f32 v65, v65
  s_nop 0
  v_add_f32 v65, 1.0, v65
  v_rcp_f32 v65, v65
  s_nop 0
  v_mul_f32 v33, v33, v65
  v_mul_f32 v33, v33, v49
  v_mul_f32 v66, s28, v34
  v_exp_f32 v66, v66
  s_nop 0
  v_add_f32 v66, 1.0, v66
  v_rcp_f32 v66, v66
  s_nop 0
  v_mul_f32 v34, v34, v66
  v_mul_f32 v34, v34, v50
  v_mul_f32 v67, s28, v35
  v_exp_f32 v67, v67
  s_nop 0
  v_add_f32 v67, 1.0, v67
  v_rcp_f32 v67, v67
  s_nop 0
  v_mul_f32 v35, v35, v67
  v_mul_f32 v35, v35, v51
  v_mul_f32 v68, s28, v36
  v_exp_f32 v68, v68
  s_nop 0
  v_add_f32 v68, 1.0, v68
  v_rcp_f32 v68, v68
  s_nop 0
  v_mul_f32 v36, v36, v68
  v_mul_f32 v36, v36, v52
  v_mul_f32 v69, s28, v37
  v_exp_f32 v69, v69
  s_nop 0
  v_add_f32 v69, 1.0, v69
  v_rcp_f32 v69, v69
  s_nop 0
  v_mul_f32 v37, v37, v69
  v_mul_f32 v37, v37, v53
  v_mul_f32 v70, s28, v38
  v_exp_f32 v70, v70
  s_nop 0
  v_add_f32 v70, 1.0, v70
  v_rcp_f32 v70, v70
  s_nop 0
  v_mul_f32 v38, v38, v70
  v_mul_f32 v38, v38, v54
  v_mul_f32 v71, s28, v39
  v_exp_f32 v71, v71
  s_nop 0
  v_add_f32 v71, 1.0, v71
  v_rcp_f32 v71, v71
  s_nop 0
  v_mul_f32 v39, v39, v71
  v_mul_f32 v39, v39, v55
  v_mul_f32 v72, s28, v40
  v_exp_f32 v72, v72
  s_nop 0
  v_add_f32 v72, 1.0, v72
  v_rcp_f32 v72, v72
  s_nop 0
  v_mul_f32 v40, v40, v72
  v_mul_f32 v40, v40, v56
  v_mul_f32 v73, s28, v41
  v_exp_f32 v73, v73
  s_nop 0
  v_add_f32 v73, 1.0, v73
  v_rcp_f32 v73, v73
  s_nop 0
  v_mul_f32 v41, v41, v73
  v_mul_f32 v41, v41, v57
  v_mul_f32 v74, s28, v42
  v_exp_f32 v74, v74
  s_nop 0
  v_add_f32 v74, 1.0, v74
  v_rcp_f32 v74, v74
  s_nop 0
  v_mul_f32 v42, v42, v74
  v_mul_f32 v42, v42, v58
  v_mul_f32 v75, s28, v43
  v_exp_f32 v75, v75
  s_nop 0
  v_add_f32 v75, 1.0, v75
  v_rcp_f32 v75, v75
  s_nop 0
  v_mul_f32 v43, v43, v75
  v_mul_f32 v43, v43, v59
  v_mul_f32 v76, s28, v44
  v_exp_f32 v76, v76
  s_nop 0
  v_add_f32 v76, 1.0, v76
  v_rcp_f32 v76, v76
  s_nop 0
  v_mul_f32 v44, v44, v76
  v_mul_f32 v44, v44, v60
  v_mul_f32 v77, s28, v45
  v_exp_f32 v77, v77
  s_nop 0
  v_add_f32 v77, 1.0, v77
  v_rcp_f32 v77, v77
  s_nop 0
  v_mul_f32 v45, v45, v77
  v_mul_f32 v45, v45, v61
  v_mul_f32 v78, s28, v46
  v_exp_f32 v78, v78
  s_nop 0
  v_add_f32 v78, 1.0, v78
  v_rcp_f32 v78, v78
  s_nop 0
  v_mul_f32 v46, v46, v78
  v_mul_f32 v46, v46, v62
  v_mul_f32 v79, s28, v47
  v_exp_f32 v79, v79
  s_nop 0
  v_add_f32 v79, 1.0, v79
  v_rcp_f32 v79, v79
  s_nop 0
  v_mul_f32 v47, v47, v79
  v_mul_f32 v47, v47, v63
  v_cvt_pk_bf16_f32 v32, v32, v32
  s_mov_b32 s29, 0
  buffer_store_short v32, v8, s[16:19], s29 offen
  v_cvt_pk_bf16_f32 v33, v33, v33
  s_mov_b32 s29, 2752
  buffer_store_short v33, v8, s[16:19], s29 offen
  v_cvt_pk_bf16_f32 v34, v34, v34
  s_mov_b32 s29, 5504
  buffer_store_short v34, v8, s[16:19], s29 offen
  v_cvt_pk_bf16_f32 v35, v35, v35
  s_mov_b32 s29, 8256
  buffer_store_short v35, v8, s[16:19], s29 offen
  v_cvt_pk_bf16_f32 v36, v36, v36
  s_mov_b32 s29, 22016
  buffer_store_short v36, v8, s[16:19], s29 offen
  v_cvt_pk_bf16_f32 v37, v37, v37
  s_mov_b32 s29, 24768
  buffer_store_short v37, v8, s[16:19], s29 offen
  v_cvt_pk_bf16_f32 v38, v38, v38
  s_mov_b32 s29, 27520
  buffer_store_short v38, v8, s[16:19], s29 offen
  v_cvt_pk_bf16_f32 v39, v39, v39
  s_mov_b32 s29, 30272
  buffer_store_short v39, v8, s[16:19], s29 offen
  v_cvt_pk_bf16_f32 v40, v40, v40
  s_mov_b32 s29, 44032
  buffer_store_short v40, v8, s[16:19], s29 offen
  v_cvt_pk_bf16_f32 v41, v41, v41
  s_mov_b32 s29, 46784
  buffer_store_short v41, v8, s[16:19], s29 offen
  v_cvt_pk_bf16_f32 v42, v42, v42
  s_mov_b32 s29, 49536
  buffer_store_short v42, v8, s[16:19], s29 offen
  v_cvt_pk_bf16_f32 v43, v43, v43
  s_mov_b32 s29, 52288
  buffer_store_short v43, v8, s[16:19], s29 offen
  v_cvt_pk_bf16_f32 v44, v44, v44
  s_mov_b32 s29, 66048
  buffer_store_short v44, v8, s[16:19], s29 offen
  v_cvt_pk_bf16_f32 v45, v45, v45
  s_mov_b32 s29, 68800
  buffer_store_short v45, v8, s[16:19], s29 offen
  v_cvt_pk_bf16_f32 v46, v46, v46
  s_mov_b32 s29, 71552
  buffer_store_short v46, v8, s[16:19], s29 offen
  v_cvt_pk_bf16_f32 v47, v47, v47
  s_mov_b32 s29, 74304
  buffer_store_short v47, v8, s[16:19], s29 offen
L_glu_kernel_end:
  s_endpgm
.p2align 8
.globl down_kernel
.type down_kernel,@function
down_kernel:
  s_cmp_ge_u32 s2, 256
  s_cbranch_scc1 L_down_kernel_end
  s_and_b32 s24, s2, 31
  s_lshl_b32 s24, s24, 6
  s_lshr_b32 s25, s2, 5
  s_lshl_b32 s25, s25, 6
  s_load_dwordx2 s[4:5], s[0:1], 88
  s_load_dwordx2 s[8:9], s[0:1], 64
  s_load_dwordx2 s[16:17], s[0:1], 72
  s_load_dwordx2 s[20:21], s[0:1], 88
  s_waitcnt lgkmcnt(0)
  s_add_u32 s4, s4, 7340032
  s_addc_u32 s5, s5, 0
  s_mov_b32 s6, 5636096
  s_mov_b32 s7, 0x00020000
  s_mov_b32 s10, 1409024
  s_mov_b32 s11, 0x00020000
  s_mov_b32 s18, 2097152
  s_mov_b32 s19, 0x00020000
  s_add_u32 s20, s20, 5242880
  s_addc_u32 s21, s21, 0
  s_mov_b32 s22, 2097152
  s_mov_b32 s23, 0x00020000
  s_mov_b32 s26, 2752
  s_mov_b32 s27, 1024
  v_and_b32 v1, 63, v0
  v_lshrrev_b32 v2, 6, v0
  v_lshrrev_b32 v3, 5, v1
  v_and_b32 v4, 31, v1
  v_lshrrev_b32 v5, 2, v0
  v_and_b32 v6, 3, v0
  v_add_u32 v7, s24, v5
  v_mul_lo_u32 v7, v7, s26
  v_lshl_add_u32 v8, v6, 4, v7
  v_mul_u32_u24 v10, 80, v5
  v_lshl_add_u32 v10, v6, 4, v10
  v_lshrrev_b32 v5, 3, v0
  v_and_b32 v6, 7, v0
  v_mul_lo_u32 v7, v5, s27
  v_lshl_add_u32 v7, v6, 4, v7
  s_lshl_b32 s28, s25, 1
  v_add_u32 v11, s28, v7
  v_add_u32 v12, 32768, v11
  v_mul_u32_u24 v13, 160, v5
  v_lshl_add_u32 v13, v6, 4, v13
  v_lshrrev_b32 v5, 1, v2
  v_and_b32 v6, 1, v2
  v_lshl_add_u32 v7, v5, 5, v4
  v_mul_u32_u24 v14, 80, v7
  v_lshl_add_u32 v14, v3, 4, v14
  v_and_b32 v7, 15, v1
  v_lshrrev_b32 v7, 2, v7
  v_lshl_add_u32 v7, v3, 3, v7
  v_mul_u32_u24 v15, 160, v7
  v_lshl_add_u32 v15, v6, 6, v15
  v_lshrrev_b32 v7, 4, v1
  v_and_b32 v7, 1, v7
  v_lshl_add_u32 v15, v7, 5, v15
  v_and_b32 v7, 3, v1
  v_lshl_add_u32 v15, v7, 3, v15
  buffer_load_dwordx4 v[136:139], v8, s[4:7], 0 offen offset:0
  s_mov_b32 s29, 0
  buffer_load_dwordx4 v[140:143], v11, s[8:11], s29 offen
  buffer_load_dwordx4 v[144:147], v8, s[4:7], 0 offen offset:64
  s_mov_b32 s29, 32768
  buffer_load_dwordx4 v[148:151], v11, s[8:11], s29 offen
  buffer_load_dwordx4 v[152:155], v8, s[4:7], 0 offen offset:128
  s_mov_b32 s29, 65536
  buffer_load_dwordx4 v[156:159], v11, s[8:11], s29 offen
  buffer_load_dwordx4 v[160:163], v8, s[4:7], 0 offen offset:192
  s_mov_b32 s29, 98304
  buffer_load_dwordx4 v[164:167], v11, s[8:11], s29 offen
  buffer_load_dwordx4 v[168:171], v8, s[4:7], 0 offen offset:256
  s_mov_b32 s29, 131072
  buffer_load_dwordx4 v[172:175], v11, s[8:11], s29 offen
  buffer_load_dwordx4 v[176:179], v8, s[4:7], 0 offen offset:320
  s_mov_b32 s29, 163840
  buffer_load_dwordx4 v[180:183], v11, s[8:11], s29 offen
  s_waitcnt vmcnt(10)
  ds_write_b128 v10, v[136:139] offset:512
  ds_write_b128 v13, v[140:143] offset:5632
  s_waitcnt lgkmcnt(0)
  s_barrier
  buffer_load_dwordx4 v[136:139], v8, s[4:7], 0 offen offset:384
  s_mov_b32 s29, 196608
  buffer_load_dwordx4 v[140:143], v11, s[8:11], s29 offen
  ds_read_b128 v[88:91], v14 offset:512
  ds_read_b64_tr_b16 v[104:105], v15 offset:5632
  ds_read_b64_tr_b16 v[106:107], v15 offset:6272
  ds_read_b128 v[92:95], v14 offset:544
  ds_read_b64_tr_b16 v[108:109], v15 offset:8192
  ds_read_b64_tr_b16 v[110:111], v15 offset:8832
  s_waitcnt lgkmcnt(3)
  v_mfma_f32_32x32x16_bf16 v[32:47], v[88:91], v[104:107], 0
  s_waitcnt lgkmcnt(0)
  v_mfma_f32_32x32x16_bf16 v[32:47], v[92:95], v[108:111], v[32:47]
  s_waitcnt vmcnt(10)
  ds_write_b128 v10, v[144:147] offset:10752
  ds_write_b128 v13, v[148:151] offset:15872
  s_waitcnt lgkmcnt(0)
  s_barrier
  buffer_load_dwordx4 v[144:147], v8, s[4:7], 0 offen offset:448
  s_mov_b32 s29, 229376
  buffer_load_dwordx4 v[148:151], v11, s[8:11], s29 offen
  ds_read_b128 v[88:91], v14 offset:10752
  ds_read_b64_tr_b16 v[104:105], v15 offset:15872
  ds_read_b64_tr_b16 v[106:107], v15 offset:16512
  ds_read_b128 v[92:95], v14 offset:10784
  ds_read_b64_tr_b16 v[108:109], v15 offset:18432
  ds_read_b64_tr_b16 v[110:111], v15 offset:19072
  s_waitcnt lgkmcnt(3)
  v_mfma_f32_32x32x16_bf16 v[32:47], v[88:91], v[104:107], v[32:47]
  s_waitcnt lgkmcnt(0)
  v_mfma_f32_32x32x16_bf16 v[32:47], v[92:95], v[108:111], v[32:47]
  s_waitcnt vmcnt(10)
  ds_write_b128 v10, v[152:155] offset:512
  ds_write_b128 v13, v[156:159] offset:5632
  s_waitcnt lgkmcnt(0)
  s_barrier
  buffer_load_dwordx4 v[152:155], v8, s[4:7], 0 offen offset:512
  s_mov_b32 s29, 262144
  buffer_load_dwordx4 v[156:159], v11, s[8:11], s29 offen
  ds_read_b128 v[88:91], v14 offset:512
  ds_read_b64_tr_b16 v[104:105], v15 offset:5632
  ds_read_b64_tr_b16 v[106:107], v15 offset:6272
  ds_read_b128 v[92:95], v14 offset:544
  ds_read_b64_tr_b16 v[108:109], v15 offset:8192
  ds_read_b64_tr_b16 v[110:111], v15 offset:8832
  s_waitcnt lgkmcnt(3)
  v_mfma_f32_32x32x16_bf16 v[32:47], v[88:91], v[104:107], v[32:47]
  s_waitcnt lgkmcnt(0)
  v_mfma_f32_32x32x16_bf16 v[32:47], v[92:95], v[108:111], v[32:47]
  s_waitcnt vmcnt(10)
  ds_write_b128 v10, v[160:163] offset:10752
  ds_write_b128 v13, v[164:167] offset:15872
  s_waitcnt lgkmcnt(0)
  s_barrier
  buffer_load_dwordx4 v[160:163], v8, s[4:7], 0 offen offset:576
  s_mov_b32 s29, 294912
  buffer_load_dwordx4 v[164:167], v11, s[8:11], s29 offen
  ds_read_b128 v[88:91], v14 offset:10752
  ds_read_b64_tr_b16 v[104:105], v15 offset:15872
  ds_read_b64_tr_b16 v[106:107], v15 offset:16512
  ds_read_b128 v[92:95], v14 offset:10784
  ds_read_b64_tr_b16 v[108:109], v15 offset:18432
  ds_read_b64_tr_b16 v[110:111], v15 offset:19072
  s_waitcnt lgkmcnt(3)
  v_mfma_f32_32x32x16_bf16 v[32:47], v[88:91], v[104:107], v[32:47]
  s_waitcnt lgkmcnt(0)
  v_mfma_f32_32x32x16_bf16 v[32:47], v[92:95], v[108:111], v[32:47]
  s_waitcnt vmcnt(10)
  ds_write_b128 v10, v[168:171] offset:512
  ds_write_b128 v13, v[172:175] offset:5632
  s_waitcnt lgkmcnt(0)
  s_barrier
  buffer_load_dwordx4 v[168:171], v8, s[4:7], 0 offen offset:640
  s_mov_b32 s29, 327680
  buffer_load_dwordx4 v[172:175], v11, s[8:11], s29 offen
  ds_read_b128 v[88:91], v14 offset:512
  ds_read_b64_tr_b16 v[104:105], v15 offset:5632
  ds_read_b64_tr_b16 v[106:107], v15 offset:6272
  ds_read_b128 v[92:95], v14 offset:544
  ds_read_b64_tr_b16 v[108:109], v15 offset:8192
  ds_read_b64_tr_b16 v[110:111], v15 offset:8832
  s_waitcnt lgkmcnt(3)
  v_mfma_f32_32x32x16_bf16 v[32:47], v[88:91], v[104:107], v[32:47]
  s_waitcnt lgkmcnt(0)
  v_mfma_f32_32x32x16_bf16 v[32:47], v[92:95], v[108:111], v[32:47]
  s_waitcnt vmcnt(10)
  ds_write_b128 v10, v[176:179] offset:10752
  ds_write_b128 v13, v[180:183] offset:15872
  s_waitcnt lgkmcnt(0)
  s_barrier
  buffer_load_dwordx4 v[176:179], v8, s[4:7], 0 offen offset:704
  s_mov_b32 s29, 360448
  buffer_load_dwordx4 v[180:183], v11, s[8:11], s29 offen
  ds_read_b128 v[88:91], v14 offset:10752
  ds_read_b64_tr_b16 v[104:105], v15 offset:15872
  ds_read_b64_tr_b16 v[106:107], v15 offset:16512
  ds_read_b128 v[92:95], v14 offset:10784
  ds_read_b64_tr_b16 v[108:109], v15 offset:18432
  ds_read_b64_tr_b16 v[110:111], v15 offset:19072
  s_waitcnt lgkmcnt(3)
  v_mfma_f32_32x32x16_bf16 v[32:47], v[88:91], v[104:107], v[32:47]
  s_waitcnt lgkmcnt(0)
  v_mfma_f32_32x32x16_bf16 v[32:47], v[92:95], v[108:111], v[32:47]
  s_waitcnt vmcnt(10)
  ds_write_b128 v10, v[136:139] offset:512
  ds_write_b128 v13, v[140:143] offset:5632
  s_waitcnt lgkmcnt(0)
  s_barrier
  buffer_load_dwordx4 v[136:139], v8, s[4:7], 0 offen offset:768
  s_mov_b32 s29, 393216
  buffer_load_dwordx4 v[140:143], v11, s[8:11], s29 offen
  ds_read_b128 v[88:91], v14 offset:512
  ds_read_b64_tr_b16 v[104:105], v15 offset:5632
  ds_read_b64_tr_b16 v[106:107], v15 offset:6272
  ds_read_b128 v[92:95], v14 offset:544
  ds_read_b64_tr_b16 v[108:109], v15 offset:8192
  ds_read_b64_tr_b16 v[110:111], v15 offset:8832
  s_waitcnt lgkmcnt(3)
  v_mfma_f32_32x32x16_bf16 v[32:47], v[88:91], v[104:107], v[32:47]
  s_waitcnt lgkmcnt(0)
  v_mfma_f32_32x32x16_bf16 v[32:47], v[92:95], v[108:111], v[32:47]
  s_waitcnt vmcnt(10)
  ds_write_b128 v10, v[144:147] offset:10752
  ds_write_b128 v13, v[148:151] offset:15872
  s_waitcnt lgkmcnt(0)
  s_barrier
  buffer_load_dwordx4 v[144:147], v8, s[4:7], 0 offen offset:832
  s_mov_b32 s29, 425984
  buffer_load_dwordx4 v[148:151], v11, s[8:11], s29 offen
  ds_read_b128 v[88:91], v14 offset:10752
  ds_read_b64_tr_b16 v[104:105], v15 offset:15872
  ds_read_b64_tr_b16 v[106:107], v15 offset:16512
  ds_read_b128 v[92:95], v14 offset:10784
  ds_read_b64_tr_b16 v[108:109], v15 offset:18432
  ds_read_b64_tr_b16 v[110:111], v15 offset:19072
  s_waitcnt lgkmcnt(3)
  v_mfma_f32_32x32x16_bf16 v[32:47], v[88:91], v[104:107], v[32:47]
  s_waitcnt lgkmcnt(0)
  v_mfma_f32_32x32x16_bf16 v[32:47], v[92:95], v[108:111], v[32:47]
  s_waitcnt vmcnt(10)
  ds_write_b128 v10, v[152:155] offset:512
  ds_write_b128 v13, v[156:159] offset:5632
  s_waitcnt lgkmcnt(0)
  s_barrier
  buffer_load_dwordx4 v[152:155], v8, s[4:7], 0 offen offset:896
  s_mov_b32 s29, 458752
  buffer_load_dwordx4 v[156:159], v11, s[8:11], s29 offen
  ds_read_b128 v[88:91], v14 offset:512
  ds_read_b64_tr_b16 v[104:105], v15 offset:5632
  ds_read_b64_tr_b16 v[106:107], v15 offset:6272
  ds_read_b128 v[92:95], v14 offset:544
  ds_read_b64_tr_b16 v[108:109], v15 offset:8192
  ds_read_b64_tr_b16 v[110:111], v15 offset:8832
  s_waitcnt lgkmcnt(3)
  v_mfma_f32_32x32x16_bf16 v[32:47], v[88:91], v[104:107], v[32:47]
  s_waitcnt lgkmcnt(0)
  v_mfma_f32_32x32x16_bf16 v[32:47], v[92:95], v[108:111], v[32:47]
  s_waitcnt vmcnt(10)
  ds_write_b128 v10, v[160:163] offset:10752
  ds_write_b128 v13, v[164:167] offset:15872
  s_waitcnt lgkmcnt(0)
  s_barrier
  buffer_load_dwordx4 v[160:163], v8, s[4:7], 0 offen offset:960
  s_mov_b32 s29, 491520
  buffer_load_dwordx4 v[164:167], v11, s[8:11], s29 offen
  ds_read_b128 v[88:91], v14 offset:10752
  ds_read_b64_tr_b16 v[104:105], v15 offset:15872
  ds_read_b64_tr_b16 v[106:107], v15 offset:16512
  ds_read_b128 v[92:95], v14 offset:10784
  ds_read_b64_tr_b16 v[108:109], v15 offset:18432
  ds_read_b64_tr_b16 v[110:111], v15 offset:19072
  s_waitcnt lgkmcnt(3)
  v_mfma_f32_32x32x16_bf16 v[32:47], v[88:91], v[104:107], v[32:47]
  s_waitcnt lgkmcnt(0)
  v_mfma_f32_32x32x16_bf16 v[32:47], v[92:95], v[108:111], v[32:47]
  s_waitcnt vmcnt(10)
  ds_write_b128 v10, v[168:171] offset:512
  ds_write_b128 v13, v[172:175] offset:5632
  s_waitcnt lgkmcnt(0)
  s_barrier
  buffer_load_dwordx4 v[168:171], v8, s[4:7], 0 offen offset:1024
  s_mov_b32 s29, 524288
  buffer_load_dwordx4 v[172:175], v11, s[8:11], s29 offen
  ds_read_b128 v[88:91], v14 offset:512
  ds_read_b64_tr_b16 v[104:105], v15 offset:5632
  ds_read_b64_tr_b16 v[106:107], v15 offset:6272
  ds_read_b128 v[92:95], v14 offset:544
  ds_read_b64_tr_b16 v[108:109], v15 offset:8192
  ds_read_b64_tr_b16 v[110:111], v15 offset:8832
  s_waitcnt lgkmcnt(3)
  v_mfma_f32_32x32x16_bf16 v[32:47], v[88:91], v[104:107], v[32:47]
  s_waitcnt lgkmcnt(0)
  v_mfma_f32_32x32x16_bf16 v[32:47], v[92:95], v[108:111], v[32:47]
  s_waitcnt vmcnt(10)
  ds_write_b128 v10, v[176:179] offset:10752
  ds_write_b128 v13, v[180:183] offset:15872
  s_waitcnt lgkmcnt(0)
  s_barrier
  buffer_load_dwordx4 v[176:179], v8, s[4:7], 0 offen offset:1088
  s_mov_b32 s29, 557056
  buffer_load_dwordx4 v[180:183], v11, s[8:11], s29 offen
  ds_read_b128 v[88:91], v14 offset:10752
  ds_read_b64_tr_b16 v[104:105], v15 offset:15872
  ds_read_b64_tr_b16 v[106:107], v15 offset:16512
  ds_read_b128 v[92:95], v14 offset:10784
  ds_read_b64_tr_b16 v[108:109], v15 offset:18432
  ds_read_b64_tr_b16 v[110:111], v15 offset:19072
  s_waitcnt lgkmcnt(3)
  v_mfma_f32_32x32x16_bf16 v[32:47], v[88:91], v[104:107], v[32:47]
  s_waitcnt lgkmcnt(0)
  v_mfma_f32_32x32x16_bf16 v[32:47], v[92:95], v[108:111], v[32:47]
  s_waitcnt vmcnt(10)
  ds_write_b128 v10, v[136:139] offset:512
  ds_write_b128 v13, v[140:143] offset:5632
  s_waitcnt lgkmcnt(0)
  s_barrier
  buffer_load_dwordx4 v[136:139], v8, s[4:7], 0 offen offset:1152
  s_mov_b32 s29, 589824
  buffer_load_dwordx4 v[140:143], v11, s[8:11], s29 offen
  ds_read_b128 v[88:91], v14 offset:512
  ds_read_b64_tr_b16 v[104:105], v15 offset:5632
  ds_read_b64_tr_b16 v[106:107], v15 offset:6272
  ds_read_b128 v[92:95], v14 offset:544
  ds_read_b64_tr_b16 v[108:109], v15 offset:8192
  ds_read_b64_tr_b16 v[110:111], v15 offset:8832
  s_waitcnt lgkmcnt(3)
  v_mfma_f32_32x32x16_bf16 v[32:47], v[88:91], v[104:107], v[32:47]
  s_waitcnt lgkmcnt(0)
  v_mfma_f32_32x32x16_bf16 v[32:47], v[92:95], v[108:111], v[32:47]
  s_waitcnt vmcnt(10)
  ds_write_b128 v10, v[144:147] offset:10752
  ds_write_b128 v13, v[148:151] offset:15872
  s_waitcnt lgkmcnt(0)
  s_barrier
  buffer_load_dwordx4 v[144:147], v8, s[4:7], 0 offen offset:1216
  s_mov_b32 s29, 622592
  buffer_load_dwordx4 v[148:151], v11, s[8:11], s29 offen
  ds_read_b128 v[88:91], v14 offset:10752
  ds_read_b64_tr_b16 v[104:105], v15 offset:15872
  ds_read_b64_tr_b16 v[106:107], v15 offset:16512
  ds_read_b128 v[92:95], v14 offset:10784
  ds_read_b64_tr_b16 v[108:109], v15 offset:18432
  ds_read_b64_tr_b16 v[110:111], v15 offset:19072
  s_waitcnt lgkmcnt(3)
  v_mfma_f32_32x32x16_bf16 v[32:47], v[88:91], v[104:107], v[32:47]
  s_waitcnt lgkmcnt(0)
  v_mfma_f32_32x32x16_bf16 v[32:47], v[92:95], v[108:111], v[32:47]
  s_waitcnt vmcnt(10)
  ds_write_b128 v10, v[152:155] offset:512
  ds_write_b128 v13, v[156:159] offset:5632
  s_waitcnt lgkmcnt(0)
  s_barrier
  buffer_load_dwordx4 v[152:155], v8, s[4:7], 0 offen offset:1280
  s_mov_b32 s29, 655360
  buffer_load_dwordx4 v[156:159], v11, s[8:11], s29 offen
  ds_read_b128 v[88:91], v14 offset:512
  ds_read_b64_tr_b16 v[104:105], v15 offset:5632
  ds_read_b64_tr_b16 v[106:107], v15 offset:6272
  ds_read_b128 v[92:95], v14 offset:544
  ds_read_b64_tr_b16 v[108:109], v15 offset:8192
  ds_read_b64_tr_b16 v[110:111], v15 offset:8832
  s_waitcnt lgkmcnt(3)
  v_mfma_f32_32x32x16_bf16 v[32:47], v[88:91], v[104:107], v[32:47]
  s_waitcnt lgkmcnt(0)
  v_mfma_f32_32x32x16_bf16 v[32:47], v[92:95], v[108:111], v[32:47]
  s_waitcnt vmcnt(10)
  ds_write_b128 v10, v[160:163] offset:10752
  ds_write_b128 v13, v[164:167] offset:15872
  s_waitcnt lgkmcnt(0)
  s_barrier
  buffer_load_dwordx4 v[160:163], v8, s[4:7], 0 offen offset:1344
  s_mov_b32 s29, 688128
  buffer_load_dwordx4 v[164:167], v11, s[8:11], s29 offen
  ds_read_b128 v[88:91], v14 offset:10752
  ds_read_b64_tr_b16 v[104:105], v15 offset:15872
  ds_read_b64_tr_b16 v[106:107], v15 offset:16512
  ds_read_b128 v[92:95], v14 offset:10784
  ds_read_b64_tr_b16 v[108:109], v15 offset:18432
  ds_read_b64_tr_b16 v[110:111], v15 offset:19072
  s_waitcnt lgkmcnt(3)
  v_mfma_f32_32x32x16_bf16 v[32:47], v[88:91], v[104:107], v[32:47]
  s_waitcnt lgkmcnt(0)
  v_mfma_f32_32x32x16_bf16 v[32:47], v[92:95], v[108:111], v[32:47]
  s_waitcnt vmcnt(10)
  ds_write_b128 v10, v[168:171] offset:512
  ds_write_b128 v13, v[172:175] offset:5632
  s_waitcnt lgkmcnt(0)
  s_barrier
  buffer_load_dwordx4 v[168:171], v8, s[4:7], 0 offen offset:1408
  s_mov_b32 s29, 720896
  buffer_load_dwordx4 v[172:175], v11, s[8:11], s29 offen
  ds_read_b128 v[88:91], v14 offset:512
  ds_read_b64_tr_b16 v[104:105], v15 offset:5632
  ds_read_b64_tr_b16 v[106:107], v15 offset:6272
  ds_read_b128 v[92:95], v14 offset:544
  ds_read_b64_tr_b16 v[108:109], v15 offset:8192
  ds_read_b64_tr_b16 v[110:111], v15 offset:8832
  s_waitcnt lgkmcnt(3)
  v_mfma_f32_32x32x16_bf16 v[32:47], v[88:91], v[104:107], v[32:47]
  s_waitcnt lgkmcnt(0)
  v_mfma_f32_32x32x16_bf16 v[32:47], v[92:95], v[108:111], v[32:47]
  s_waitcnt vmcnt(10)
  ds_write_b128 v10, v[176:179] offset:10752
  ds_write_b128 v13, v[180:183] offset:15872
  s_waitcnt lgkmcnt(0)
  s_barrier
  buffer_load_dwordx4 v[176:179], v8, s[4:7], 0 offen offset:1472
  s_mov_b32 s29, 753664
  buffer_load_dwordx4 v[180:183], v11, s[8:11], s29 offen
  ds_read_b128 v[88:91], v14 offset:10752
  ds_read_b64_tr_b16 v[104:105], v15 offset:15872
  ds_read_b64_tr_b16 v[106:107], v15 offset:16512
  ds_read_b128 v[92:95], v14 offset:10784
  ds_read_b64_tr_b16 v[108:109], v15 offset:18432
  ds_read_b64_tr_b16 v[110:111], v15 offset:19072
  s_waitcnt lgkmcnt(3)
  v_mfma_f32_32x32x16_bf16 v[32:47], v[88:91], v[104:107], v[32:47]
  s_waitcnt lgkmcnt(0)
  v_mfma_f32_32x32x16_bf16 v[32:47], v[92:95], v[108:111], v[32:47]
  s_waitcnt vmcnt(10)
  ds_write_b128 v10, v[136:139] offset:512
  ds_write_b128 v13, v[140:143] offset:5632
  s_waitcnt lgkmcnt(0)
  s_barrier
  buffer_load_dwordx4 v[136:139], v8, s[4:7], 0 offen offset:1536
  s_mov_b32 s29, 786432
  buffer_load_dwordx4 v[140:143], v11, s[8:11], s29 offen
  ds_read_b128 v[88:91], v14 offset:512
  ds_read_b64_tr_b16 v[104:105], v15 offset:5632
  ds_read_b64_tr_b16 v[106:107], v15 offset:6272
  ds_read_b128 v[92:95], v14 offset:544
  ds_read_b64_tr_b16 v[108:109], v15 offset:8192
  ds_read_b64_tr_b16 v[110:111], v15 offset:8832
  s_waitcnt lgkmcnt(3)
  v_mfma_f32_32x32x16_bf16 v[32:47], v[88:91], v[104:107], v[32:47]
  s_waitcnt lgkmcnt(0)
  v_mfma_f32_32x32x16_bf16 v[32:47], v[92:95], v[108:111], v[32:47]
  s_waitcnt vmcnt(10)
  ds_write_b128 v10, v[144:147] offset:10752
  ds_write_b128 v13, v[148:151] offset:15872
  s_waitcnt lgkmcnt(0)
  s_barrier
  buffer_load_dwordx4 v[144:147], v8, s[4:7], 0 offen offset:1600
  s_mov_b32 s29, 819200
  buffer_load_dwordx4 v[148:151], v11, s[8:11], s29 offen
  ds_read_b128 v[88:91], v14 offset:10752
  ds_read_b64_tr_b16 v[104:105], v15 offset:15872
  ds_read_b64_tr_b16 v[106:107], v15 offset:16512
  ds_read_b128 v[92:95], v14 offset:10784
  ds_read_b64_tr_b16 v[108:109], v15 offset:18432
  ds_read_b64_tr_b16 v[110:111], v15 offset:19072
  s_waitcnt lgkmcnt(3)
  v_mfma_f32_32x32x16_bf16 v[32:47], v[88:91], v[104:107], v[32:47]
  s_waitcnt lgkmcnt(0)
  v_mfma_f32_32x32x16_bf16 v[32:47], v[92:95], v[108:111], v[32:47]
  s_waitcnt vmcnt(10)
  ds_write_b128 v10, v[152:155] offset:512
  ds_write_b128 v13, v[156:159] offset:5632
  s_waitcnt lgkmcnt(0)
  s_barrier
  buffer_load_dwordx4 v[152:155], v8, s[4:7], 0 offen offset:1664
  s_mov_b32 s29, 851968
  buffer_load_dwordx4 v[156:159], v11, s[8:11], s29 offen
  ds_read_b128 v[88:91], v14 offset:512
  ds_read_b64_tr_b16 v[104:105], v15 offset:5632
  ds_read_b64_tr_b16 v[106:107], v15 offset:6272
  ds_read_b128 v[92:95], v14 offset:544
  ds_read_b64_tr_b16 v[108:109], v15 offset:8192
  ds_read_b64_tr_b16 v[110:111], v15 offset:8832
  s_waitcnt lgkmcnt(3)
  v_mfma_f32_32x32x16_bf16 v[32:47], v[88:91], v[104:107], v[32:47]
  s_waitcnt lgkmcnt(0)
  v_mfma_f32_32x32x16_bf16 v[32:47], v[92:95], v[108:111], v[32:47]
  s_waitcnt vmcnt(10)
  ds_write_b128 v10, v[160:163] offset:10752
  ds_write_b128 v13, v[164:167] offset:15872
  s_waitcnt lgkmcnt(0)
  s_barrier
  buffer_load_dwordx4 v[160:163], v8, s[4:7], 0 offen offset:1728
  s_mov_b32 s29, 884736
  buffer_load_dwordx4 v[164:167], v11, s[8:11], s29 offen
  ds_read_b128 v[88:91], v14 offset:10752
  ds_read_b64_tr_b16 v[104:105], v15 offset:15872
  ds_read_b64_tr_b16 v[106:107], v15 offset:16512
  ds_read_b128 v[92:95], v14 offset:10784
  ds_read_b64_tr_b16 v[108:109], v15 offset:18432
  ds_read_b64_tr_b16 v[110:111], v15 offset:19072
  s_waitcnt lgkmcnt(3)
  v_mfma_f32_32x32x16_bf16 v[32:47], v[88:91], v[104:107], v[32:47]
  s_waitcnt lgkmcnt(0)
  v_mfma_f32_32x32x16_bf16 v[32:47], v[92:95], v[108:111], v[32:47]
  s_waitcnt vmcnt(10)
  ds_write_b128 v10, v[168:171] offset:512
  ds_write_b128 v13, v[172:175] offset:5632
  s_waitcnt lgkmcnt(0)
  s_barrier
  buffer_load_dwordx4 v[168:171], v8, s[4:7], 0 offen offset:1792
  s_mov_b32 s29, 917504
  buffer_load_dwordx4 v[172:175], v11, s[8:11], s29 offen
  ds_read_b128 v[88:91], v14 offset:512
  ds_read_b64_tr_b16 v[104:105], v15 offset:5632
  ds_read_b64_tr_b16 v[106:107], v15 offset:6272
  ds_read_b128 v[92:95], v14 offset:544
  ds_read_b64_tr_b16 v[108:109], v15 offset:8192
  ds_read_b64_tr_b16 v[110:111], v15 offset:8832
  s_waitcnt lgkmcnt(3)
  v_mfma_f32_32x32x16_bf16 v[32:47], v[88:91], v[104:107], v[32:47]
  s_waitcnt lgkmcnt(0)
  v_mfma_f32_32x32x16_bf16 v[32:47], v[92:95], v[108:111], v[32:47]
  s_waitcnt vmcnt(10)
  ds_write_b128 v10, v[176:179] offset:10752
  ds_write_b128 v13, v[180:183] offset:15872
  s_waitcnt lgkmcnt(0)
  s_barrier
  buffer_load_dwordx4 v[176:179], v8, s[4:7], 0 offen offset:1856
  s_mov_b32 s29, 950272
  buffer_load_dwordx4 v[180:183], v11, s[8:11], s29 offen
  ds_read_b128 v[88:91], v14 offset:10752
  ds_read_b64_tr_b16 v[104:105], v15 offset:15872
  ds_read_b64_tr_b16 v[106:107], v15 offset:16512
  ds_read_b128 v[92:95], v14 offset:10784
  ds_read_b64_tr_b16 v[108:109], v15 offset:18432
  ds_read_b64_tr_b16 v[110:111], v15 offset:19072
  s_waitcnt lgkmcnt(3)
  v_mfma_f32_32x32x16_bf16 v[32:47], v[88:91], v[104:107], v[32:47]
  s_waitcnt lgkmcnt(0)
  v_mfma_f32_32x32x16_bf16 v[32:47], v[92:95], v[108:111], v[32:47]
  s_waitcnt vmcnt(10)
  ds_write_b128 v10, v[136:139] offset:512
  ds_write_b128 v13, v[140:143] offset:5632
  s_waitcnt lgkmcnt(0)
  s_barrier
  buffer_load_dwordx4 v[136:139], v8, s[4:7], 0 offen offset:1920
  s_mov_b32 s29, 983040
  buffer_load_dwordx4 v[140:143], v11, s[8:11], s29 offen
  ds_read_b128 v[88:91], v14 offset:512
  ds_read_b64_tr_b16 v[104:105], v15 offset:5632
  ds_read_b64_tr_b16 v[106:107], v15 offset:6272
  ds_read_b128 v[92:95], v14 offset:544
  ds_read_b64_tr_b16 v[108:109], v15 offset:8192
  ds_read_b64_tr_b16 v[110:111], v15 offset:8832
  s_waitcnt lgkmcnt(3)
  v_mfma_f32_32x32x16_bf16 v[32:47], v[88:91], v[104:107], v[32:47]
  s_waitcnt lgkmcnt(0)
  v_mfma_f32_32x32x16_bf16 v[32:47], v[92:95], v[108:111], v[32:47]
  s_waitcnt vmcnt(10)
  ds_write_b128 v10, v[144:147] offset:10752
  ds_write_b128 v13, v[148:151] offset:15872
  s_waitcnt lgkmcnt(0)
  s_barrier
  buffer_load_dwordx4 v[144:147], v8, s[4:7], 0 offen offset:1984
  s_mov_b32 s29, 1015808
  buffer_load_dwordx4 v[148:151], v11, s[8:11], s29 offen
  ds_read_b128 v[88:91], v14 offset:10752
  ds_read_b64_tr_b16 v[104:105], v15 offset:15872
  ds_read_b64_tr_b16 v[106:107], v15 offset:16512
  ds_read_b128 v[92:95], v14 offset:10784
  ds_read_b64_tr_b16 v[108:109], v15 offset:18432
  ds_read_b64_tr_b16 v[110:111], v15 offset:19072
  s_waitcnt lgkmcnt(3)
  v_mfma_f32_32x32x16_bf16 v[32:47], v[88:91], v[104:107], v[32:47]
  s_waitcnt lgkmcnt(0)
  v_mfma_f32_32x32x16_bf16 v[32:47], v[92:95], v[108:111], v[32:47]
  s_waitcnt vmcnt(10)
  ds_write_b128 v10, v[152:155] offset:512
  ds_write_b128 v13, v[156:159] offset:5632
  s_waitcnt lgkmcnt(0)
  s_barrier
  buffer_load_dwordx4 v[152:155], v8, s[4:7], 0 offen offset:2048
  s_mov_b32 s29, 1048576
  buffer_load_dwordx4 v[156:159], v11, s[8:11], s29 offen
  ds_read_b128 v[88:91], v14 offset:512
  ds_read_b64_tr_b16 v[104:105], v15 offset:5632
  ds_read_b64_tr_b16 v[106:107], v15 offset:6272
  ds_read_b128 v[92:95], v14 offset:544
  ds_read_b64_tr_b16 v[108:109], v15 offset:8192
  ds_read_b64_tr_b16 v[110:111], v15 offset:8832
  s_waitcnt lgkmcnt(3)
  v_mfma_f32_32x32x16_bf16 v[32:47], v[88:91], v[104:107], v[32:47]
  s_waitcnt lgkmcnt(0)
  v_mfma_f32_32x32x16_bf16 v[32:47], v[92:95], v[108:111], v[32:47]
  s_waitcnt vmcnt(10)
  ds_write_b128 v10, v[160:163] offset:10752
  ds_write_b128 v13, v[164:167] offset:15872
  s_waitcnt lgkmcnt(0)
  s_barrier
  buffer_load_dwordx4 v[160:163], v8, s[4:7], 0 offen offset:2112
  s_mov_b32 s29, 1081344
  buffer_load_dwordx4 v[164:167], v11, s[8:11], s29 offen
  ds_read_b128 v[88:91], v14 offset:10752
  ds_read_b64_tr_b16 v[104:105], v15 offset:15872
  ds_read_b64_tr_b16 v[106:107], v15 offset:16512
  ds_read_b128 v[92:95], v14 offset:10784
  ds_read_b64_tr_b16 v[108:109], v15 offset:18432
  ds_read_b64_tr_b16 v[110:111], v15 offset:19072
  s_waitcnt lgkmcnt(3)
  v_mfma_f32_32x32x16_bf16 v[32:47], v[88:91], v[104:107], v[32:47]
  s_waitcnt lgkmcnt(0)
  v_mfma_f32_32x32x16_bf16 v[32:47], v[92:95], v[108:111], v[32:47]
  s_waitcnt vmcnt(10)
  ds_write_b128 v10, v[168:171] offset:512
  ds_write_b128 v13, v[172:175] offset:5632
  s_waitcnt lgkmcnt(0)
  s_barrier
  buffer_load_dwordx4 v[168:171], v8, s[4:7], 0 offen offset:2176
  s_mov_b32 s29, 1114112
  buffer_load_dwordx4 v[172:175], v11, s[8:11], s29 offen
  ds_read_b128 v[88:91], v14 offset:512
  ds_read_b64_tr_b16 v[104:105], v15 offset:5632
  ds_read_b64_tr_b16 v[106:107], v15 offset:6272
  ds_read_b128 v[92:95], v14 offset:544
  ds_read_b64_tr_b16 v[108:109], v15 offset:8192
  ds_read_b64_tr_b16 v[110:111], v15 offset:8832
  s_waitcnt lgkmcnt(3)
  v_mfma_f32_32x32x16_bf16 v[32:47], v[88:91], v[104:107], v[32:47]
  s_waitcnt lgkmcnt(0)
  v_mfma_f32_32x32x16_bf16 v[32:47], v[92:95], v[108:111], v[32:47]
  s_waitcnt vmcnt(10)
  ds_write_b128 v10, v[176:179] offset:10752
  ds_write_b128 v13, v[180:183] offset:15872
  s_waitcnt lgkmcnt(0)
  s_barrier
  buffer_load_dwordx4 v[176:179], v8, s[4:7], 0 offen offset:2240
  s_mov_b32 s29, 1146880
  buffer_load_dwordx4 v[180:183], v11, s[8:11], s29 offen
  ds_read_b128 v[88:91], v14 offset:10752
  ds_read_b64_tr_b16 v[104:105], v15 offset:15872
  ds_read_b64_tr_b16 v[106:107], v15 offset:16512
  ds_read_b128 v[92:95], v14 offset:10784
  ds_read_b64_tr_b16 v[108:109], v15 offset:18432
  ds_read_b64_tr_b16 v[110:111], v15 offset:19072
  s_waitcnt lgkmcnt(3)
  v_mfma_f32_32x32x16_bf16 v[32:47], v[88:91], v[104:107], v[32:47]
  s_waitcnt lgkmcnt(0)
  v_mfma_f32_32x32x16_bf16 v[32:47], v[92:95], v[108:111], v[32:47]
  s_waitcnt vmcnt(10)
  ds_write_b128 v10, v[136:139] offset:512
  ds_write_b128 v13, v[140:143] offset:5632
  s_waitcnt lgkmcnt(0)
  s_barrier
  buffer_load_dwordx4 v[136:139], v8, s[4:7], 0 offen offset:2304
  s_mov_b32 s29, 1179648
  buffer_load_dwordx4 v[140:143], v11, s[8:11], s29 offen
  ds_read_b128 v[88:91], v14 offset:512
  ds_read_b64_tr_b16 v[104:105], v15 offset:5632
  ds_read_b64_tr_b16 v[106:107], v15 offset:6272
  ds_read_b128 v[92:95], v14 offset:544
  ds_read_b64_tr_b16 v[108:109], v15 offset:8192
  ds_read_b64_tr_b16 v[110:111], v15 offset:8832
  s_waitcnt lgkmcnt(3)
  v_mfma_f32_32x32x16_bf16 v[32:47], v[88:91], v[104:107], v[32:47]
  s_waitcnt lgkmcnt(0)
  v_mfma_f32_32x32x16_bf16 v[32:47], v[92:95], v[108:111], v[32:47]
  s_waitcnt vmcnt(10)
  ds_write_b128 v10, v[144:147] offset:10752
  ds_write_b128 v13, v[148:151] offset:15872
  s_waitcnt lgkmcnt(0)
  s_barrier
  buffer_load_dwordx4 v[144:147], v8, s[4:7], 0 offen offset:2368
  s_mov_b32 s29, 1212416
  buffer_load_dwordx4 v[148:151], v11, s[8:11], s29 offen
  ds_read_b128 v[88:91], v14 offset:10752
  ds_read_b64_tr_b16 v[104:105], v15 offset:15872
  ds_read_b64_tr_b16 v[106:107], v15 offset:16512
  ds_read_b128 v[92:95], v14 offset:10784
  ds_read_b64_tr_b16 v[108:109], v15 offset:18432
  ds_read_b64_tr_b16 v[110:111], v15 offset:19072
  s_waitcnt lgkmcnt(3)
  v_mfma_f32_32x32x16_bf16 v[32:47], v[88:91], v[104:107], v[32:47]
  s_waitcnt lgkmcnt(0)
  v_mfma_f32_32x32x16_bf16 v[32:47], v[92:95], v[108:111], v[32:47]
  s_waitcnt vmcnt(10)
  ds_write_b128 v10, v[152:155] offset:512
  ds_write_b128 v13, v[156:159] offset:5632
  s_waitcnt lgkmcnt(0)
  s_barrier
  buffer_load_dwordx4 v[152:155], v8, s[4:7], 0 offen offset:2432
  s_mov_b32 s29, 1245184
  buffer_load_dwordx4 v[156:159], v11, s[8:11], s29 offen
  ds_read_b128 v[88:91], v14 offset:512
  ds_read_b64_tr_b16 v[104:105], v15 offset:5632
  ds_read_b64_tr_b16 v[106:107], v15 offset:6272
  ds_read_b128 v[92:95], v14 offset:544
  ds_read_b64_tr_b16 v[108:109], v15 offset:8192
  ds_read_b64_tr_b16 v[110:111], v15 offset:8832
  s_waitcnt lgkmcnt(3)
  v_mfma_f32_32x32x16_bf16 v[32:47], v[88:91], v[104:107], v[32:47]
  s_waitcnt lgkmcnt(0)
  v_mfma_f32_32x32x16_bf16 v[32:47], v[92:95], v[108:111], v[32:47]
  s_waitcnt vmcnt(10)
  ds_write_b128 v10, v[160:163] offset:10752
  ds_write_b128 v13, v[164:167] offset:15872
  s_waitcnt lgkmcnt(0)
  s_barrier
  buffer_load_dwordx4 v[160:163], v8, s[4:7], 0 offen offset:2496
  s_mov_b32 s29, 1277952
  buffer_load_dwordx4 v[164:167], v11, s[8:11], s29 offen
  ds_read_b128 v[88:91], v14 offset:10752
  ds_read_b64_tr_b16 v[104:105], v15 offset:15872
  ds_read_b64_tr_b16 v[106:107], v15 offset:16512
  ds_read_b128 v[92:95], v14 offset:10784
  ds_read_b64_tr_b16 v[108:109], v15 offset:18432
  ds_read_b64_tr_b16 v[110:111], v15 offset:19072
  s_waitcnt lgkmcnt(3)
  v_mfma_f32_32x32x16_bf16 v[32:47], v[88:91], v[104:107], v[32:47]
  s_waitcnt lgkmcnt(0)
  v_mfma_f32_32x32x16_bf16 v[32:47], v[92:95], v[108:111], v[32:47]
  s_waitcnt vmcnt(10)
  ds_write_b128 v10, v[168:171] offset:512
  ds_write_b128 v13, v[172:175] offset:5632
  s_waitcnt lgkmcnt(0)
  s_barrier
  buffer_load_dwordx4 v[168:171], v8, s[4:7], 0 offen offset:2560
  s_mov_b32 s29, 1310720
  buffer_load_dwordx4 v[172:175], v11, s[8:11], s29 offen
  ds_read_b128 v[88:91], v14 offset:512
  ds_read_b64_tr_b16 v[104:105], v15 offset:5632
  ds_read_b64_tr_b16 v[106:107], v15 offset:6272
  ds_read_b128 v[92:95], v14 offset:544
  ds_read_b64_tr_b16 v[108:109], v15 offset:8192
  ds_read_b64_tr_b16 v[110:111], v15 offset:8832
  s_waitcnt lgkmcnt(3)
  v_mfma_f32_32x32x16_bf16 v[32:47], v[88:91], v[104:107], v[32:47]
  s_waitcnt lgkmcnt(0)
  v_mfma_f32_32x32x16_bf16 v[32:47], v[92:95], v[108:111], v[32:47]
  s_waitcnt vmcnt(10)
  ds_write_b128 v10, v[176:179] offset:10752
  ds_write_b128 v13, v[180:183] offset:15872
  s_waitcnt lgkmcnt(0)
  s_barrier
  buffer_load_dwordx4 v[176:179], v8, s[4:7], 0 offen offset:2624
  s_mov_b32 s29, 1343488
  buffer_load_dwordx4 v[180:183], v11, s[8:11], s29 offen
  ds_read_b128 v[88:91], v14 offset:10752
  ds_read_b64_tr_b16 v[104:105], v15 offset:15872
  ds_read_b64_tr_b16 v[106:107], v15 offset:16512
  ds_read_b128 v[92:95], v14 offset:10784
  ds_read_b64_tr_b16 v[108:109], v15 offset:18432
  ds_read_b64_tr_b16 v[110:111], v15 offset:19072
  s_waitcnt lgkmcnt(3)
  v_mfma_f32_32x32x16_bf16 v[32:47], v[88:91], v[104:107], v[32:47]
  s_waitcnt lgkmcnt(0)
  v_mfma_f32_32x32x16_bf16 v[32:47], v[92:95], v[108:111], v[32:47]
  s_waitcnt vmcnt(10)
  ds_write_b128 v10, v[136:139] offset:512
  ds_write_b128 v13, v[140:143] offset:5632
  s_waitcnt lgkmcnt(0)
  s_barrier
  buffer_load_dwordx4 v[136:139], v8, s[4:7], 0 offen offset:2688
  s_mov_b32 s29, 1376256
  buffer_load_dwordx4 v[140:143], v11, s[8:11], s29 offen
  ds_read_b128 v[88:91], v14 offset:512
  ds_read_b64_tr_b16 v[104:105], v15 offset:5632
  ds_read_b64_tr_b16 v[106:107], v15 offset:6272
  ds_read_b128 v[92:95], v14 offset:544
  ds_read_b64_tr_b16 v[108:109], v15 offset:8192
  ds_read_b64_tr_b16 v[110:111], v15 offset:8832
  s_waitcnt lgkmcnt(3)
  v_mfma_f32_32x32x16_bf16 v[32:47], v[88:91], v[104:107], v[32:47]
  s_waitcnt lgkmcnt(0)
  v_mfma_f32_32x32x16_bf16 v[32:47], v[92:95], v[108:111], v[32:47]
  s_waitcnt vmcnt(10)
  ds_write_b128 v10, v[144:147] offset:10752
  ds_write_b128 v13, v[148:151] offset:15872
  s_waitcnt lgkmcnt(0)
  s_barrier
  ds_read_b128 v[88:91], v14 offset:10752
  ds_read_b64_tr_b16 v[104:105], v15 offset:15872
  ds_read_b64_tr_b16 v[106:107], v15 offset:16512
  ds_read_b128 v[92:95], v14 offset:10784
  ds_read_b64_tr_b16 v[108:109], v15 offset:18432
  ds_read_b64_tr_b16 v[110:111], v15 offset:19072
  s_waitcnt lgkmcnt(3)
  v_mfma_f32_32x32x16_bf16 v[32:47], v[88:91], v[104:107], v[32:47]
  s_waitcnt lgkmcnt(0)
  v_mfma_f32_32x32x16_bf16 v[32:47], v[92:95], v[108:111], v[32:47]
  s_waitcnt vmcnt(8)
  ds_write_b128 v10, v[152:155] offset:512
  ds_write_b128 v13, v[156:159] offset:5632
  s_waitcnt lgkmcnt(0)
  s_barrier
  ds_read_b128 v[88:91], v14 offset:512
  ds_read_b64_tr_b16 v[104:105], v15 offset:5632
  ds_read_b64_tr_b16 v[106:107], v15 offset:6272
  ds_read_b128 v[92:95], v14 offset:544
  ds_read_b64_tr_b16 v[108:109], v15 offset:8192
  ds_read_b64_tr_b16 v[110:111], v15 offset:8832
  s_waitcnt lgkmcnt(3)
  v_mfma_f32_32x32x16_bf16 v[32:47], v[88:91], v[104:107], v[32:47]
  s_waitcnt lgkmcnt(0)
  v_mfma_f32_32x32x16_bf16 v[32:47], v[92:95], v[108:111], v[32:47]
  s_waitcnt vmcnt(6)
  ds_write_b128 v10, v[160:163] offset:10752
  ds_write_b128 v13, v[164:167] offset:15872
  s_waitcnt lgkmcnt(0)
  s_barrier
  ds_read_b128 v[88:91], v14 offset:10752
  ds_read_b64_tr_b16 v[104:105], v15 offset:15872
  ds_read_b64_tr_b16 v[106:107], v15 offset:16512
  ds_read_b128 v[92:95], v14 offset:10784
  ds_read_b64_tr_b16 v[108:109], v15 offset:18432
  ds_read_b64_tr_b16 v[110:111], v15 offset:19072
  s_waitcnt lgkmcnt(3)
  v_mfma_f32_32x32x16_bf16 v[32:47], v[88:91], v[104:107], v[32:47]
  s_waitcnt lgkmcnt(0)
  v_mfma_f32_32x32x16_bf16 v[32:47], v[92:95], v[108:111], v[32:47]
  s_waitcnt vmcnt(4)
  ds_write_b128 v10, v[168:171] offset:512
  ds_write_b128 v13, v[172:175] offset:5632
  s_waitcnt lgkmcnt(0)
  s_barrier
  ds_read_b128 v[88:91], v14 offset:512
  ds_read_b64_tr_b16 v[104:105], v15 offset:5632
  ds_read_b64_tr_b16 v[106:107], v15 offset:6272
  ds_read_b128 v[92:95], v14 offset:544
  ds_read_b64_tr_b16 v[108:109], v15 offset:8192
  ds_read_b64_tr_b16 v[110:111], v15 offset:8832
  s_waitcnt lgkmcnt(3)
  v_mfma_f32_32x32x16_bf16 v[32:47], v[88:91], v[104:107], v[32:47]
  s_waitcnt lgkmcnt(0)
  v_mfma_f32_32x32x16_bf16 v[32:47], v[92:95], v[108:111], v[32:47]
  s_waitcnt vmcnt(2)
  ds_write_b128 v10, v[176:179] offset:10752
  ds_write_b128 v13, v[180:183] offset:15872
  s_waitcnt lgkmcnt(0)
  s_barrier
  ds_read_b128 v[88:91], v14 offset:10752
  ds_read_b64_tr_b16 v[104:105], v15 offset:15872
  ds_read_b64_tr_b16 v[106:107], v15 offset:16512
  ds_read_b128 v[92:95], v14 offset:10784
  ds_read_b64_tr_b16 v[108:109], v15 offset:18432
  ds_read_b64_tr_b16 v[110:111], v15 offset:19072
  s_waitcnt lgkmcnt(3)
  v_mfma_f32_32x32x16_bf16 v[32:47], v[88:91], v[104:107], v[32:47]
  s_waitcnt lgkmcnt(0)
  v_mfma_f32_32x32x16_bf16 v[32:47], v[92:95], v[108:111], v[32:47]
  s_waitcnt vmcnt(0)
  ds_write_b128 v10, v[136:139] offset:512
  ds_write_b128 v13, v[140:143] offset:5632
  s_waitcnt lgkmcnt(0)
  s_barrier
  ds_read_b128 v[88:91], v14 offset:512
  ds_read_b64_tr_b16 v[104:105], v15 offset:5632
  ds_read_b64_tr_b16 v[106:107], v15 offset:6272
  ds_read_b128 v[92:95], v14 offset:544
  ds_read_b64_tr_b16 v[108:109], v15 offset:8192
  ds_read_b64_tr_b16 v[110:111], v15 offset:8832
  s_waitcnt lgkmcnt(3)
  v_mfma_f32_32x32x16_bf16 v[32:47], v[88:91], v[104:107], v[32:47]
  s_waitcnt lgkmcnt(0)
  v_mfma_f32_32x32x16_bf16 v[32:47], v[92:95], v[108:111], v[32:47]
  s_nop 15
  v_lshrrev_b32 v5, 1, v2
  v_and_b32 v6, 1, v2
  v_lshlrev_b32 v7, 5, v5
  v_lshl_add_u32 v7, v3, 2, v7
  v_add_u32 v7, s24, v7
  s_mov_b32 s28, 1024
  v_mul_lo_u32 v8, v7, s28
  v_lshl_add_u32 v9, v6, 5, v4
  v_add_u32 v9, s25, v9
  v_lshl_add_u32 v8, v9, 1, v8
  s_mov_b32 s29, 0
  buffer_load_ushort v64, v8, s[20:23], s29 offen
  s_mov_b32 s29, 1024
  buffer_load_ushort v65, v8, s[20:23], s29 offen
  s_mov_b32 s29, 2048
  buffer_load_ushort v66, v8, s[20:23], s29 offen
  s_mov_b32 s29, 3072
  buffer_load_ushort v67, v8, s[20:23], s29 offen
  s_mov_b32 s29, 8192
  buffer_load_ushort v68, v8, s[20:23], s29 offen
  s_mov_b32 s29, 9216
  buffer_load_ushort v69, v8, s[20:23], s29 offen
  s_mov_b32 s29, 10240
  buffer_load_ushort v70, v8, s[20:23], s29 offen
  s_mov_b32 s29, 11264
  buffer_load_ushort v71, v8, s[20:23], s29 offen
  s_mov_b32 s29, 16384
  buffer_load_ushort v72, v8, s[20:23], s29 offen
  s_mov_b32 s29, 17408
  buffer_load_ushort v73, v8, s[20:23], s29 offen
  s_mov_b32 s29, 18432
  buffer_load_ushort v74, v8, s[20:23], s29 offen
  s_mov_b32 s29, 19456
  buffer_load_ushort v75, v8, s[20:23], s29 offen
  s_mov_b32 s29, 24576
  buffer_load_ushort v76, v8, s[20:23], s29 offen
  s_mov_b32 s29, 25600
  buffer_load_ushort v77, v8, s[20:23], s29 offen
  s_mov_b32 s29, 26624
  buffer_load_ushort v78, v8, s[20:23], s29 offen
  s_mov_b32 s29, 27648
  buffer_load_ushort v79, v8, s[20:23], s29 offen
  s_waitcnt vmcnt(0)
  v_lshlrev_b32 v64, 16, v64
  v_add_f32 v32, v32, v64
  v_lshlrev_b32 v65, 16, v65
  v_add_f32 v33, v33, v65
  v_lshlrev_b32 v66, 16, v66
  v_add_f32 v34, v34, v66
  v_lshlrev_b32 v67, 16, v67
  v_add_f32 v35, v35, v67
  v_lshlrev_b32 v68, 16, v68
  v_add_f32 v36, v36, v68
  v_lshlrev_b32 v69, 16, v69
  v_add_f32 v37, v37, v69
  v_lshlrev_b32 v70, 16, v70
  v_add_f32 v38, v38, v70
  v_lshlrev_b32 v71, 16, v71
  v_add_f32 v39, v39, v71
  v_lshlrev_b32 v72, 16, v72
  v_add_f32 v40, v40, v72
  v_lshlrev_b32 v73, 16, v73
  v_add_f32 v41, v41, v73
  v_lshlrev_b32 v74, 16, v74
  v_add_f32 v42, v42, v74
  v_lshlrev_b32 v75, 16, v75
  v_add_f32 v43, v43, v75
  v_lshlrev_b32 v76, 16, v76
  v_add_f32 v44, v44, v76
  v_lshlrev_b32 v77, 16, v77
  v_add_f32 v45, v45, v77
  v_lshlrev_b32 v78, 16, v78
  v_add_f32 v46, v46, v78
  v_lshlrev_b32 v79, 16, v79
  v_add_f32 v47, v47, v79
  v_cvt_pk_bf16_f32 v32, v32, v32
  s_mov_b32 s29, 0
  buffer_store_short v32, v8, s[16:19], s29 offen
  v_cvt_pk_bf16_f32 v33, v33, v33
  s_mov_b32 s29, 1024
  buffer_store_short v33, v8, s[16:19], s29 offen
  v_cvt_pk_bf16_f32 v34, v34, v34
  s_mov_b32 s29, 2048
  buffer_store_short v34, v8, s[16:19], s29 offen
  v_cvt_pk_bf16_f32 v35, v35, v35
  s_mov_b32 s29, 3072
  buffer_store_short v35, v8, s[16:19], s29 offen
  v_cvt_pk_bf16_f32 v36, v36, v36
  s_mov_b32 s29, 8192
  buffer_store_short v36, v8, s[16:19], s29 offen
  v_cvt_pk_bf16_f32 v37, v37, v37
  s_mov_b32 s29, 9216
  buffer_store_short v37, v8, s[16:19], s29 offen
  v_cvt_pk_bf16_f32 v38, v38, v38
  s_mov_b32 s29, 10240
  buffer_store_short v38, v8, s[16:19], s29 offen
  v_cvt_pk_bf16_f32 v39, v39, v39
  s_mov_b32 s29, 11264
  buffer_store_short v39, v8, s[16:19], s29 offen
  v_cvt_pk_bf16_f32 v40, v40, v40
  s_mov_b32 s29, 16384
  buffer_store_short v40, v8, s[16:19], s29 offen
  v_cvt_pk_bf16_f32 v41, v41, v41
  s_mov_b32 s29, 17408
  buffer_store_short v41, v8, s[16:19], s29 offen
  v_cvt_pk_bf16_f32 v42, v42, v42
  s_mov_b32 s29, 18432
  buffer_store_short v42, v8, s[16:19], s29 offen
  v_cvt_pk_bf16_f32 v43, v43, v43
  s_mov_b32 s29, 19456
  buffer_store_short v43, v8, s[16:19], s29 offen
  v_cvt_pk_bf16_f32 v44, v44, v44
  s_mov_b32 s29, 24576
  buffer_store_short v44, v8, s[16:19], s29 offen
  v_cvt_pk_bf16_f32 v45, v45, v45
  s_mov_b32 s29, 25600
  buffer_store_short v45, v8, s[16:19], s29 offen
  v_cvt_pk_bf16_f32 v46, v46, v46
  s_mov_b32 s29, 26624
  buffer_store_short v46, v8, s[16:19], s29 offen
  v_cvt_pk_bf16_f32 v47, v47, v47
  s_mov_b32 s29, 27648
  buffer_store_short v47, v8, s[16:19], s29 offen
L_down_kernel_end:
  s_endpgm
.section .rodata,"a"
.p2align 6
.amdhsa_kernel qkv_kernel
  .amdhsa_next_free_vgpr 188
  .amdhsa_next_free_sgpr 48
  .amdhsa_accum_offset 188
  .amdhsa_group_segment_fixed_size 0
  .amdhsa_kernarg_size 96
  .amdhsa_user_sgpr_count 2
  .amdhsa_user_sgpr_kernarg_segment_ptr 1
  .amdhsa_system_sgpr_workgroup_id_x 1
.end_amdhsa_kernel
.amdhsa_kernel oproj_kernel
  .amdhsa_next_free_vgpr 188
  .amdhsa_next_free_sgpr 48
  .amdhsa_accum_offset 188
  .amdhsa_group_segment_fixed_size 0
  .amdhsa_kernarg_size 96
  .amdhsa_user_sgpr_count 2
  .amdhsa_user_sgpr_kernarg_segment_ptr 1
  .amdhsa_system_sgpr_workgroup_id_x 1
.end_amdhsa_kernel
.amdhsa_kernel glu_kernel
  .amdhsa_next_free_vgpr 188
  .amdhsa_next_free_sgpr 48
  .amdhsa_accum_offset 188
  .amdhsa_group_segment_fixed_size 0
  .amdhsa_kernarg_size 96
  .amdhsa_user_sgpr_count 2
  .amdhsa_user_sgpr_kernarg_segment_ptr 1
  .amdhsa_system_sgpr_workgroup_id_x 1
.end_amdhsa_kernel
.amdhsa_kernel down_kernel
  .amdhsa_next_free_vgpr 188
  .amdhsa_next_free_sgpr 48
  .amdhsa_accum_offset 188
  .amdhsa_group_segment_fixed_size 0
  .amdhsa_kernarg_size 96
  .amdhsa_user_sgpr_count 2
  .amdhsa_user_sgpr_kernarg_segment_ptr 1
  .amdhsa_system_sgpr_workgroup_id_x 1
.end_amdhsa_kernel
.amdhsa_kernel attn_kernel
  .amdhsa_next_free_vgpr 116
  .amdhsa_next_free_sgpr 48
  .amdhsa_accum_offset 116
  .amdhsa_group_segment_fixed_size 0
  .amdhsa_kernarg_size 96
  .amdhsa_user_sgpr_count 2
  .amdhsa_user_sgpr_kernarg_segment_ptr 1
  .amdhsa_system_sgpr_workgroup_id_x 1
.end_amdhsa_kernel
```
